```python
import torch

def _softmax(x, axis=-1):
    return torch.softmax(x, dim=axis)
def _gelu(x):
    return torch.nn.functional.gelu(x, approximate="tanh")
def _silu(x):
    return torch.nn.functional.silu(x)
def _sigmoid(x):
    return torch.sigmoid(x)
def _layernorm(x, axis=-1, eps=1e-5):
    m = x.mean(dim=axis, keepdim=True)
    v = x.var(dim=axis, keepdim=True, unbiased=False)
    return (x - m) / torch.sqrt(v + eps)
def _scatter_add(tgt, idx, src, axis=0):
    return tgt.clone().index_add_(axis, idx, src)
def _segment_sum(src, seg, n):
    out = torch.zeros((n,) + src.shape[1:], dtype=src.dtype)
    return out.index_add_(0, seg, src)
def _pad(x, pw):
    flat = tuple(v for pair in reversed(pw) for v in pair)
    return torch.nn.functional.pad(x, flat)

kernel_name = 'sequential_preLN__mha_block__glu_gated_geglu__prompt'

def setup_inputs():

    _w = (lambda a: (lambda t: t.to(torch.bfloat16) if t.is_floating_point() else t)(torch.as_tensor(a)))
    def _A_setup():
        B, S, D, H = 1, 2048, 576, 32
        return {
            "x": _w((lambda *s: torch.randn(*s, dtype=torch.bfloat16) * 0.05)(B, S, D)),
            "wqkv": _w((lambda *s: torch.randn(*s, dtype=torch.bfloat16) * 0.05)(D, 3 * D)),
            "wo": _w((lambda *s: torch.randn(*s, dtype=torch.bfloat16) * 0.05)(D, D)),
        }
    _A_in = _A_setup()

    def _B_setup():
        B, S, Dm, Df = 1, 2048, 576, 4608
        return {
            "x": _w((lambda *s: torch.randn(*s, dtype=torch.bfloat16) * 0.05)(B, S, Dm)),
            "w_gate": _w((lambda *s: torch.randn(*s, dtype=torch.bfloat16) * 0.8)(Dm, Df) * (Dm ** -0.5)),
            "w_up": _w((lambda *s: torch.randn(*s, dtype=torch.bfloat16) * 0.8)(Dm, Df) * (Dm ** -0.5)),
            "w_down": _w((lambda *s: torch.randn(*s, dtype=torch.bfloat16) * 0.8)(Df, Dm) * (Df ** -0.5)),
        }
    _B_in = _B_setup()

    return {
        "A_x": _A_in["x"],
        "A_wqkv": _A_in["wqkv"],
        "A_wo": _A_in["wo"],
        "B_x": _B_in["x"],
        "B_w_gate": _B_in["w_gate"],
        "B_w_up": _B_in["w_up"],
        "B_w_down": _B_in["w_down"],
    }

def reference(A_x, A_wqkv, A_wo, B_x, B_w_gate, B_w_up, B_w_down):
    def _A_ref(x, wqkv, wo):
        B, S, D = x.shape
        H = 32
        Dh = D // H
        qkv = (lambda x, *d: x.permute(*d))((x @ wqkv).reshape(B, S, 3, H, Dh), 2, 0, 3, 1, 4)
        q, k, v = qkv[0], qkv[1], qkv[2]
        scores = torch.einsum("bhqd,bhkd->bhqk", q, k) * (Dh ** -0.5)
        p = _softmax(scores, axis=-1)
        o = torch.einsum("bhqk,bhkd->bhqd", p, v)
        return (lambda x, *d: x.permute(*d))(o, 0, 2, 1, 3).reshape(B, S, D) @ wo

    def _B_ref(x, w_gate, w_up, w_down):
        g = torch.einsum("bsd,df->bsf", x, w_gate)
        u = torch.einsum("bsd,df->bsf", x, w_up)
        h = _gelu(g) * u
        return torch.einsum("bsf,fd->bsd", h, w_down)

    x = A_x
    h = x + _A_ref(_layernorm(x, axis=-1), A_wqkv, A_wo)
    h2 = h + _B_ref(_layernorm(h, axis=-1), B_w_gate, B_w_up, B_w_down)
    return h2
```

```asm
; @launch kernel=qkv_kernel grid=(256,1,1) block=(512,1,1) lds=149504
; @launch kernel=attn_kernel grid=(256,1,1) block=(512,1,1) lds=155648
; @launch kernel=oproj_kernel grid=(256,1,1) block=(256,1,1) lds=61440
; @launch kernel=ffn1_kernel grid=(256,1,1) block=(512,1,1) lds=147456
; @launch kernel=ffn2_kernel grid=(256,1,1) block=(512,1,1) lds=148480
.amdgcn_target "amdgcn-amd-amdhsa--gfx950"
.text
code_begin:
.text
.globl qkv_kernel
.p2align 8
.type qkv_kernel,@function
qkv_kernel:
  s_cmp_ge_u32 s2, 256
  s_cbranch_scc1 qkv_kernel_end
  s_cmp_lt_u32 s2, 64
  s_cbranch_scc1 qkv_kernel_spare
  s_sub_u32 s2, s2, 64
  s_getpc_b64 s[94:95]
qkv_kernel_pc:
  s_sub_u32 s94, s94, qkv_kernel_pc-code_begin
  s_subb_u32 s95, s95, 0
  v_lshlrev_b32 v1, 7, v0
  v_min_u32 v1, code_end-code_begin-4, v1
  global_load_dword v173, v1, s[94:95]
  s_load_dwordx4 s[4:7], s[0:1], 0
  s_load_dwordx2 s[8:9], s[0:1], 72
  s_load_dwordx2 s[10:11], s[0:1], 64
  v_lshrrev_b32 v1, 6, v0
  v_and_b32 v165, 63, v0
  v_readfirstlane_b32 s24, v1
  s_and_b32 s25, s2, 7
  s_lshr_b32 s26, s2, 3
  s_and_b32 s27, s25, 3
  s_lshl_b32 s27, s27, 2
  s_and_b32 s28, s26, 3
  s_add_u32 s27, s27, s28
  s_lshr_b32 s28, s25, 2
  s_mul_i32 s28, s28, 6
  s_lshr_b32 s29, s26, 2
  s_add_u32 s28, s28, s29
  s_lshr_b32 s29, s28, 2
  s_and_b32 s30, s28, 3
  s_and_b32 s31, s24, 3
  s_lshr_b32 s32, s24, 2
  v_lshrrev_b32 v1, 4, v165
  v_and_b32 v2, 7, v165
  v_xor_b32 v1, v1, v2
  v_lshlrev_b32 v1, 4, v1
  v_lshrrev_b32 v2, 3, v165
  v_mul_u32_u24 v2, 1152, v2
  v_add_u32 v144, v1, v2
  v_lshrrev_b32 v1, 4, v165
  v_add_u32 v1, 4, v1
  v_and_b32 v2, 7, v165
  v_xor_b32 v1, v1, v2
  v_lshlrev_b32 v1, 4, v1
  v_lshrrev_b32 v2, 3, v165
  v_mul_u32_u24 v2, 1152, v2
  v_add_u32 v145, v1, v2
  s_lshl_b32 s35, s27, 7
  s_lshl_b32 s36, s24, 4
  s_add_u32 s35, s35, s36
  s_mul_i32 s35, s35, 1152
  s_lshl_b32 s37, s24, 11
  s_mul_i32 s36, s29, 1152
  s_mul_i32 s33, s30, 288
  s_add_u32 s36, s36, s33
  s_mul_i32 s55, s24, 3
  s_lshl_b32 s33, s24, 1
  s_add_u32 s33, s33, 4
  s_cmp_lt_u32 s24, 4
  s_cselect_b32 s55, s55, s33
  s_lshl_b32 s38, s55, 10
  s_add_u32 s38, s38, 65536
  s_waitcnt lgkmcnt(0)
  s_mov_b32 s12, s4
  s_mov_b32 s13, s5
  s_mov_b32 s14, 2359296
  s_mov_b32 s15, 0x00020000
  s_mov_b32 s16, s6
  s_mov_b32 s17, s7
  s_mov_b32 s18, 1990656
  s_mov_b32 s19, 0x00020000
  s_add_u32 m0, s37, 0
  s_add_u32 s40, s35, 0
  buffer_load_dwordx4 v144, s[12:15], s40 offen lds
  s_add_u32 m0, s37, 1024
  s_add_u32 s40, s35, 9216
  buffer_load_dwordx4 v145, s[12:15], s40 offen lds
  s_lshl_b32 s33, s55, 6
  s_mov_b32 s34, 3277
  v_add_u32 v1, s33, v165
  v_mul_lo_u32 v2, v1, s34
  v_lshrrev_b32 v2, 16, v2
  v_mul_u32_u24 v3, 20, v2
  v_sub_u32 v3, v1, v3
  v_lshrrev_b32 v162, 2, v3
  v_mul_u32_u24 v162, 72, v162
  v_and_b32 v163, 3, v3
  v_lshl_add_u32 v162, v163, 4, v162
  v_lshrrev_b32 v164, 1, v163
  v_lshl_add_u32 v162, v164, 3, v162
  v_mul_u32_u24 v163, 72, v163
  v_add_u32 v163, 32, v163
  v_cmp_gt_u32 vcc, 16, v3
  v_mul_u32_u24 v2, 3456, v2
  s_nop 0
  v_cndmask_b32 v162, v163, v162, vcc
  v_add_u32 v146, v2, v162
  v_add_u32 v1, s33, v165
  v_add_u32 v1, 64, v1
  v_mul_lo_u32 v2, v1, s34
  v_lshrrev_b32 v2, 16, v2
  v_mul_u32_u24 v3, 20, v2
  v_sub_u32 v3, v1, v3
  v_lshrrev_b32 v162, 2, v3
  v_mul_u32_u24 v162, 72, v162
  v_and_b32 v163, 3, v3
  v_lshl_add_u32 v162, v163, 4, v162
  v_lshrrev_b32 v164, 1, v163
  v_lshl_add_u32 v162, v164, 3, v162
  v_mul_u32_u24 v163, 72, v163
  v_add_u32 v163, 32, v163
  v_cmp_gt_u32 vcc, 16, v3
  v_mul_u32_u24 v2, 3456, v2
  s_nop 0
  v_cndmask_b32 v162, v163, v162, vcc
  v_add_u32 v147, v2, v162
  v_add_u32 v1, s33, v165
  v_add_u32 v1, 128, v1
  v_mul_lo_u32 v2, v1, s34
  v_lshrrev_b32 v2, 16, v2
  v_mul_u32_u24 v3, 20, v2
  v_sub_u32 v3, v1, v3
  v_lshrrev_b32 v162, 2, v3
  v_mul_u32_u24 v162, 72, v162
  v_and_b32 v163, 3, v3
  v_lshl_add_u32 v162, v163, 4, v162
  v_lshrrev_b32 v164, 1, v163
  v_lshl_add_u32 v162, v164, 3, v162
  v_mul_u32_u24 v163, 72, v163
  v_add_u32 v163, 32, v163
  v_cmp_gt_u32 vcc, 16, v3
  v_mul_u32_u24 v2, 3456, v2
  s_nop 0
  v_cndmask_b32 v162, v163, v162, vcc
  v_add_u32 v148, v2, v162
  s_add_u32 m0, s38, 0
  s_add_u32 s40, s36, 0
  buffer_load_dwordx4 v146, s[16:19], s40 offen lds
  s_add_u32 m0, s38, 1024
  s_add_u32 s40, s36, 0
  buffer_load_dwordx4 v147, s[16:19], s40 offen lds
  s_cmp_ge_u32 s24, 4
  s_cbranch_scc1 qkv_kernel_pw1
  s_add_u32 m0, s38, 2048
  s_add_u32 s40, s36, 0
  buffer_load_dwordx4 v148, s[16:19], s40 offen lds
qkv_kernel_pw1:
  s_add_u32 m0, s37, 16384
  s_add_u32 s40, s35, 128
  buffer_load_dwordx4 v144, s[12:15], s40 offen lds
  s_add_u32 m0, s37, 17408
  s_add_u32 s40, s35, 9344
  buffer_load_dwordx4 v145, s[12:15], s40 offen lds
  s_add_u32 m0, s38, 20480
  s_add_u32 s40, s36, 221184
  buffer_load_dwordx4 v146, s[16:19], s40 offen lds
  s_add_u32 m0, s38, 21504
  s_add_u32 s40, s36, 221184
  buffer_load_dwordx4 v147, s[16:19], s40 offen lds
  s_cmp_ge_u32 s24, 4
  s_cbranch_scc1 qkv_kernel_pw2
  s_add_u32 m0, s38, 22528
  s_add_u32 s40, s36, 221184
  buffer_load_dwordx4 v148, s[16:19], s40 offen lds
qkv_kernel_pw2:
  s_mov_b32 s20, s8
  s_mov_b32 s21, s9
  s_mov_b32 s22, 9437184
  s_mov_b32 s23, 0x00020000
  s_add_u32 s52, s8, 8454144
  s_addc_u32 s53, s9, 0
  s_mov_b32 s54, 72448
  s_mov_b32 s55, 0x00020000
  s_mov_b32 s56, s10
  s_mov_b32 s57, s11
  s_mov_b32 s58, 256
  s_mov_b32 s59, 0x00020000
  v_lshrrev_b32 v166, 5, v165
  v_and_b32 v167, 31, v165
  v_lshrrev_b32 v2, 1, v167
  v_and_b32 v2, 7, v2
  s_lshl_b32 s40, s31, 12
  v_lshl_add_u32 v3, v167, 7, s40
  v_add_u32 v162, 0, v166
  v_xor_b32 v162, v162, v2
  v_lshl_add_u32 v134, v162, 4, v3
  v_add_u32 v162, 2, v166
  v_xor_b32 v162, v162, v2
  v_lshl_add_u32 v135, v162, 4, v3
  v_add_u32 v162, 4, v166
  v_xor_b32 v162, v162, v2
  v_lshl_add_u32 v136, v162, 4, v3
  v_add_u32 v162, 6, v166
  v_xor_b32 v162, v162, v2
  v_lshl_add_u32 v137, v162, 4, v3
  v_bfe_u32 v1, v165, 2, 2
  v_lshl_add_u32 v1, v166, 3, v1
  v_mul_u32_u24 v1, 320, v1
  v_add_u32 v1, 65536, v1
  v_and_b32 v2, 3, v165
  v_lshlrev_b32 v3, 4, v2
  v_add_u32 v3, v3, v1
  v_add_u32 v142, 256, v3
  v_add_u32 v143, 41216, v3
  v_and_b32 v3, 1, v2
  v_lshrrev_b32 v162, 1, v2
  v_lshl_add_u32 v3, v3, 1, v162
  v_lshl_add_u32 v1, v3, 3, v1
  v_bfe_u32 v3, v165, 4, 1
  v_lshl_add_u32 v1, v3, 5, v1
  s_and_b32 s39, s31, 1
  s_xor_b32 s40, s39, 0
  s_lshl_b32 s41, s32, 1
  s_add_u32 s40, s40, s41
  s_lshl_b32 s40, s40, 6
  v_add_u32 v138, s40, v1
  v_add_u32 v139, 40960, v138
  s_xor_b32 s40, s39, 1
  s_lshl_b32 s41, s32, 1
  s_add_u32 s40, s40, s41
  s_lshl_b32 s40, s40, 6
  v_add_u32 v140, s40, v1
  v_add_u32 v141, 40960, v140
  v_mov_b32 v4, 0
  v_mov_b32 v5, 0
  v_mov_b32 v6, 0
  v_mov_b32 v7, 0
  v_mov_b32 v8, 0
  v_mov_b32 v9, 0
  v_mov_b32 v10, 0
  v_mov_b32 v11, 0
  v_mov_b32 v12, 0
  v_mov_b32 v13, 0
  v_mov_b32 v14, 0
  v_mov_b32 v15, 0
  v_mov_b32 v16, 0
  v_mov_b32 v17, 0
  v_mov_b32 v18, 0
  v_mov_b32 v19, 0
  v_mov_b32 v20, 0
  v_mov_b32 v21, 0
  v_mov_b32 v22, 0
  v_mov_b32 v23, 0
  v_mov_b32 v24, 0
  v_mov_b32 v25, 0
  v_mov_b32 v26, 0
  v_mov_b32 v27, 0
  v_mov_b32 v28, 0
  v_mov_b32 v29, 0
  v_mov_b32 v30, 0
  v_mov_b32 v31, 0
  v_mov_b32 v32, 0
  v_mov_b32 v33, 0
  v_mov_b32 v34, 0
  v_mov_b32 v35, 0
  v_mov_b32 v36, 0
  v_mov_b32 v37, 0
  v_mov_b32 v38, 0
  v_mov_b32 v39, 0
  v_mov_b32 v40, 0
  v_mov_b32 v41, 0
  v_mov_b32 v42, 0
  v_mov_b32 v43, 0
  v_mov_b32 v44, 0
  v_mov_b32 v45, 0
  v_mov_b32 v46, 0
  v_mov_b32 v47, 0
  v_mov_b32 v48, 0
  v_mov_b32 v49, 0
  v_mov_b32 v50, 0
  v_mov_b32 v51, 0
  v_mov_b32 v149, 0
  v_mov_b32 v150, 0
  v_mov_b32 v151, 0
  v_mov_b32 v152, 0
  v_mov_b32 v153, 0
  v_mov_b32 v154, 0
  v_mov_b32 v155, 0
  v_mov_b32 v156, 0
  v_mov_b32 v157, 0
  v_mov_b32 v158, 0
  v_mov_b32 v159, 0
  v_mov_b32 v160, 0
  v_mov_b32 v161, 0x3f803f80
  s_waitcnt vmcnt(4)
  s_barrier
  s_cmp_eq_u32 s32, 0
  s_cbranch_scc0 qkv_kernel_nh1
  ds_read_b128 v[52:55], v134 offset:0
  ds_read_b64_tr_b16 v[60:61], v138 offset:0
  ds_read_b64_tr_b16 v[62:63], v138 offset:1280
  ds_read_b64_tr_b16 v[64:65], v140 offset:0
  ds_read_b64_tr_b16 v[66:67], v140 offset:1280
  ds_read_b64_tr_b16 v[68:69], v142 offset:0
  ds_read_b64_tr_b16 v[70:71], v142 offset:1280
  s_waitcnt lgkmcnt(0)
  v_mfma_f32_32x32x16_bf16 v[4:19], v[60:63], v[52:55], v[4:19]
  ds_read_b128 v[56:59], v135 offset:0
  ds_read_b64_tr_b16 v[72:73], v138 offset:5120
  ds_read_b64_tr_b16 v[74:75], v138 offset:6400
  ds_read_b64_tr_b16 v[76:77], v140 offset:5120
  ds_read_b64_tr_b16 v[78:79], v140 offset:6400
  ds_read_b64_tr_b16 v[80:81], v142 offset:5120
  ds_read_b64_tr_b16 v[82:83], v142 offset:6400
  v_mfma_f32_32x32x16_bf16 v[20:35], v[64:67], v[52:55], v[20:35]
  v_mfma_f32_32x32x16_bf16 v[36:51], v[68:71], v[52:55], v[36:51]
  s_add_u32 m0, s37, 32768
  s_add_u32 s40, s35, 256
  buffer_load_dwordx4 v144, s[12:15], s40 offen lds
  s_add_u32 m0, s37, 33792
  s_add_u32 s40, s35, 9472
  buffer_load_dwordx4 v145, s[12:15], s40 offen lds
  s_add_u32 m0, s38, 40960
  s_add_u32 s40, s36, 442368
  buffer_load_dwordx4 v146, s[16:19], s40 offen lds
  s_add_u32 m0, s38, 41984
  s_add_u32 s40, s36, 442368
  buffer_load_dwordx4 v147, s[16:19], s40 offen lds
  s_add_u32 m0, s38, 43008
  s_add_u32 s40, s36, 442368
  buffer_load_dwordx4 v148, s[16:19], s40 offen lds
  s_waitcnt lgkmcnt(0)
  v_mfma_f32_32x32x16_bf16 v[4:19], v[72:75], v[56:59], v[4:19]
  ds_read_b128 v[52:55], v136 offset:0
  ds_read_b64_tr_b16 v[60:61], v138 offset:10240
  ds_read_b64_tr_b16 v[62:63], v138 offset:11520
  ds_read_b64_tr_b16 v[64:65], v140 offset:10240
  ds_read_b64_tr_b16 v[66:67], v140 offset:11520
  ds_read_b64_tr_b16 v[68:69], v142 offset:10240
  ds_read_b64_tr_b16 v[70:71], v142 offset:11520
  v_mfma_f32_32x32x16_bf16 v[20:35], v[76:79], v[56:59], v[20:35]
  v_mfma_f32_32x32x16_bf16 v[36:51], v[80:83], v[56:59], v[36:51]
  s_waitcnt vmcnt(5)
  s_barrier
  s_waitcnt lgkmcnt(0)
  v_mfma_f32_32x32x16_bf16 v[4:19], v[60:63], v[52:55], v[4:19]
  ds_read_b128 v[56:59], v137 offset:0
  ds_read_b64_tr_b16 v[72:73], v138 offset:15360
  ds_read_b64_tr_b16 v[74:75], v138 offset:16640
  ds_read_b64_tr_b16 v[76:77], v140 offset:15360
  ds_read_b64_tr_b16 v[78:79], v140 offset:16640
  ds_read_b64_tr_b16 v[80:81], v142 offset:15360
  ds_read_b64_tr_b16 v[82:83], v142 offset:16640
  v_mfma_f32_32x32x16_bf16 v[20:35], v[64:67], v[52:55], v[20:35]
  v_mfma_f32_32x32x16_bf16 v[36:51], v[68:71], v[52:55], v[36:51]
  s_add_u32 m0, s37, 49152
  s_add_u32 s40, s35, 384
  buffer_load_dwordx4 v144, s[12:15], s40 offen lds
  s_add_u32 m0, s37, 50176
  s_add_u32 s40, s35, 9600
  buffer_load_dwordx4 v145, s[12:15], s40 offen lds
  s_add_u32 m0, s38, 61440
  s_add_u32 s40, s36, 663552
  buffer_load_dwordx4 v146, s[16:19], s40 offen lds
  s_add_u32 m0, s38, 62464
  s_add_u32 s40, s36, 663552
  buffer_load_dwordx4 v147, s[16:19], s40 offen lds
  s_add_u32 m0, s38, 63488
  s_add_u32 s40, s36, 663552
  buffer_load_dwordx4 v148, s[16:19], s40 offen lds
  s_waitcnt lgkmcnt(0)
  v_mfma_f32_32x32x16_bf16 v[4:19], v[72:75], v[56:59], v[4:19]
  ds_read_b128 v[52:55], v134 offset:16384
  ds_read_b64_tr_b16 v[60:61], v138 offset:20480
  ds_read_b64_tr_b16 v[62:63], v138 offset:21760
  ds_read_b64_tr_b16 v[64:65], v140 offset:20480
  ds_read_b64_tr_b16 v[66:67], v140 offset:21760
  ds_read_b64_tr_b16 v[68:69], v142 offset:20480
  ds_read_b64_tr_b16 v[70:71], v142 offset:21760
  v_mfma_f32_32x32x16_bf16 v[20:35], v[76:79], v[56:59], v[20:35]
  v_mfma_f32_32x32x16_bf16 v[36:51], v[80:83], v[56:59], v[36:51]
  s_waitcnt lgkmcnt(0)
  v_mfma_f32_32x32x16_bf16 v[4:19], v[60:63], v[52:55], v[4:19]
  ds_read_b128 v[56:59], v135 offset:16384
  ds_read_b64_tr_b16 v[72:73], v138 offset:25600
  ds_read_b64_tr_b16 v[74:75], v138 offset:26880
  ds_read_b64_tr_b16 v[76:77], v140 offset:25600
  ds_read_b64_tr_b16 v[78:79], v140 offset:26880
  ds_read_b64_tr_b16 v[80:81], v142 offset:25600
  ds_read_b64_tr_b16 v[82:83], v142 offset:26880
  v_mfma_f32_32x32x16_bf16 v[20:35], v[64:67], v[52:55], v[20:35]
  v_mfma_f32_32x32x16_bf16 v[36:51], v[68:71], v[52:55], v[36:51]
  s_waitcnt lgkmcnt(0)
  v_mfma_f32_32x32x16_bf16 v[4:19], v[72:75], v[56:59], v[4:19]
  ds_read_b128 v[52:55], v136 offset:16384
  ds_read_b64_tr_b16 v[60:61], v138 offset:30720
  ds_read_b64_tr_b16 v[62:63], v138 offset:32000
  ds_read_b64_tr_b16 v[64:65], v140 offset:30720
  ds_read_b64_tr_b16 v[66:67], v140 offset:32000
  ds_read_b64_tr_b16 v[68:69], v142 offset:30720
  ds_read_b64_tr_b16 v[70:71], v142 offset:32000
  v_mfma_f32_32x32x16_bf16 v[20:35], v[76:79], v[56:59], v[20:35]
  v_mfma_f32_32x32x16_bf16 v[36:51], v[80:83], v[56:59], v[36:51]
  s_waitcnt vmcnt(5)
  s_barrier
  s_waitcnt lgkmcnt(0)
  v_mfma_f32_32x32x16_bf16 v[4:19], v[60:63], v[52:55], v[4:19]
  ds_read_b128 v[56:59], v137 offset:16384
  ds_read_b64_tr_b16 v[72:73], v138 offset:35840
  ds_read_b64_tr_b16 v[74:75], v138 offset:37120
  ds_read_b64_tr_b16 v[76:77], v140 offset:35840
  ds_read_b64_tr_b16 v[78:79], v140 offset:37120
  ds_read_b64_tr_b16 v[80:81], v142 offset:35840
  ds_read_b64_tr_b16 v[82:83], v142 offset:37120
  v_mfma_f32_32x32x16_bf16 v[20:35], v[64:67], v[52:55], v[20:35]
  v_mfma_f32_32x32x16_bf16 v[36:51], v[68:71], v[52:55], v[36:51]
  s_add_u32 m0, s37, 0
  s_add_u32 s40, s35, 512
  buffer_load_dwordx4 v144, s[12:15], s40 offen lds
  s_add_u32 m0, s37, 1024
  s_add_u32 s40, s35, 9728
  buffer_load_dwordx4 v145, s[12:15], s40 offen lds
  s_add_u32 m0, s38, 0
  s_add_u32 s40, s36, 884736
  buffer_load_dwordx4 v146, s[16:19], s40 offen lds
  s_add_u32 m0, s38, 1024
  s_add_u32 s40, s36, 884736
  buffer_load_dwordx4 v147, s[16:19], s40 offen lds
  s_add_u32 m0, s38, 2048
  s_add_u32 s40, s36, 884736
  buffer_load_dwordx4 v148, s[16:19], s40 offen lds
  s_waitcnt lgkmcnt(0)
  v_mfma_f32_32x32x16_bf16 v[4:19], v[72:75], v[56:59], v[4:19]
  ds_read_b128 v[52:55], v134 offset:32768
  ds_read_b64_tr_b16 v[60:61], v139 offset:0
  ds_read_b64_tr_b16 v[62:63], v139 offset:1280
  ds_read_b64_tr_b16 v[64:65], v141 offset:0
  ds_read_b64_tr_b16 v[66:67], v141 offset:1280
  ds_read_b64_tr_b16 v[68:69], v143 offset:0
  ds_read_b64_tr_b16 v[70:71], v143 offset:1280
  v_mfma_f32_32x32x16_bf16 v[20:35], v[76:79], v[56:59], v[20:35]
  v_mfma_f32_32x32x16_bf16 v[36:51], v[80:83], v[56:59], v[36:51]
  s_waitcnt lgkmcnt(0)
  v_mfma_f32_32x32x16_bf16 v[4:19], v[60:63], v[52:55], v[4:19]
  ds_read_b128 v[56:59], v135 offset:32768
  ds_read_b64_tr_b16 v[72:73], v139 offset:5120
  ds_read_b64_tr_b16 v[74:75], v139 offset:6400
  ds_read_b64_tr_b16 v[76:77], v141 offset:5120
  ds_read_b64_tr_b16 v[78:79], v141 offset:6400
  ds_read_b64_tr_b16 v[80:81], v143 offset:5120
  ds_read_b64_tr_b16 v[82:83], v143 offset:6400
  v_mfma_f32_32x32x16_bf16 v[20:35], v[64:67], v[52:55], v[20:35]
  v_mfma_f32_32x32x16_bf16 v[36:51], v[68:71], v[52:55], v[36:51]
  s_waitcnt lgkmcnt(0)
  v_mfma_f32_32x32x16_bf16 v[4:19], v[72:75], v[56:59], v[4:19]
  ds_read_b128 v[52:55], v136 offset:32768
  ds_read_b64_tr_b16 v[60:61], v139 offset:10240
  ds_read_b64_tr_b16 v[62:63], v139 offset:11520
  ds_read_b64_tr_b16 v[64:65], v141 offset:10240
  ds_read_b64_tr_b16 v[66:67], v141 offset:11520
  ds_read_b64_tr_b16 v[68:69], v143 offset:10240
  ds_read_b64_tr_b16 v[70:71], v143 offset:11520
  v_mfma_f32_32x32x16_bf16 v[20:35], v[76:79], v[56:59], v[20:35]
  v_mfma_f32_32x32x16_bf16 v[36:51], v[80:83], v[56:59], v[36:51]
  s_waitcnt vmcnt(5)
  s_barrier
  s_waitcnt lgkmcnt(0)
  v_mfma_f32_32x32x16_bf16 v[4:19], v[60:63], v[52:55], v[4:19]
  ds_read_b128 v[56:59], v137 offset:32768
  ds_read_b64_tr_b16 v[72:73], v139 offset:15360
  ds_read_b64_tr_b16 v[74:75], v139 offset:16640
  ds_read_b64_tr_b16 v[76:77], v141 offset:15360
  ds_read_b64_tr_b16 v[78:79], v141 offset:16640
  ds_read_b64_tr_b16 v[80:81], v143 offset:15360
  ds_read_b64_tr_b16 v[82:83], v143 offset:16640
  v_mfma_f32_32x32x16_bf16 v[20:35], v[64:67], v[52:55], v[20:35]
  v_mfma_f32_32x32x16_bf16 v[36:51], v[68:71], v[52:55], v[36:51]
  s_add_u32 m0, s37, 16384
  s_add_u32 s40, s35, 640
  buffer_load_dwordx4 v144, s[12:15], s40 offen lds
  s_add_u32 m0, s37, 17408
  s_add_u32 s40, s35, 9856
  buffer_load_dwordx4 v145, s[12:15], s40 offen lds
  s_add_u32 m0, s38, 20480
  s_add_u32 s40, s36, 1105920
  buffer_load_dwordx4 v146, s[16:19], s40 offen lds
  s_add_u32 m0, s38, 21504
  s_add_u32 s40, s36, 1105920
  buffer_load_dwordx4 v147, s[16:19], s40 offen lds
  s_add_u32 m0, s38, 22528
  s_add_u32 s40, s36, 1105920
  buffer_load_dwordx4 v148, s[16:19], s40 offen lds
  s_waitcnt lgkmcnt(0)
  v_mfma_f32_32x32x16_bf16 v[4:19], v[72:75], v[56:59], v[4:19]
  ds_read_b128 v[52:55], v134 offset:49152
  ds_read_b64_tr_b16 v[60:61], v139 offset:20480
  ds_read_b64_tr_b16 v[62:63], v139 offset:21760
  ds_read_b64_tr_b16 v[64:65], v141 offset:20480
  ds_read_b64_tr_b16 v[66:67], v141 offset:21760
  ds_read_b64_tr_b16 v[68:69], v143 offset:20480
  ds_read_b64_tr_b16 v[70:71], v143 offset:21760
  v_mfma_f32_32x32x16_bf16 v[20:35], v[76:79], v[56:59], v[20:35]
  v_mfma_f32_32x32x16_bf16 v[36:51], v[80:83], v[56:59], v[36:51]
  s_waitcnt lgkmcnt(0)
  v_mfma_f32_32x32x16_bf16 v[4:19], v[60:63], v[52:55], v[4:19]
  ds_read_b128 v[56:59], v135 offset:49152
  ds_read_b64_tr_b16 v[72:73], v139 offset:25600
  ds_read_b64_tr_b16 v[74:75], v139 offset:26880
  ds_read_b64_tr_b16 v[76:77], v141 offset:25600
  ds_read_b64_tr_b16 v[78:79], v141 offset:26880
  ds_read_b64_tr_b16 v[80:81], v143 offset:25600
  ds_read_b64_tr_b16 v[82:83], v143 offset:26880
  v_mfma_f32_32x32x16_bf16 v[20:35], v[64:67], v[52:55], v[20:35]
  v_mfma_f32_32x32x16_bf16 v[36:51], v[68:71], v[52:55], v[36:51]
  s_waitcnt lgkmcnt(0)
  v_mfma_f32_32x32x16_bf16 v[4:19], v[72:75], v[56:59], v[4:19]
  ds_read_b128 v[52:55], v136 offset:49152
  ds_read_b64_tr_b16 v[60:61], v139 offset:30720
  ds_read_b64_tr_b16 v[62:63], v139 offset:32000
  ds_read_b64_tr_b16 v[64:65], v141 offset:30720
  ds_read_b64_tr_b16 v[66:67], v141 offset:32000
  ds_read_b64_tr_b16 v[68:69], v143 offset:30720
  ds_read_b64_tr_b16 v[70:71], v143 offset:32000
  v_mfma_f32_32x32x16_bf16 v[20:35], v[76:79], v[56:59], v[20:35]
  v_mfma_f32_32x32x16_bf16 v[36:51], v[80:83], v[56:59], v[36:51]
  s_waitcnt vmcnt(5)
  s_barrier
  s_waitcnt lgkmcnt(0)
  v_mfma_f32_32x32x16_bf16 v[4:19], v[60:63], v[52:55], v[4:19]
  ds_read_b128 v[56:59], v137 offset:49152
  ds_read_b64_tr_b16 v[72:73], v139 offset:35840
  ds_read_b64_tr_b16 v[74:75], v139 offset:37120
  ds_read_b64_tr_b16 v[76:77], v141 offset:35840
  ds_read_b64_tr_b16 v[78:79], v141 offset:37120
  ds_read_b64_tr_b16 v[80:81], v143 offset:35840
  ds_read_b64_tr_b16 v[82:83], v143 offset:37120
  v_mfma_f32_32x32x16_bf16 v[20:35], v[64:67], v[52:55], v[20:35]
  v_mfma_f32_32x32x16_bf16 v[36:51], v[68:71], v[52:55], v[36:51]
  s_add_u32 m0, s37, 32768
  s_add_u32 s40, s35, 768
  buffer_load_dwordx4 v144, s[12:15], s40 offen lds
  s_add_u32 m0, s37, 33792
  s_add_u32 s40, s35, 9984
  buffer_load_dwordx4 v145, s[12:15], s40 offen lds
  s_add_u32 m0, s38, 40960
  s_add_u32 s40, s36, 1327104
  buffer_load_dwordx4 v146, s[16:19], s40 offen lds
  s_add_u32 m0, s38, 41984
  s_add_u32 s40, s36, 1327104
  buffer_load_dwordx4 v147, s[16:19], s40 offen lds
  s_add_u32 m0, s38, 43008
  s_add_u32 s40, s36, 1327104
  buffer_load_dwordx4 v148, s[16:19], s40 offen lds
  s_waitcnt lgkmcnt(0)
  v_mfma_f32_32x32x16_bf16 v[4:19], v[72:75], v[56:59], v[4:19]
  ds_read_b128 v[52:55], v134 offset:0
  ds_read_b64_tr_b16 v[60:61], v138 offset:0
  ds_read_b64_tr_b16 v[62:63], v138 offset:1280
  ds_read_b64_tr_b16 v[64:65], v140 offset:0
  ds_read_b64_tr_b16 v[66:67], v140 offset:1280
  ds_read_b64_tr_b16 v[68:69], v142 offset:0
  ds_read_b64_tr_b16 v[70:71], v142 offset:1280
  v_mfma_f32_32x32x16_bf16 v[20:35], v[76:79], v[56:59], v[20:35]
  v_mfma_f32_32x32x16_bf16 v[36:51], v[80:83], v[56:59], v[36:51]
  s_waitcnt lgkmcnt(0)
  v_mfma_f32_32x32x16_bf16 v[4:19], v[60:63], v[52:55], v[4:19]
  ds_read_b128 v[56:59], v135 offset:0
  ds_read_b64_tr_b16 v[72:73], v138 offset:5120
  ds_read_b64_tr_b16 v[74:75], v138 offset:6400
  ds_read_b64_tr_b16 v[76:77], v140 offset:5120
  ds_read_b64_tr_b16 v[78:79], v140 offset:6400
  ds_read_b64_tr_b16 v[80:81], v142 offset:5120
  ds_read_b64_tr_b16 v[82:83], v142 offset:6400
  v_mfma_f32_32x32x16_bf16 v[20:35], v[64:67], v[52:55], v[20:35]
  v_mfma_f32_32x32x16_bf16 v[36:51], v[68:71], v[52:55], v[36:51]
  s_waitcnt lgkmcnt(0)
  v_mfma_f32_32x32x16_bf16 v[4:19], v[72:75], v[56:59], v[4:19]
  ds_read_b128 v[52:55], v136 offset:0
  ds_read_b64_tr_b16 v[60:61], v138 offset:10240
  ds_read_b64_tr_b16 v[62:63], v138 offset:11520
  ds_read_b64_tr_b16 v[64:65], v140 offset:10240
  ds_read_b64_tr_b16 v[66:67], v140 offset:11520
  ds_read_b64_tr_b16 v[68:69], v142 offset:10240
  ds_read_b64_tr_b16 v[70:71], v142 offset:11520
  v_mfma_f32_32x32x16_bf16 v[20:35], v[76:79], v[56:59], v[20:35]
  v_mfma_f32_32x32x16_bf16 v[36:51], v[80:83], v[56:59], v[36:51]
  s_waitcnt vmcnt(5)
  s_barrier
  s_waitcnt lgkmcnt(0)
  v_mfma_f32_32x32x16_bf16 v[4:19], v[60:63], v[52:55], v[4:19]
  ds_read_b128 v[56:59], v137 offset:0
  ds_read_b64_tr_b16 v[72:73], v138 offset:15360
  ds_read_b64_tr_b16 v[74:75], v138 offset:16640
  ds_read_b64_tr_b16 v[76:77], v140 offset:15360
  ds_read_b64_tr_b16 v[78:79], v140 offset:16640
  ds_read_b64_tr_b16 v[80:81], v142 offset:15360
  ds_read_b64_tr_b16 v[82:83], v142 offset:16640
  v_mfma_f32_32x32x16_bf16 v[20:35], v[64:67], v[52:55], v[20:35]
  v_mfma_f32_32x32x16_bf16 v[36:51], v[68:71], v[52:55], v[36:51]
  s_add_u32 m0, s37, 49152
  s_add_u32 s40, s35, 896
  buffer_load_dwordx4 v144, s[12:15], s40 offen lds
  s_add_u32 m0, s37, 50176
  s_add_u32 s40, s35, 10112
  buffer_load_dwordx4 v145, s[12:15], s40 offen lds
  s_add_u32 m0, s38, 61440
  s_add_u32 s40, s36, 1548288
  buffer_load_dwordx4 v146, s[16:19], s40 offen lds
  s_add_u32 m0, s38, 62464
  s_add_u32 s40, s36, 1548288
  buffer_load_dwordx4 v147, s[16:19], s40 offen lds
  s_add_u32 m0, s38, 63488
  s_add_u32 s40, s36, 1548288
  buffer_load_dwordx4 v148, s[16:19], s40 offen lds
  s_waitcnt lgkmcnt(0)
  v_mfma_f32_32x32x16_bf16 v[4:19], v[72:75], v[56:59], v[4:19]
  ds_read_b128 v[52:55], v134 offset:16384
  ds_read_b64_tr_b16 v[60:61], v138 offset:20480
  ds_read_b64_tr_b16 v[62:63], v138 offset:21760
  ds_read_b64_tr_b16 v[64:65], v140 offset:20480
  ds_read_b64_tr_b16 v[66:67], v140 offset:21760
  ds_read_b64_tr_b16 v[68:69], v142 offset:20480
  ds_read_b64_tr_b16 v[70:71], v142 offset:21760
  v_mfma_f32_32x32x16_bf16 v[20:35], v[76:79], v[56:59], v[20:35]
  v_mfma_f32_32x32x16_bf16 v[36:51], v[80:83], v[56:59], v[36:51]
  s_waitcnt lgkmcnt(0)
  v_mfma_f32_32x32x16_bf16 v[4:19], v[60:63], v[52:55], v[4:19]
  ds_read_b128 v[56:59], v135 offset:16384
  ds_read_b64_tr_b16 v[72:73], v138 offset:25600
  ds_read_b64_tr_b16 v[74:75], v138 offset:26880
  ds_read_b64_tr_b16 v[76:77], v140 offset:25600
  ds_read_b64_tr_b16 v[78:79], v140 offset:26880
  ds_read_b64_tr_b16 v[80:81], v142 offset:25600
  ds_read_b64_tr_b16 v[82:83], v142 offset:26880
  v_mfma_f32_32x32x16_bf16 v[20:35], v[64:67], v[52:55], v[20:35]
  v_mfma_f32_32x32x16_bf16 v[36:51], v[68:71], v[52:55], v[36:51]
  s_waitcnt lgkmcnt(0)
  v_mfma_f32_32x32x16_bf16 v[4:19], v[72:75], v[56:59], v[4:19]
  ds_read_b128 v[52:55], v136 offset:16384
  ds_read_b64_tr_b16 v[60:61], v138 offset:30720
  ds_read_b64_tr_b16 v[62:63], v138 offset:32000
  ds_read_b64_tr_b16 v[64:65], v140 offset:30720
  ds_read_b64_tr_b16 v[66:67], v140 offset:32000
  ds_read_b64_tr_b16 v[68:69], v142 offset:30720
  ds_read_b64_tr_b16 v[70:71], v142 offset:32000
  v_mfma_f32_32x32x16_bf16 v[20:35], v[76:79], v[56:59], v[20:35]
  v_mfma_f32_32x32x16_bf16 v[36:51], v[80:83], v[56:59], v[36:51]
  s_waitcnt vmcnt(5)
  s_barrier
  s_waitcnt lgkmcnt(0)
  v_mfma_f32_32x32x16_bf16 v[4:19], v[60:63], v[52:55], v[4:19]
  ds_read_b128 v[56:59], v137 offset:16384
  ds_read_b64_tr_b16 v[72:73], v138 offset:35840
  ds_read_b64_tr_b16 v[74:75], v138 offset:37120
  ds_read_b64_tr_b16 v[76:77], v140 offset:35840
  ds_read_b64_tr_b16 v[78:79], v140 offset:37120
  ds_read_b64_tr_b16 v[80:81], v142 offset:35840
  ds_read_b64_tr_b16 v[82:83], v142 offset:37120
  v_mfma_f32_32x32x16_bf16 v[20:35], v[64:67], v[52:55], v[20:35]
  v_mfma_f32_32x32x16_bf16 v[36:51], v[68:71], v[52:55], v[36:51]
  s_add_u32 m0, s37, 0
  s_add_u32 s40, s35, 1024
  buffer_load_dwordx4 v144, s[12:15], s40 offen lds
  s_add_u32 m0, s37, 1024
  s_add_u32 s40, s35, 10240
  buffer_load_dwordx4 v145, s[12:15], s40 offen lds
  s_add_u32 m0, s38, 0
  s_add_u32 s40, s36, 1769472
  buffer_load_dwordx4 v146, s[16:19], s40 offen lds
  s_add_u32 m0, s38, 1024
  s_add_u32 s40, s36, 1769472
  buffer_load_dwordx4 v147, s[16:19], s40 offen lds
  s_add_u32 m0, s38, 2048
  s_add_u32 s40, s36, 1769472
  buffer_load_dwordx4 v148, s[16:19], s40 offen lds
  s_waitcnt lgkmcnt(0)
  v_mfma_f32_32x32x16_bf16 v[4:19], v[72:75], v[56:59], v[4:19]
  ds_read_b128 v[52:55], v134 offset:32768
  ds_read_b64_tr_b16 v[60:61], v139 offset:0
  ds_read_b64_tr_b16 v[62:63], v139 offset:1280
  ds_read_b64_tr_b16 v[64:65], v141 offset:0
  ds_read_b64_tr_b16 v[66:67], v141 offset:1280
  ds_read_b64_tr_b16 v[68:69], v143 offset:0
  ds_read_b64_tr_b16 v[70:71], v143 offset:1280
  v_mfma_f32_32x32x16_bf16 v[20:35], v[76:79], v[56:59], v[20:35]
  v_mfma_f32_32x32x16_bf16 v[36:51], v[80:83], v[56:59], v[36:51]
  s_waitcnt lgkmcnt(0)
  v_mfma_f32_32x32x16_bf16 v[4:19], v[60:63], v[52:55], v[4:19]
  ds_read_b128 v[56:59], v135 offset:32768
  ds_read_b64_tr_b16 v[72:73], v139 offset:5120
  ds_read_b64_tr_b16 v[74:75], v139 offset:6400
  ds_read_b64_tr_b16 v[76:77], v141 offset:5120
  ds_read_b64_tr_b16 v[78:79], v141 offset:6400
  ds_read_b64_tr_b16 v[80:81], v143 offset:5120
  ds_read_b64_tr_b16 v[82:83], v143 offset:6400
  v_mfma_f32_32x32x16_bf16 v[20:35], v[64:67], v[52:55], v[20:35]
  v_mfma_f32_32x32x16_bf16 v[36:51], v[68:71], v[52:55], v[36:51]
  s_waitcnt lgkmcnt(0)
  v_mfma_f32_32x32x16_bf16 v[4:19], v[72:75], v[56:59], v[4:19]
  ds_read_b128 v[52:55], v136 offset:32768
  ds_read_b64_tr_b16 v[60:61], v139 offset:10240
  ds_read_b64_tr_b16 v[62:63], v139 offset:11520
  ds_read_b64_tr_b16 v[64:65], v141 offset:10240
  ds_read_b64_tr_b16 v[66:67], v141 offset:11520
  ds_read_b64_tr_b16 v[68:69], v143 offset:10240
  ds_read_b64_tr_b16 v[70:71], v143 offset:11520
  v_mfma_f32_32x32x16_bf16 v[20:35], v[76:79], v[56:59], v[20:35]
  v_mfma_f32_32x32x16_bf16 v[36:51], v[80:83], v[56:59], v[36:51]
  s_waitcnt vmcnt(5)
  s_barrier
  s_waitcnt lgkmcnt(0)
  v_mfma_f32_32x32x16_bf16 v[4:19], v[60:63], v[52:55], v[4:19]
  ds_read_b128 v[56:59], v137 offset:32768
  ds_read_b64_tr_b16 v[72:73], v139 offset:15360
  ds_read_b64_tr_b16 v[74:75], v139 offset:16640
  ds_read_b64_tr_b16 v[76:77], v141 offset:15360
  ds_read_b64_tr_b16 v[78:79], v141 offset:16640
  ds_read_b64_tr_b16 v[80:81], v143 offset:15360
  ds_read_b64_tr_b16 v[82:83], v143 offset:16640
  v_mfma_f32_32x32x16_bf16 v[20:35], v[64:67], v[52:55], v[20:35]
  v_mfma_f32_32x32x16_bf16 v[36:51], v[68:71], v[52:55], v[36:51]
  s_waitcnt lgkmcnt(0)
  v_mfma_f32_32x32x16_bf16 v[4:19], v[72:75], v[56:59], v[4:19]
  ds_read_b128 v[52:55], v134 offset:49152
  ds_read_b64_tr_b16 v[60:61], v139 offset:20480
  ds_read_b64_tr_b16 v[62:63], v139 offset:21760
  ds_read_b64_tr_b16 v[64:65], v141 offset:20480
  ds_read_b64_tr_b16 v[66:67], v141 offset:21760
  ds_read_b64_tr_b16 v[68:69], v143 offset:20480
  ds_read_b64_tr_b16 v[70:71], v143 offset:21760
  v_mfma_f32_32x32x16_bf16 v[20:35], v[76:79], v[56:59], v[20:35]
  v_mfma_f32_32x32x16_bf16 v[36:51], v[80:83], v[56:59], v[36:51]
  s_waitcnt lgkmcnt(0)
  v_mfma_f32_32x32x16_bf16 v[4:19], v[60:63], v[52:55], v[4:19]
  ds_read_b128 v[56:59], v135 offset:49152
  ds_read_b64_tr_b16 v[72:73], v139 offset:25600
  ds_read_b64_tr_b16 v[74:75], v139 offset:26880
  ds_read_b64_tr_b16 v[76:77], v141 offset:25600
  ds_read_b64_tr_b16 v[78:79], v141 offset:26880
  ds_read_b64_tr_b16 v[80:81], v143 offset:25600
  ds_read_b64_tr_b16 v[82:83], v143 offset:26880
  v_mfma_f32_32x32x16_bf16 v[20:35], v[64:67], v[52:55], v[20:35]
  v_mfma_f32_32x32x16_bf16 v[36:51], v[68:71], v[52:55], v[36:51]
  s_waitcnt lgkmcnt(0)
  v_mfma_f32_32x32x16_bf16 v[4:19], v[72:75], v[56:59], v[4:19]
  ds_read_b128 v[52:55], v136 offset:49152
  ds_read_b64_tr_b16 v[60:61], v139 offset:30720
  ds_read_b64_tr_b16 v[62:63], v139 offset:32000
  ds_read_b64_tr_b16 v[64:65], v141 offset:30720
  ds_read_b64_tr_b16 v[66:67], v141 offset:32000
  ds_read_b64_tr_b16 v[68:69], v143 offset:30720
  ds_read_b64_tr_b16 v[70:71], v143 offset:32000
  v_mfma_f32_32x32x16_bf16 v[20:35], v[76:79], v[56:59], v[20:35]
  v_mfma_f32_32x32x16_bf16 v[36:51], v[80:83], v[56:59], v[36:51]
  s_waitcnt vmcnt(0)
  s_barrier
  s_cmp_gt_u32 s24, 1
  s_cbranch_scc1 qkv_kernel_nst0
  v_mov_b32 v2, 0
  s_mov_b32 s43, 0x200000
qkv_kernel_poll0:
  buffer_load_dword v1, v2, s[56:59], 0 offen sc1
  s_waitcnt vmcnt(0)
  v_readfirstlane_b32 s48, v1
  s_sub_u32 s43, s43, 1
  s_cmp_eq_u32 s43, 0
  s_cbranch_scc1 qkv_kernel_go0
  s_cmp_ge_u32 s48, 64
  s_cbranch_scc1 qkv_kernel_go0
  s_sleep 1
  s_branch qkv_kernel_poll0
qkv_kernel_go0:
  s_mul_i32 s40, s29, 576
  s_mul_i32 s41, s30, 144
  s_add_u32 s40, s40, s41
  s_lshl_b32 s40, s40, 2
  s_add_u32 s40, s40, 65536
  s_lshl_b32 s41, s27, 10
  s_cmp_eq_u32 s24, 0
  s_cselect_b32 s40, s40, s41
  s_lshl_b32 s41, s24, 10
  s_add_u32 m0, s41, 147456
  v_lshlrev_b32 v2, 4, v165
  buffer_load_dwordx4 v2, s[52:55], s40 offen sc1 lds
qkv_kernel_nst0:
  s_waitcnt lgkmcnt(0)
  v_mfma_f32_32x32x16_bf16 v[4:19], v[60:63], v[52:55], v[4:19]
  ds_read_b128 v[56:59], v137 offset:49152
  ds_read_b64_tr_b16 v[72:73], v139 offset:35840
  ds_read_b64_tr_b16 v[74:75], v139 offset:37120
  ds_read_b64_tr_b16 v[76:77], v141 offset:35840
  ds_read_b64_tr_b16 v[78:79], v141 offset:37120
  ds_read_b64_tr_b16 v[80:81], v143 offset:35840
  ds_read_b64_tr_b16 v[82:83], v143 offset:37120
  v_mfma_f32_32x32x16_bf16 v[20:35], v[64:67], v[52:55], v[20:35]
  v_mfma_f32_32x32x16_bf16 v[36:51], v[68:71], v[52:55], v[36:51]
  s_waitcnt lgkmcnt(0)
  v_mfma_f32_32x32x16_bf16 v[4:19], v[72:75], v[56:59], v[4:19]
  ds_read_b128 v[52:55], v134 offset:0
  ds_read_b64_tr_b16 v[60:61], v138 offset:0
  ds_read_b64_tr_b16 v[62:63], v138 offset:1280
  ds_read_b64_tr_b16 v[64:65], v140 offset:0
  ds_read_b64_tr_b16 v[66:67], v140 offset:1280
  ds_read_b64_tr_b16 v[68:69], v142 offset:0
  ds_read_b64_tr_b16 v[70:71], v142 offset:1280
  v_mfma_f32_32x32x16_bf16 v[20:35], v[76:79], v[56:59], v[20:35]
  v_mfma_f32_32x32x16_bf16 v[36:51], v[80:83], v[56:59], v[36:51]
  s_waitcnt lgkmcnt(0)
  v_mfma_f32_32x32x16_bf16 v[4:19], v[60:63], v[52:55], v[4:19]
  ds_read_b128 v[56:59], v135 offset:0
  ds_read_b64_tr_b16 v[72:73], v138 offset:5120
  ds_read_b64_tr_b16 v[74:75], v138 offset:6400
  ds_read_b64_tr_b16 v[76:77], v140 offset:5120
  ds_read_b64_tr_b16 v[78:79], v140 offset:6400
  ds_read_b64_tr_b16 v[80:81], v142 offset:5120
  ds_read_b64_tr_b16 v[82:83], v142 offset:6400
  v_mfma_f32_32x32x16_bf16 v[20:35], v[64:67], v[52:55], v[20:35]
  v_mfma_f32_32x32x16_bf16 v[36:51], v[68:71], v[52:55], v[36:51]
  s_waitcnt lgkmcnt(0)
  v_mfma_f32_32x32x16_bf16 v[4:19], v[72:75], v[56:59], v[4:19]
  ds_read_b128 v[52:55], v136 offset:0
  ds_read_b64_tr_b16 v[60:61], v138 offset:10240
  ds_read_b64_tr_b16 v[62:63], v138 offset:11520
  ds_read_b64_tr_b16 v[64:65], v140 offset:10240
  ds_read_b64_tr_b16 v[66:67], v140 offset:11520
  ds_read_b64_tr_b16 v[68:69], v142 offset:10240
  ds_read_b64_tr_b16 v[70:71], v142 offset:11520
  v_mfma_f32_32x32x16_bf16 v[20:35], v[76:79], v[56:59], v[20:35]
  v_mfma_f32_32x32x16_bf16 v[36:51], v[80:83], v[56:59], v[36:51]
  s_waitcnt vmcnt(0)
  s_barrier
  s_xor_b32 s40, s39, 0
  s_lshl_b32 s41, s32, 1
  s_add_u32 s40, s40, s41
  s_mul_i32 s40, s40, 144
  s_add_u32 s40, s40, 147456
  v_lshl_add_u32 v2, v166, 5, s40
  ds_read_b128 v[84:87], v2 offset:0
  ds_read_b128 v[88:91], v2 offset:16
  ds_read_b128 v[92:95], v2 offset:80
  ds_read_b128 v[96:99], v2 offset:96
  s_xor_b32 s40, s39, 1
  s_lshl_b32 s41, s32, 1
  s_add_u32 s40, s40, s41
  s_mul_i32 s40, s40, 144
  s_add_u32 s40, s40, 147456
  v_lshl_add_u32 v2, v166, 5, s40
  ds_read_b128 v[100:103], v2 offset:0
  ds_read_b128 v[104:107], v2 offset:16
  ds_read_b128 v[108:111], v2 offset:80
  ds_read_b128 v[112:115], v2 offset:96
  v_mul_u32_u24 v2, 144, v166
  v_add_u32 v2, 147456, v2
  ds_read_b128 v[116:119], v2 offset:64
  ds_read_b128 v[120:123], v2 offset:352
  s_lshl_b32 s40, s31, 8
  s_add_u32 s40, s40, 148480
  v_lshl_add_u32 v2, v167, 3, s40
  ds_read_b64 v[132:133], v2
  s_lshl_b32 s41, s27, 2
  s_add_u32 s48, s31, s41
  s_lshr_b32 s40, s48, 3
  s_mul_i32 s53, s40, 19456
  s_and_b32 s54, s48, 7
  s_lshl_b32 s49, s54, 10
  s_add_u32 s49, s49, s53
  s_mul_i32 s50, s54, 1280
  s_add_u32 s50, s50, s53
  s_add_u32 s50, s50, 9216
  s_lshl_b32 s51, s48, 10
  s_cmp_eq_u32 s29, 0
  s_cselect_b32 s45, 0, 3145728
  s_mov_b32 s46, 155648
  s_cselect_b32 s46, 65536, s46
  s_cselect_b32 s47, s51, s49
  s_cselect_b32 s44, 0x3eae1a93, 1.0
  s_cmp_eq_u32 s29, 2
  s_cselect_b32 s47, s50, s47
  s_cselect_b64 vcc, -1, 0
  s_add_u32 s47, s47, s45
  v_lshlrev_b32 v170, 4, v165
  v_mul_u32_u24 v2, 40, v167
  v_lshl_add_u32 v2, v166, 4, v2
  v_cndmask_b32 v170, v170, v2, vcc
  s_waitcnt lgkmcnt(0)
  v_mfma_f32_32x32x16_bf16 v[4:19], v[60:63], v[52:55], v[4:19]
  ds_read_b128 v[56:59], v137 offset:0
  ds_read_b64_tr_b16 v[72:73], v138 offset:15360
  ds_read_b64_tr_b16 v[74:75], v138 offset:16640
  ds_read_b64_tr_b16 v[76:77], v140 offset:15360
  ds_read_b64_tr_b16 v[78:79], v140 offset:16640
  ds_read_b64_tr_b16 v[80:81], v142 offset:15360
  ds_read_b64_tr_b16 v[82:83], v142 offset:16640
  v_mfma_f32_32x32x16_bf16 v[20:35], v[64:67], v[52:55], v[20:35]
  v_mfma_f32_32x32x16_bf16 v[36:51], v[68:71], v[52:55], v[36:51]
  s_waitcnt lgkmcnt(0)
  v_mfma_f32_32x32x16_bf16 v[4:19], v[72:75], v[56:59], v[4:19]
  v_mfma_f32_32x32x16_bf16 v[20:35], v[76:79], v[56:59], v[20:35]
  v_mfma_f32_32x32x16_bf16 v[36:51], v[80:83], v[56:59], v[36:51]
  s_branch qkv_kernel_epi
qkv_kernel_nh1:
  ds_read_b128 v[52:55], v134 offset:0
  ds_read_b64_tr_b16 v[60:61], v138 offset:0
  ds_read_b64_tr_b16 v[62:63], v138 offset:1280
  ds_read_b64_tr_b16 v[64:65], v140 offset:0
  ds_read_b64_tr_b16 v[66:67], v140 offset:1280
  s_waitcnt lgkmcnt(0)
  v_mfma_f32_32x32x16_bf16 v[4:19], v[60:63], v[52:55], v[4:19]
  ds_read_b128 v[56:59], v135 offset:0
  ds_read_b64_tr_b16 v[72:73], v138 offset:5120
  ds_read_b64_tr_b16 v[74:75], v138 offset:6400
  ds_read_b64_tr_b16 v[76:77], v140 offset:5120
  ds_read_b64_tr_b16 v[78:79], v140 offset:6400
  v_mfma_f32_32x32x16_bf16 v[20:35], v[64:67], v[52:55], v[20:35]
  s_add_u32 m0, s37, 32768
  s_add_u32 s40, s35, 256
  buffer_load_dwordx4 v144, s[12:15], s40 offen lds
  s_add_u32 m0, s37, 33792
  s_add_u32 s40, s35, 9472
  buffer_load_dwordx4 v145, s[12:15], s40 offen lds
  s_add_u32 m0, s38, 40960
  s_add_u32 s40, s36, 442368
  buffer_load_dwordx4 v146, s[16:19], s40 offen lds
  s_add_u32 m0, s38, 41984
  s_add_u32 s40, s36, 442368
  buffer_load_dwordx4 v147, s[16:19], s40 offen lds
  s_waitcnt lgkmcnt(0)
  v_mfma_f32_32x32x16_bf16 v[4:19], v[72:75], v[56:59], v[4:19]
  ds_read_b128 v[52:55], v136 offset:0
  ds_read_b64_tr_b16 v[60:61], v138 offset:10240
  ds_read_b64_tr_b16 v[62:63], v138 offset:11520
  ds_read_b64_tr_b16 v[64:65], v140 offset:10240
  ds_read_b64_tr_b16 v[66:67], v140 offset:11520
  v_mfma_f32_32x32x16_bf16 v[20:35], v[76:79], v[56:59], v[20:35]
  s_waitcnt vmcnt(4)
  s_barrier
  s_waitcnt lgkmcnt(0)
  v_mfma_f32_32x32x16_bf16 v[4:19], v[60:63], v[52:55], v[4:19]
  ds_read_b128 v[56:59], v137 offset:0
  ds_read_b64_tr_b16 v[72:73], v138 offset:15360
  ds_read_b64_tr_b16 v[74:75], v138 offset:16640
  ds_read_b64_tr_b16 v[76:77], v140 offset:15360
  ds_read_b64_tr_b16 v[78:79], v140 offset:16640
  v_mfma_f32_32x32x16_bf16 v[20:35], v[64:67], v[52:55], v[20:35]
  s_add_u32 m0, s37, 49152
  s_add_u32 s40, s35, 384
  buffer_load_dwordx4 v144, s[12:15], s40 offen lds
  s_add_u32 m0, s37, 50176
  s_add_u32 s40, s35, 9600
  buffer_load_dwordx4 v145, s[12:15], s40 offen lds
  s_add_u32 m0, s38, 61440
  s_add_u32 s40, s36, 663552
  buffer_load_dwordx4 v146, s[16:19], s40 offen lds
  s_add_u32 m0, s38, 62464
  s_add_u32 s40, s36, 663552
  buffer_load_dwordx4 v147, s[16:19], s40 offen lds
  s_waitcnt lgkmcnt(0)
  v_mfma_f32_32x32x16_bf16 v[4:19], v[72:75], v[56:59], v[4:19]
  ds_read_b128 v[52:55], v134 offset:16384
  ds_read_b64_tr_b16 v[60:61], v138 offset:20480
  ds_read_b64_tr_b16 v[62:63], v138 offset:21760
  ds_read_b64_tr_b16 v[64:65], v140 offset:20480
  ds_read_b64_tr_b16 v[66:67], v140 offset:21760
  v_mfma_f32_32x32x16_bf16 v[20:35], v[76:79], v[56:59], v[20:35]
  s_waitcnt lgkmcnt(0)
  v_mfma_f32_32x32x16_bf16 v[4:19], v[60:63], v[52:55], v[4:19]
  ds_read_b128 v[56:59], v135 offset:16384
  ds_read_b64_tr_b16 v[72:73], v138 offset:25600
  ds_read_b64_tr_b16 v[74:75], v138 offset:26880
  ds_read_b64_tr_b16 v[76:77], v140 offset:25600
  ds_read_b64_tr_b16 v[78:79], v140 offset:26880
  v_mfma_f32_32x32x16_bf16 v[20:35], v[64:67], v[52:55], v[20:35]
  s_waitcnt lgkmcnt(0)
  v_mfma_f32_32x32x16_bf16 v[4:19], v[72:75], v[56:59], v[4:19]
  ds_read_b128 v[52:55], v136 offset:16384
  ds_read_b64_tr_b16 v[60:61], v138 offset:30720
  ds_read_b64_tr_b16 v[62:63], v138 offset:32000
  ds_read_b64_tr_b16 v[64:65], v140 offset:30720
  ds_read_b64_tr_b16 v[66:67], v140 offset:32000
  v_mfma_f32_32x32x16_bf16 v[20:35], v[76:79], v[56:59], v[20:35]
  s_waitcnt vmcnt(4)
  s_barrier
  s_waitcnt lgkmcnt(0)
  v_mfma_f32_32x32x16_bf16 v[4:19], v[60:63], v[52:55], v[4:19]
  ds_read_b128 v[56:59], v137 offset:16384
  ds_read_b64_tr_b16 v[72:73], v138 offset:35840
  ds_read_b64_tr_b16 v[74:75], v138 offset:37120
  ds_read_b64_tr_b16 v[76:77], v140 offset:35840
  ds_read_b64_tr_b16 v[78:79], v140 offset:37120
  v_mfma_f32_32x32x16_bf16 v[20:35], v[64:67], v[52:55], v[20:35]
  s_add_u32 m0, s37, 0
  s_add_u32 s40, s35, 512
  buffer_load_dwordx4 v144, s[12:15], s40 offen lds
  s_add_u32 m0, s37, 1024
  s_add_u32 s40, s35, 9728
  buffer_load_dwordx4 v145, s[12:15], s40 offen lds
  s_add_u32 m0, s38, 0
  s_add_u32 s40, s36, 884736
  buffer_load_dwordx4 v146, s[16:19], s40 offen lds
  s_add_u32 m0, s38, 1024
  s_add_u32 s40, s36, 884736
  buffer_load_dwordx4 v147, s[16:19], s40 offen lds
  s_waitcnt lgkmcnt(0)
  v_mfma_f32_32x32x16_bf16 v[4:19], v[72:75], v[56:59], v[4:19]
  ds_read_b128 v[52:55], v134 offset:32768
  ds_read_b64_tr_b16 v[60:61], v139 offset:0
  ds_read_b64_tr_b16 v[62:63], v139 offset:1280
  ds_read_b64_tr_b16 v[64:65], v141 offset:0
  ds_read_b64_tr_b16 v[66:67], v141 offset:1280
  v_mfma_f32_32x32x16_bf16 v[20:35], v[76:79], v[56:59], v[20:35]
  s_waitcnt lgkmcnt(0)
  v_mfma_f32_32x32x16_bf16 v[4:19], v[60:63], v[52:55], v[4:19]
  ds_read_b128 v[56:59], v135 offset:32768
  ds_read_b64_tr_b16 v[72:73], v139 offset:5120
  ds_read_b64_tr_b16 v[74:75], v139 offset:6400
  ds_read_b64_tr_b16 v[76:77], v141 offset:5120
  ds_read_b64_tr_b16 v[78:79], v141 offset:6400
  v_mfma_f32_32x32x16_bf16 v[20:35], v[64:67], v[52:55], v[20:35]
  s_waitcnt lgkmcnt(0)
  v_mfma_f32_32x32x16_bf16 v[4:19], v[72:75], v[56:59], v[4:19]
  ds_read_b128 v[52:55], v136 offset:32768
  ds_read_b64_tr_b16 v[60:61], v139 offset:10240
  ds_read_b64_tr_b16 v[62:63], v139 offset:11520
  ds_read_b64_tr_b16 v[64:65], v141 offset:10240
  ds_read_b64_tr_b16 v[66:67], v141 offset:11520
  v_mfma_f32_32x32x16_bf16 v[20:35], v[76:79], v[56:59], v[20:35]
  s_waitcnt vmcnt(4)
  s_barrier
  s_waitcnt lgkmcnt(0)
  v_mfma_f32_32x32x16_bf16 v[4:19], v[60:63], v[52:55], v[4:19]
  ds_read_b128 v[56:59], v137 offset:32768
  ds_read_b64_tr_b16 v[72:73], v139 offset:15360
  ds_read_b64_tr_b16 v[74:75], v139 offset:16640
  ds_read_b64_tr_b16 v[76:77], v141 offset:15360
  ds_read_b64_tr_b16 v[78:79], v141 offset:16640
  v_mfma_f32_32x32x16_bf16 v[20:35], v[64:67], v[52:55], v[20:35]
  s_add_u32 m0, s37, 16384
  s_add_u32 s40, s35, 640
  buffer_load_dwordx4 v144, s[12:15], s40 offen lds
  s_add_u32 m0, s37, 17408
  s_add_u32 s40, s35, 9856
  buffer_load_dwordx4 v145, s[12:15], s40 offen lds
  s_add_u32 m0, s38, 20480
  s_add_u32 s40, s36, 1105920
  buffer_load_dwordx4 v146, s[16:19], s40 offen lds
  s_add_u32 m0, s38, 21504
  s_add_u32 s40, s36, 1105920
  buffer_load_dwordx4 v147, s[16:19], s40 offen lds
  s_waitcnt lgkmcnt(0)
  v_mfma_f32_32x32x16_bf16 v[4:19], v[72:75], v[56:59], v[4:19]
  ds_read_b128 v[52:55], v134 offset:49152
  ds_read_b64_tr_b16 v[60:61], v139 offset:20480
  ds_read_b64_tr_b16 v[62:63], v139 offset:21760
  ds_read_b64_tr_b16 v[64:65], v141 offset:20480
  ds_read_b64_tr_b16 v[66:67], v141 offset:21760
  v_mfma_f32_32x32x16_bf16 v[20:35], v[76:79], v[56:59], v[20:35]
  s_waitcnt lgkmcnt(0)
  v_mfma_f32_32x32x16_bf16 v[4:19], v[60:63], v[52:55], v[4:19]
  ds_read_b128 v[56:59], v135 offset:49152
  ds_read_b64_tr_b16 v[72:73], v139 offset:25600
  ds_read_b64_tr_b16 v[74:75], v139 offset:26880
  ds_read_b64_tr_b16 v[76:77], v141 offset:25600
  ds_read_b64_tr_b16 v[78:79], v141 offset:26880
  v_mfma_f32_32x32x16_bf16 v[20:35], v[64:67], v[52:55], v[20:35]
  s_waitcnt lgkmcnt(0)
  v_mfma_f32_32x32x16_bf16 v[4:19], v[72:75], v[56:59], v[4:19]
  ds_read_b128 v[52:55], v136 offset:49152
  ds_read_b64_tr_b16 v[60:61], v139 offset:30720
  ds_read_b64_tr_b16 v[62:63], v139 offset:32000
  ds_read_b64_tr_b16 v[64:65], v141 offset:30720
  ds_read_b64_tr_b16 v[66:67], v141 offset:32000
  v_mfma_f32_32x32x16_bf16 v[20:35], v[76:79], v[56:59], v[20:35]
  s_waitcnt vmcnt(4)
  s_barrier
  s_waitcnt lgkmcnt(0)
  v_mfma_f32_32x32x16_bf16 v[4:19], v[60:63], v[52:55], v[4:19]
  ds_read_b128 v[56:59], v137 offset:49152
  ds_read_b64_tr_b16 v[72:73], v139 offset:35840
  ds_read_b64_tr_b16 v[74:75], v139 offset:37120
  ds_read_b64_tr_b16 v[76:77], v141 offset:35840
  ds_read_b64_tr_b16 v[78:79], v141 offset:37120
  v_mfma_f32_32x32x16_bf16 v[20:35], v[64:67], v[52:55], v[20:35]
  s_add_u32 m0, s37, 32768
  s_add_u32 s40, s35, 768
  buffer_load_dwordx4 v144, s[12:15], s40 offen lds
  s_add_u32 m0, s37, 33792
  s_add_u32 s40, s35, 9984
  buffer_load_dwordx4 v145, s[12:15], s40 offen lds
  s_add_u32 m0, s38, 40960
  s_add_u32 s40, s36, 1327104
  buffer_load_dwordx4 v146, s[16:19], s40 offen lds
  s_add_u32 m0, s38, 41984
  s_add_u32 s40, s36, 1327104
  buffer_load_dwordx4 v147, s[16:19], s40 offen lds
  s_waitcnt lgkmcnt(0)
  v_mfma_f32_32x32x16_bf16 v[4:19], v[72:75], v[56:59], v[4:19]
  ds_read_b128 v[52:55], v134 offset:0
  ds_read_b64_tr_b16 v[60:61], v138 offset:0
  ds_read_b64_tr_b16 v[62:63], v138 offset:1280
  ds_read_b64_tr_b16 v[64:65], v140 offset:0
  ds_read_b64_tr_b16 v[66:67], v140 offset:1280
  v_mfma_f32_32x32x16_bf16 v[20:35], v[76:79], v[56:59], v[20:35]
  s_waitcnt lgkmcnt(0)
  v_mfma_f32_32x32x16_bf16 v[4:19], v[60:63], v[52:55], v[4:19]
  ds_read_b128 v[56:59], v135 offset:0
  ds_read_b64_tr_b16 v[72:73], v138 offset:5120
  ds_read_b64_tr_b16 v[74:75], v138 offset:6400
  ds_read_b64_tr_b16 v[76:77], v140 offset:5120
  ds_read_b64_tr_b16 v[78:79], v140 offset:6400
  v_mfma_f32_32x32x16_bf16 v[20:35], v[64:67], v[52:55], v[20:35]
  s_waitcnt lgkmcnt(0)
  v_mfma_f32_32x32x16_bf16 v[4:19], v[72:75], v[56:59], v[4:19]
  ds_read_b128 v[52:55], v136 offset:0
  ds_read_b64_tr_b16 v[60:61], v138 offset:10240
  ds_read_b64_tr_b16 v[62:63], v138 offset:11520
  ds_read_b64_tr_b16 v[64:65], v140 offset:10240
  ds_read_b64_tr_b16 v[66:67], v140 offset:11520
  v_mfma_f32_32x32x16_bf16 v[20:35], v[76:79], v[56:59], v[20:35]
  s_waitcnt vmcnt(4)
  s_barrier
  s_waitcnt lgkmcnt(0)
  v_mfma_f32_32x32x16_bf16 v[4:19], v[60:63], v[52:55], v[4:19]
  ds_read_b128 v[56:59], v137 offset:0
  ds_read_b64_tr_b16 v[72:73], v138 offset:15360
  ds_read_b64_tr_b16 v[74:75], v138 offset:16640
  ds_read_b64_tr_b16 v[76:77], v140 offset:15360
  ds_read_b64_tr_b16 v[78:79], v140 offset:16640
  v_mfma_f32_32x32x16_bf16 v[20:35], v[64:67], v[52:55], v[20:35]
  s_add_u32 m0, s37, 49152
  s_add_u32 s40, s35, 896
  buffer_load_dwordx4 v144, s[12:15], s40 offen lds
  s_add_u32 m0, s37, 50176
  s_add_u32 s40, s35, 10112
  buffer_load_dwordx4 v145, s[12:15], s40 offen lds
  s_add_u32 m0, s38, 61440
  s_add_u32 s40, s36, 1548288
  buffer_load_dwordx4 v146, s[16:19], s40 offen lds
  s_add_u32 m0, s38, 62464
  s_add_u32 s40, s36, 1548288
  buffer_load_dwordx4 v147, s[16:19], s40 offen lds
  s_waitcnt lgkmcnt(0)
  v_mfma_f32_32x32x16_bf16 v[4:19], v[72:75], v[56:59], v[4:19]
  ds_read_b128 v[52:55], v134 offset:16384
  ds_read_b64_tr_b16 v[60:61], v138 offset:20480
  ds_read_b64_tr_b16 v[62:63], v138 offset:21760
  ds_read_b64_tr_b16 v[64:65], v140 offset:20480
  ds_read_b64_tr_b16 v[66:67], v140 offset:21760
  v_mfma_f32_32x32x16_bf16 v[20:35], v[76:79], v[56:59], v[20:35]
  s_waitcnt lgkmcnt(0)
  v_mfma_f32_32x32x16_bf16 v[4:19], v[60:63], v[52:55], v[4:19]
  ds_read_b128 v[56:59], v135 offset:16384
  ds_read_b64_tr_b16 v[72:73], v138 offset:25600
  ds_read_b64_tr_b16 v[74:75], v138 offset:26880
  ds_read_b64_tr_b16 v[76:77], v140 offset:25600
  ds_read_b64_tr_b16 v[78:79], v140 offset:26880
  v_mfma_f32_32x32x16_bf16 v[20:35], v[64:67], v[52:55], v[20:35]
  s_waitcnt lgkmcnt(0)
  v_mfma_f32_32x32x16_bf16 v[4:19], v[72:75], v[56:59], v[4:19]
  ds_read_b128 v[52:55], v136 offset:16384
  ds_read_b64_tr_b16 v[60:61], v138 offset:30720
  ds_read_b64_tr_b16 v[62:63], v138 offset:32000
  ds_read_b64_tr_b16 v[64:65], v140 offset:30720
  ds_read_b64_tr_b16 v[66:67], v140 offset:32000
  v_mfma_f32_32x32x16_bf16 v[20:35], v[76:79], v[56:59], v[20:35]
  s_waitcnt vmcnt(4)
  s_barrier
  s_waitcnt lgkmcnt(0)
  v_mfma_f32_32x32x16_bf16 v[4:19], v[60:63], v[52:55], v[4:19]
  ds_read_b128 v[56:59], v137 offset:16384
  ds_read_b64_tr_b16 v[72:73], v138 offset:35840
  ds_read_b64_tr_b16 v[74:75], v138 offset:37120
  ds_read_b64_tr_b16 v[76:77], v140 offset:35840
  ds_read_b64_tr_b16 v[78:79], v140 offset:37120
  v_mfma_f32_32x32x16_bf16 v[20:35], v[64:67], v[52:55], v[20:35]
  s_add_u32 m0, s37, 0
  s_add_u32 s40, s35, 1024
  buffer_load_dwordx4 v144, s[12:15], s40 offen lds
  s_add_u32 m0, s37, 1024
  s_add_u32 s40, s35, 10240
  buffer_load_dwordx4 v145, s[12:15], s40 offen lds
  s_add_u32 m0, s38, 0
  s_add_u32 s40, s36, 1769472
  buffer_load_dwordx4 v146, s[16:19], s40 offen lds
  s_add_u32 m0, s38, 1024
  s_add_u32 s40, s36, 1769472
  buffer_load_dwordx4 v147, s[16:19], s40 offen lds
  s_waitcnt lgkmcnt(0)
  v_mfma_f32_32x32x16_bf16 v[4:19], v[72:75], v[56:59], v[4:19]
  ds_read_b128 v[52:55], v134 offset:32768
  ds_read_b64_tr_b16 v[60:61], v139 offset:0
  ds_read_b64_tr_b16 v[62:63], v139 offset:1280
  ds_read_b64_tr_b16 v[64:65], v141 offset:0
  ds_read_b64_tr_b16 v[66:67], v141 offset:1280
  v_mfma_f32_32x32x16_bf16 v[20:35], v[76:79], v[56:59], v[20:35]
  s_waitcnt lgkmcnt(0)
  v_mfma_f32_32x32x16_bf16 v[4:19], v[60:63], v[52:55], v[4:19]
  ds_read_b128 v[56:59], v135 offset:32768
  ds_read_b64_tr_b16 v[72:73], v139 offset:5120
  ds_read_b64_tr_b16 v[74:75], v139 offset:6400
  ds_read_b64_tr_b16 v[76:77], v141 offset:5120
  ds_read_b64_tr_b16 v[78:79], v141 offset:6400
  v_mfma_f32_32x32x16_bf16 v[20:35], v[64:67], v[52:55], v[20:35]
  s_waitcnt lgkmcnt(0)
  v_mfma_f32_32x32x16_bf16 v[4:19], v[72:75], v[56:59], v[4:19]
  ds_read_b128 v[52:55], v136 offset:32768
  ds_read_b64_tr_b16 v[60:61], v139 offset:10240
  ds_read_b64_tr_b16 v[62:63], v139 offset:11520
  ds_read_b64_tr_b16 v[64:65], v141 offset:10240
  ds_read_b64_tr_b16 v[66:67], v141 offset:11520
  v_mfma_f32_32x32x16_bf16 v[20:35], v[76:79], v[56:59], v[20:35]
  s_waitcnt vmcnt(4)
  s_barrier
  s_waitcnt lgkmcnt(0)
  v_mfma_f32_32x32x16_bf16 v[4:19], v[60:63], v[52:55], v[4:19]
  ds_read_b128 v[56:59], v137 offset:32768
  ds_read_b64_tr_b16 v[72:73], v139 offset:15360
  ds_read_b64_tr_b16 v[74:75], v139 offset:16640
  ds_read_b64_tr_b16 v[76:77], v141 offset:15360
  ds_read_b64_tr_b16 v[78:79], v141 offset:16640
  v_mfma_f32_32x32x16_bf16 v[20:35], v[64:67], v[52:55], v[20:35]
  s_waitcnt lgkmcnt(0)
  v_mfma_f32_32x32x16_bf16 v[4:19], v[72:75], v[56:59], v[4:19]
  ds_read_b128 v[52:55], v134 offset:49152
  ds_read_b64_tr_b16 v[60:61], v139 offset:20480
  ds_read_b64_tr_b16 v[62:63], v139 offset:21760
  ds_read_b64_tr_b16 v[64:65], v141 offset:20480
  ds_read_b64_tr_b16 v[66:67], v141 offset:21760
  v_mfma_f32_32x32x16_bf16 v[20:35], v[76:79], v[56:59], v[20:35]
  s_waitcnt lgkmcnt(0)
  v_mfma_f32_32x32x16_bf16 v[4:19], v[60:63], v[52:55], v[4:19]
  ds_read_b128 v[56:59], v135 offset:49152
  ds_read_b64_tr_b16 v[72:73], v139 offset:25600
  ds_read_b64_tr_b16 v[74:75], v139 offset:26880
  ds_read_b64_tr_b16 v[76:77], v141 offset:25600
  ds_read_b64_tr_b16 v[78:79], v141 offset:26880
  v_mfma_f32_32x32x16_bf16 v[20:35], v[64:67], v[52:55], v[20:35]
  s_waitcnt lgkmcnt(0)
  v_mfma_f32_32x32x16_bf16 v[4:19], v[72:75], v[56:59], v[4:19]
  ds_read_b128 v[52:55], v136 offset:49152
  ds_read_b64_tr_b16 v[60:61], v139 offset:30720
  ds_read_b64_tr_b16 v[62:63], v139 offset:32000
  ds_read_b64_tr_b16 v[64:65], v141 offset:30720
  ds_read_b64_tr_b16 v[66:67], v141 offset:32000
  v_mfma_f32_32x32x16_bf16 v[20:35], v[76:79], v[56:59], v[20:35]
  s_waitcnt vmcnt(0)
  s_barrier
  s_cmp_gt_u32 s24, 1
  s_cbranch_scc1 qkv_kernel_nst1
  v_mov_b32 v2, 0
  s_mov_b32 s43, 0x200000
qkv_kernel_poll1:
  buffer_load_dword v1, v2, s[56:59], 0 offen sc1
  s_waitcnt vmcnt(0)
  v_readfirstlane_b32 s48, v1
  s_sub_u32 s43, s43, 1
  s_cmp_eq_u32 s43, 0
  s_cbranch_scc1 qkv_kernel_go1
  s_cmp_ge_u32 s48, 64
  s_cbranch_scc1 qkv_kernel_go1
  s_sleep 1
  s_branch qkv_kernel_poll1
qkv_kernel_go1:
  s_mul_i32 s40, s29, 576
  s_mul_i32 s41, s30, 144
  s_add_u32 s40, s40, s41
  s_lshl_b32 s40, s40, 2
  s_add_u32 s40, s40, 65536
  s_lshl_b32 s41, s27, 10
  s_cmp_eq_u32 s24, 0
  s_cselect_b32 s40, s40, s41
  s_lshl_b32 s41, s24, 10
  s_add_u32 m0, s41, 147456
  v_lshlrev_b32 v2, 4, v165
  buffer_load_dwordx4 v2, s[52:55], s40 offen sc1 lds
qkv_kernel_nst1:
  s_waitcnt lgkmcnt(0)
  v_mfma_f32_32x32x16_bf16 v[4:19], v[60:63], v[52:55], v[4:19]
  ds_read_b128 v[56:59], v137 offset:49152
  ds_read_b64_tr_b16 v[72:73], v139 offset:35840
  ds_read_b64_tr_b16 v[74:75], v139 offset:37120
  ds_read_b64_tr_b16 v[76:77], v141 offset:35840
  ds_read_b64_tr_b16 v[78:79], v141 offset:37120
  v_mfma_f32_32x32x16_bf16 v[20:35], v[64:67], v[52:55], v[20:35]
  s_waitcnt lgkmcnt(0)
  v_mfma_f32_32x32x16_bf16 v[4:19], v[72:75], v[56:59], v[4:19]
  ds_read_b128 v[52:55], v134 offset:0
  ds_read_b64_tr_b16 v[60:61], v138 offset:0
  ds_read_b64_tr_b16 v[62:63], v138 offset:1280
  ds_read_b64_tr_b16 v[64:65], v140 offset:0
  ds_read_b64_tr_b16 v[66:67], v140 offset:1280
  v_mfma_f32_32x32x16_bf16 v[20:35], v[76:79], v[56:59], v[20:35]
  s_waitcnt lgkmcnt(0)
  v_mfma_f32_32x32x16_bf16 v[4:19], v[60:63], v[52:55], v[4:19]
  ds_read_b128 v[56:59], v135 offset:0
  ds_read_b64_tr_b16 v[72:73], v138 offset:5120
  ds_read_b64_tr_b16 v[74:75], v138 offset:6400
  ds_read_b64_tr_b16 v[76:77], v140 offset:5120
  ds_read_b64_tr_b16 v[78:79], v140 offset:6400
  v_mfma_f32_32x32x16_bf16 v[20:35], v[64:67], v[52:55], v[20:35]
  s_waitcnt lgkmcnt(0)
  v_mfma_f32_32x32x16_bf16 v[4:19], v[72:75], v[56:59], v[4:19]
  ds_read_b128 v[52:55], v136 offset:0
  ds_read_b64_tr_b16 v[60:61], v138 offset:10240
  ds_read_b64_tr_b16 v[62:63], v138 offset:11520
  ds_read_b64_tr_b16 v[64:65], v140 offset:10240
  ds_read_b64_tr_b16 v[66:67], v140 offset:11520
  v_mfma_f32_32x32x16_bf16 v[20:35], v[76:79], v[56:59], v[20:35]
  s_waitcnt vmcnt(0)
  s_barrier
  s_xor_b32 s40, s39, 0
  s_lshl_b32 s41, s32, 1
  s_add_u32 s40, s40, s41
  s_mul_i32 s40, s40, 144
  s_add_u32 s40, s40, 147456
  v_lshl_add_u32 v2, v166, 5, s40
  ds_read_b128 v[84:87], v2 offset:0
  ds_read_b128 v[88:91], v2 offset:16
  ds_read_b128 v[92:95], v2 offset:80
  ds_read_b128 v[96:99], v2 offset:96
  s_xor_b32 s40, s39, 1
  s_lshl_b32 s41, s32, 1
  s_add_u32 s40, s40, s41
  s_mul_i32 s40, s40, 144
  s_add_u32 s40, s40, 147456
  v_lshl_add_u32 v2, v166, 5, s40
  ds_read_b128 v[100:103], v2 offset:0
  ds_read_b128 v[104:107], v2 offset:16
  ds_read_b128 v[108:111], v2 offset:80
  ds_read_b128 v[112:115], v2 offset:96
  v_mul_u32_u24 v2, 144, v166
  v_add_u32 v2, 147456, v2
  ds_read_b128 v[116:119], v2 offset:64
  ds_read_b128 v[120:123], v2 offset:352
  s_lshl_b32 s40, s31, 8
  s_add_u32 s40, s40, 148480
  v_lshl_add_u32 v2, v167, 3, s40
  ds_read_b64 v[132:133], v2
  s_lshl_b32 s41, s27, 2
  s_add_u32 s48, s31, s41
  s_lshr_b32 s40, s48, 3
  s_mul_i32 s53, s40, 19456
  s_and_b32 s54, s48, 7
  s_lshl_b32 s49, s54, 10
  s_add_u32 s49, s49, s53
  s_mul_i32 s50, s54, 1280
  s_add_u32 s50, s50, s53
  s_add_u32 s50, s50, 9216
  s_lshl_b32 s51, s48, 10
  s_cmp_eq_u32 s29, 0
  s_cselect_b32 s45, 0, 3145728
  s_mov_b32 s46, 155648
  s_cselect_b32 s46, 65536, s46
  s_cselect_b32 s47, s51, s49
  s_cselect_b32 s44, 0x3eae1a93, 1.0
  s_cmp_eq_u32 s29, 2
  s_cselect_b32 s47, s50, s47
  s_cselect_b64 vcc, -1, 0
  s_add_u32 s47, s47, s45
  v_lshlrev_b32 v170, 4, v165
  v_mul_u32_u24 v2, 40, v167
  v_lshl_add_u32 v2, v166, 4, v2
  v_cndmask_b32 v170, v170, v2, vcc
  s_waitcnt lgkmcnt(0)
  v_mfma_f32_32x32x16_bf16 v[4:19], v[60:63], v[52:55], v[4:19]
  ds_read_b128 v[56:59], v137 offset:0
  ds_read_b64_tr_b16 v[72:73], v138 offset:15360
  ds_read_b64_tr_b16 v[74:75], v138 offset:16640
  ds_read_b64_tr_b16 v[76:77], v140 offset:15360
  ds_read_b64_tr_b16 v[78:79], v140 offset:16640
  v_mfma_f32_32x32x16_bf16 v[20:35], v[64:67], v[52:55], v[20:35]
  s_waitcnt lgkmcnt(0)
  v_mfma_f32_32x32x16_bf16 v[4:19], v[72:75], v[56:59], v[4:19]
  v_mfma_f32_32x32x16_bf16 v[20:35], v[76:79], v[56:59], v[20:35]
qkv_kernel_epi:
  s_nop 9
  s_waitcnt lgkmcnt(0)
  v_mov_b32 v168, v132
  v_mul_f32 v169, s44, v133
  v_fma_f32 v4, -v168, v84, v4
  v_fma_f32 v5, -v168, v85, v5
  v_fma_f32 v6, -v168, v86, v6
  v_fma_f32 v7, -v168, v87, v7
  v_fma_f32 v8, -v168, v88, v8
  v_fma_f32 v9, -v168, v89, v9
  v_fma_f32 v10, -v168, v90, v10
  v_fma_f32 v11, -v168, v91, v11
  v_fma_f32 v12, -v168, v92, v12
  v_fma_f32 v13, -v168, v93, v13
  v_fma_f32 v14, -v168, v94, v14
  v_fma_f32 v15, -v168, v95, v15
  v_fma_f32 v16, -v168, v96, v16
  v_fma_f32 v17, -v168, v97, v17
  v_fma_f32 v18, -v168, v98, v18
  v_fma_f32 v19, -v168, v99, v19
  v_mul_f32 v4, v169, v4
  v_mul_f32 v5, v169, v5
  v_mul_f32 v6, v169, v6
  v_mul_f32 v7, v169, v7
  v_mul_f32 v8, v169, v8
  v_mul_f32 v9, v169, v9
  v_mul_f32 v10, v169, v10
  v_mul_f32 v11, v169, v11
  v_mul_f32 v12, v169, v12
  v_mul_f32 v13, v169, v13
  v_mul_f32 v14, v169, v14
  v_mul_f32 v15, v169, v15
  v_mul_f32 v16, v169, v16
  v_mul_f32 v17, v169, v17
  v_mul_f32 v18, v169, v18
  v_mul_f32 v19, v169, v19
  v_cvt_pk_bf16_f32 v124, v4, v5
  v_cvt_pk_bf16_f32 v125, v6, v7
  v_cvt_pk_bf16_f32 v126, v8, v9
  v_cvt_pk_bf16_f32 v127, v10, v11
  v_cvt_pk_bf16_f32 v128, v12, v13
  v_cvt_pk_bf16_f32 v129, v14, v15
  v_cvt_pk_bf16_f32 v130, v16, v17
  v_cvt_pk_bf16_f32 v131, v18, v19
  s_xor_b32 s40, s39, 0
  s_lshl_b32 s41, s32, 1
  s_add_u32 s40, s40, s41
  s_lshl_b32 s41, s30, 2
  s_add_u32 s40, s40, s41
  s_lshl_b32 s40, s40, 1
  s_mul_i32 s40, s40, s46
  s_add_u32 s40, s40, s47
  buffer_store_dwordx4 v[124:127], v170, s[20:23], s40 offen
  s_add_u32 s40, s40, s46
  buffer_store_dwordx4 v[128:131], v170, s[20:23], s40 offen
  v_fma_f32 v20, -v168, v100, v20
  v_fma_f32 v21, -v168, v101, v21
  v_fma_f32 v22, -v168, v102, v22
  v_fma_f32 v23, -v168, v103, v23
  v_fma_f32 v24, -v168, v104, v24
  v_fma_f32 v25, -v168, v105, v25
  v_fma_f32 v26, -v168, v106, v26
  v_fma_f32 v27, -v168, v107, v27
  v_fma_f32 v28, -v168, v108, v28
  v_fma_f32 v29, -v168, v109, v29
  v_fma_f32 v30, -v168, v110, v30
  v_fma_f32 v31, -v168, v111, v31
  v_fma_f32 v32, -v168, v112, v32
  v_fma_f32 v33, -v168, v113, v33
  v_fma_f32 v34, -v168, v114, v34
  v_fma_f32 v35, -v168, v115, v35
  v_mul_f32 v20, v169, v20
  v_mul_f32 v21, v169, v21
  v_mul_f32 v22, v169, v22
  v_mul_f32 v23, v169, v23
  v_mul_f32 v24, v169, v24
  v_mul_f32 v25, v169, v25
  v_mul_f32 v26, v169, v26
  v_mul_f32 v27, v169, v27
  v_mul_f32 v28, v169, v28
  v_mul_f32 v29, v169, v29
  v_mul_f32 v30, v169, v30
  v_mul_f32 v31, v169, v31
  v_mul_f32 v32, v169, v32
  v_mul_f32 v33, v169, v33
  v_mul_f32 v34, v169, v34
  v_mul_f32 v35, v169, v35
  v_cvt_pk_bf16_f32 v84, v20, v21
  v_cvt_pk_bf16_f32 v85, v22, v23
  v_cvt_pk_bf16_f32 v86, v24, v25
  v_cvt_pk_bf16_f32 v87, v26, v27
  v_cvt_pk_bf16_f32 v88, v28, v29
  v_cvt_pk_bf16_f32 v89, v30, v31
  v_cvt_pk_bf16_f32 v90, v32, v33
  v_cvt_pk_bf16_f32 v91, v34, v35
  s_xor_b32 s40, s39, 1
  s_lshl_b32 s41, s32, 1
  s_add_u32 s40, s40, s41
  s_lshl_b32 s41, s30, 2
  s_add_u32 s40, s40, s41
  s_lshl_b32 s40, s40, 1
  s_mul_i32 s40, s40, s46
  s_add_u32 s40, s40, s47
  buffer_store_dwordx4 v[84:87], v170, s[20:23], s40 offen
  s_add_u32 s40, s40, s46
  buffer_store_dwordx4 v[88:91], v170, s[20:23], s40 offen
  s_cmp_eq_u32 s32, 0
  s_cbranch_scc0 qkv_kernel_fin
qkv_kernel_ext:
  v_fma_f32 v36, -v168, v116, v36
  v_fma_f32 v37, -v168, v117, v37
  v_fma_f32 v38, -v168, v118, v38
  v_fma_f32 v39, -v168, v119, v39
  v_fma_f32 v40, -v168, v120, v40
  v_fma_f32 v41, -v168, v121, v41
  v_fma_f32 v42, -v168, v122, v42
  v_fma_f32 v43, -v168, v123, v43
  v_mul_f32 v36, v169, v36
  v_mul_f32 v37, v169, v37
  v_mul_f32 v38, v169, v38
  v_mul_f32 v39, v169, v39
  v_mul_f32 v40, v169, v40
  v_mul_f32 v41, v169, v41
  v_mul_f32 v42, v169, v42
  v_mul_f32 v43, v169, v43
  v_cvt_pk_bf16_f32 v100, v36, v37
  v_cvt_pk_bf16_f32 v101, v38, v39
  v_cvt_pk_bf16_f32 v102, v40, v41
  v_cvt_pk_bf16_f32 v103, v42, v43
  s_cmp_eq_u32 s29, 2
  s_cbranch_scc1 qkv_kernel_extv
  s_lshl_b32 s51, s48, 7
  s_add_u32 s51, s51, 2097152
  s_lshl_b32 s41, s54, 7
  s_add_u32 s40, s53, s41
  s_add_u32 s40, s40, 3153920
  s_cmp_eq_u32 s29, 0
  s_cselect_b32 s51, s51, s40
  s_mov_b32 s52, 155648
  s_cselect_b32 s52, 8192, s52
  s_lshl_b32 s40, s30, 2
  s_add_u32 s40, s40, 0
  v_add_u32 v2, s40, v166
  v_lshlrev_b32 v2, 1, v2
  v_mul_lo_u32 v2, v2, s52
  v_lshl_add_u32 v2, v167, 2, v2
  buffer_store_dword v100, v2, s[20:23], s51 offen
  s_add_u32 s40, s51, s52
  buffer_store_dword v101, v2, s[20:23], s40 offen
  s_lshl_b32 s40, s30, 2
  s_add_u32 s40, s40, 2
  v_add_u32 v2, s40, v166
  v_lshlrev_b32 v2, 1, v2
  v_mul_lo_u32 v2, v2, s52
  v_lshl_add_u32 v2, v167, 2, v2
  buffer_store_dword v102, v2, s[20:23], s51 offen
  s_add_u32 s40, s51, s52
  buffer_store_dword v103, v2, s[20:23], s40 offen
  s_branch qkv_kernel_fin
qkv_kernel_extv:
  s_add_u32 s51, s50, 3145760
  s_mov_b32 s52, 155648
  s_lshl_b32 s40, s30, 2
  s_add_u32 s40, s40, 0
  v_add_u32 v2, s40, v166
  v_lshlrev_b32 v2, 1, v2
  v_mul_lo_u32 v2, v2, s52
  v_mul_u32_u24 v3, 40, v167
  v_add_u32 v2, v2, v3
  v_mov_b32 v104, v100
  v_mov_b32 v105, 0x00003f80
  s_mov_b32 s40, s51
  buffer_store_dwordx2 v[104:105], v2, s[20:23], s40 offen
  v_mov_b32 v106, v101
  v_mov_b32 v107, 0x00003f80
  s_add_u32 s40, s51, s52
  buffer_store_dwordx2 v[106:107], v2, s[20:23], s40 offen
  s_lshl_b32 s40, s30, 2
  s_add_u32 s40, s40, 2
  v_add_u32 v2, s40, v166
  v_lshlrev_b32 v2, 1, v2
  v_mul_lo_u32 v2, v2, s52
  v_mul_u32_u24 v3, 40, v167
  v_add_u32 v2, v2, v3
  v_mov_b32 v108, v102
  v_mov_b32 v109, 0x00003f80
  s_mov_b32 s40, s51
  buffer_store_dwordx2 v[108:109], v2, s[20:23], s40 offen
  v_mov_b32 v110, v103
  v_mov_b32 v111, 0x00003f80
  s_add_u32 s40, s51, s52
  buffer_store_dwordx2 v[110:111], v2, s[20:23], s40 offen
qkv_kernel_fin:
  s_endpgm
qkv_kernel_spare:
  s_load_dwordx4 s[4:7], s[0:1], 0
  s_load_dwordx2 s[8:9], s[0:1], 72
  s_load_dwordx2 s[10:11], s[0:1], 64
  v_lshrrev_b32 v1, 6, v0
  v_and_b32 v165, 63, v0
  v_readfirstlane_b32 s24, v1
  s_waitcnt lgkmcnt(0)
  s_mov_b32 s12, s4
  s_mov_b32 s13, s5
  s_mov_b32 s14, 2359296
  s_mov_b32 s15, 0x00020000
  s_mov_b32 s16, s6
  s_mov_b32 s17, s7
  s_mov_b32 s18, 1990656
  s_mov_b32 s19, 0x00020000
  s_add_u32 s52, s8, 8454144
  s_addc_u32 s53, s9, 0
  s_mov_b32 s54, 16384
  s_mov_b32 s55, 0x00020000
  s_mov_b32 s56, s10
  s_mov_b32 s57, s11
  s_mov_b32 s58, 256
  s_mov_b32 s59, 0x00020000
  s_add_u32 s60, s8, 8519680
  s_addc_u32 s61, s9, 0
  s_mov_b32 s62, 6912
  s_mov_b32 s63, 0x00020000
  s_lshl_b32 s25, s2, 3
  s_add_u32 s25, s25, s24
  s_lshl_b32 s25, s25, 2
  s_mul_i32 s26, s25, 1152
  v_lshrrev_b32 v1, 4, v165
  v_and_b32 v2, 15, v165
  v_mul_u32_u24 v3, 1152, v1
  v_lshl_add_u32 v3, v2, 4, v3
  buffer_load_dwordx4 v[4:7], v3, s[12:15], s26 offen offset:0
  buffer_load_dwordx4 v[8:11], v3, s[12:15], s26 offen offset:256
  buffer_load_dwordx4 v[12:15], v3, s[12:15], s26 offen offset:512
  buffer_load_dwordx4 v[16:19], v3, s[12:15], s26 offen offset:768
  v_cmp_gt_u32 vcc, 8, v2
  v_add_u32 v162, 1024, v3
  v_mov_b32 v163, 0x7ff00000
  v_cndmask_b32 v162, v163, v162, vcc
  buffer_load_dwordx4 v[20:23], v162, s[12:15], s26 offen
  s_cmp_ge_u32 s2, 27
  s_cbranch_scc1 qkv_kernel_nocsld
  s_mul_i32 s27, s24, 72*3456
  s_lshl_b32 s28, s2, 7
  s_add_u32 s27, s27, s28
  v_lshrrev_b32 v162, 3, v165
  v_mul_u32_u24 v162, 3456, v162
  v_and_b32 v163, 7, v165
  v_lshl_add_u32 v162, v163, 4, v162
  buffer_load_dwordx4 v[84:87], v162, s[16:19], s27 offen
  s_add_u32 s27, s27, 8*3456
  buffer_load_dwordx4 v[88:91], v162, s[16:19], s27 offen
  s_add_u32 s27, s27, 8*3456
  buffer_load_dwordx4 v[92:95], v162, s[16:19], s27 offen
  s_add_u32 s27, s27, 8*3456
  buffer_load_dwordx4 v[96:99], v162, s[16:19], s27 offen
  s_add_u32 s27, s27, 8*3456
  buffer_load_dwordx4 v[100:103], v162, s[16:19], s27 offen
  s_add_u32 s27, s27, 8*3456
  buffer_load_dwordx4 v[104:107], v162, s[16:19], s27 offen
  s_add_u32 s27, s27, 8*3456
  buffer_load_dwordx4 v[108:111], v162, s[16:19], s27 offen
  s_add_u32 s27, s27, 8*3456
  buffer_load_dwordx4 v[112:115], v162, s[16:19], s27 offen
  s_add_u32 s27, s27, 8*3456
  buffer_load_dwordx4 v[116:119], v162, s[16:19], s27 offen
  s_branch qkv_kernel_ldrest
qkv_kernel_nocsld:
  s_load_dwordx2 s[14:15], s[0:1], 16
  s_sub_u32 s86, s2, 27
  s_lshl_b32 s86, s86, 3
  s_add_u32 s86, s86, s24
  s_add_u32 s87, s86, 296
  s_lshr_b32 s80, s86, 4
  s_and_b32 s81, s86, 15
  s_mul_i32 s82, s80, 18
  s_and_b32 s83, s80, 1
  s_lshl_b32 s83, s83, 1
  s_add_u32 s82, s82, s83
  s_add_u32 s82, s82, s81
  s_sub_u32 s84, s80, 32
  s_lshl_b32 s84, s84, 3
  s_bfe_u32 s85, s81, 0x10002
  s_lshl_b32 s85, s85, 2
  s_add_u32 s84, s84, s85
  s_lshr_b32 s85, s81, 3
  s_lshl_b32 s85, s85, 1
  s_add_u32 s84, s84, s85
  s_mul_i32 s84, s84, 18
  s_and_b32 s85, s81, 3
  s_add_u32 s84, s84, s85
  s_add_u32 s84, s84, 16
  s_cmp_lt_u32 s80, 32
  s_cselect_b32 s82, s82, s84
  s_mul_i32 s88, s82, 1152
  s_lshr_b32 s80, s87, 4
  s_and_b32 s81, s87, 15
  s_mul_i32 s82, s80, 18
  s_and_b32 s83, s80, 1
  s_lshl_b32 s83, s83, 1
  s_add_u32 s82, s82, s83
  s_add_u32 s82, s82, s81
  s_sub_u32 s84, s80, 32
  s_lshl_b32 s84, s84, 3
  s_bfe_u32 s85, s81, 0x10002
  s_lshl_b32 s85, s85, 2
  s_add_u32 s84, s84, s85
  s_lshr_b32 s85, s81, 3
  s_lshl_b32 s85, s85, 1
  s_add_u32 s84, s84, s85
  s_mul_i32 s84, s84, 18
  s_and_b32 s85, s81, 3
  s_add_u32 s84, s84, s85
  s_add_u32 s84, s84, 16
  s_cmp_lt_u32 s80, 32
  s_cselect_b32 s82, s82, s84
  s_mul_i32 s89, s82, 1152
  s_cmp_lt_u32 s87, 576
  s_cselect_b32 s89, s89, 0x7f000000
  v_lshrrev_b32 v162, 2, v165
  v_and_b32 v163, 3, v165
  v_mul_u32_u24 v162, 72, v162
  v_lshl_add_u32 v163, v163, 4, v162
  s_waitcnt lgkmcnt(0)
  s_mov_b32 s92, s14
  s_mov_b32 s93, s15
  s_mov_b32 s94, 663552
  s_mov_b32 s95, 0x00020000
  buffer_load_dwordx4 v[176:179], v163, s[92:95], s88 offen
  buffer_load_dwordx2 v[180:181], v162, s[92:95], s88 offen offset:64
  buffer_load_dwordx4 v[184:187], v163, s[92:95], s89 offen
  buffer_load_dwordx2 v[188:189], v162, s[92:95], s89 offen offset:64
qkv_kernel_ldrest:
  v_lshrrev_b32 v1, 4, v165
  v_mov_b32 v36, 0
  v_mov_b32 v37, 0
  v_mov_b32 v38, 0x3f803f80
  s_waitcnt vmcnt(0)
  v_dot2c_f32_bf16 v36, v4, v38
  v_dot2c_f32_bf16 v37, v4, v4
  v_dot2c_f32_bf16 v36, v5, v38
  v_dot2c_f32_bf16 v37, v5, v5
  v_dot2c_f32_bf16 v36, v6, v38
  v_dot2c_f32_bf16 v37, v6, v6
  v_dot2c_f32_bf16 v36, v7, v38
  v_dot2c_f32_bf16 v37, v7, v7
  v_dot2c_f32_bf16 v36, v8, v38
  v_dot2c_f32_bf16 v37, v8, v8
  v_dot2c_f32_bf16 v36, v9, v38
  v_dot2c_f32_bf16 v37, v9, v9
  v_dot2c_f32_bf16 v36, v10, v38
  v_dot2c_f32_bf16 v37, v10, v10
  v_dot2c_f32_bf16 v36, v11, v38
  v_dot2c_f32_bf16 v37, v11, v11
  v_dot2c_f32_bf16 v36, v12, v38
  v_dot2c_f32_bf16 v37, v12, v12
  v_dot2c_f32_bf16 v36, v13, v38
  v_dot2c_f32_bf16 v37, v13, v13
  v_dot2c_f32_bf16 v36, v14, v38
  v_dot2c_f32_bf16 v37, v14, v14
  v_dot2c_f32_bf16 v36, v15, v38
  v_dot2c_f32_bf16 v37, v15, v15
  v_dot2c_f32_bf16 v36, v16, v38
  v_dot2c_f32_bf16 v37, v16, v16
  v_dot2c_f32_bf16 v36, v17, v38
  v_dot2c_f32_bf16 v37, v17, v17
  v_dot2c_f32_bf16 v36, v18, v38
  v_dot2c_f32_bf16 v37, v18, v18
  v_dot2c_f32_bf16 v36, v19, v38
  v_dot2c_f32_bf16 v37, v19, v19
  v_dot2c_f32_bf16 v36, v20, v38
  v_dot2c_f32_bf16 v37, v20, v20
  v_dot2c_f32_bf16 v36, v21, v38
  v_dot2c_f32_bf16 v37, v21, v21
  v_dot2c_f32_bf16 v36, v22, v38
  v_dot2c_f32_bf16 v37, v22, v22
  v_dot2c_f32_bf16 v36, v23, v38
  v_dot2c_f32_bf16 v37, v23, v23
  s_nop 2
  s_nop 1
  v_add_f32_dpp v36, v36, v36 quad_perm:[1,0,3,2] row_mask:0xf bank_mask:0xf
  s_nop 1
  v_add_f32_dpp v36, v36, v36 quad_perm:[2,3,0,1] row_mask:0xf bank_mask:0xf
  s_nop 1
  v_add_f32_dpp v36, v36, v36 row_half_mirror row_mask:0xf bank_mask:0xf
  s_nop 1
  v_add_f32_dpp v36, v36, v36 row_mirror row_mask:0xf bank_mask:0xf
  s_nop 1
  v_add_f32_dpp v37, v37, v37 quad_perm:[1,0,3,2] row_mask:0xf bank_mask:0xf
  s_nop 1
  v_add_f32_dpp v37, v37, v37 quad_perm:[2,3,0,1] row_mask:0xf bank_mask:0xf
  s_nop 1
  v_add_f32_dpp v37, v37, v37 row_half_mirror row_mask:0xf bank_mask:0xf
  s_nop 1
  v_add_f32_dpp v37, v37, v37 row_mirror row_mask:0xf bank_mask:0xf
  v_mul_f32 v36, 0x3ae38e39, v36
  v_mul_f32 v37, 0x3ae38e39, v37
  v_fma_f32 v37, -v36, v36, v37
  v_max_f32 v37, 0, v37
  v_add_f32 v37, 0x3727c5ac, v37
  v_rsq_f32 v37, v37
  v_lshlrev_b32 v3, 3, v1
  s_lshl_b32 s26, s25, 3
  buffer_store_dwordx2 v[36:37], v3, s[52:55], s26 offen sc1
  s_cmp_ge_u32 s2, 27
  s_cbranch_scc1 qkv_kernel_signal
  v_mov_b32 v4, 0
  v_mov_b32 v5, 0
  v_mov_b32 v6, 0
  v_mov_b32 v7, 0
  v_mov_b32 v8, 0
  v_mov_b32 v9, 0
  v_mov_b32 v10, 0
  v_mov_b32 v11, 0
  v_lshlrev_b32 v3, 16, v84
  v_and_b32 v162, 0xffff0000, v84
  v_add_f32 v4, v4, v3
  v_add_f32 v5, v5, v162
  v_lshlrev_b32 v3, 16, v85
  v_and_b32 v162, 0xffff0000, v85
  v_add_f32 v6, v6, v3
  v_add_f32 v7, v7, v162
  v_lshlrev_b32 v3, 16, v86
  v_and_b32 v162, 0xffff0000, v86
  v_add_f32 v8, v8, v3
  v_add_f32 v9, v9, v162
  v_lshlrev_b32 v3, 16, v87
  v_and_b32 v162, 0xffff0000, v87
  v_add_f32 v10, v10, v3
  v_add_f32 v11, v11, v162
  v_lshlrev_b32 v3, 16, v88
  v_and_b32 v162, 0xffff0000, v88
  v_add_f32 v4, v4, v3
  v_add_f32 v5, v5, v162
  v_lshlrev_b32 v3, 16, v89
  v_and_b32 v162, 0xffff0000, v89
  v_add_f32 v6, v6, v3
  v_add_f32 v7, v7, v162
  v_lshlrev_b32 v3, 16, v90
  v_and_b32 v162, 0xffff0000, v90
  v_add_f32 v8, v8, v3
  v_add_f32 v9, v9, v162
  v_lshlrev_b32 v3, 16, v91
  v_and_b32 v162, 0xffff0000, v91
  v_add_f32 v10, v10, v3
  v_add_f32 v11, v11, v162
  v_lshlrev_b32 v3, 16, v92
  v_and_b32 v162, 0xffff0000, v92
  v_add_f32 v4, v4, v3
  v_add_f32 v5, v5, v162
  v_lshlrev_b32 v3, 16, v93
  v_and_b32 v162, 0xffff0000, v93
  v_add_f32 v6, v6, v3
  v_add_f32 v7, v7, v162
  v_lshlrev_b32 v3, 16, v94
  v_and_b32 v162, 0xffff0000, v94
  v_add_f32 v8, v8, v3
  v_add_f32 v9, v9, v162
  v_lshlrev_b32 v3, 16, v95
  v_and_b32 v162, 0xffff0000, v95
  v_add_f32 v10, v10, v3
  v_add_f32 v11, v11, v162
  v_lshlrev_b32 v3, 16, v96
  v_and_b32 v162, 0xffff0000, v96
  v_add_f32 v4, v4, v3
  v_add_f32 v5, v5, v162
  v_lshlrev_b32 v3, 16, v97
  v_and_b32 v162, 0xffff0000, v97
  v_add_f32 v6, v6, v3
  v_add_f32 v7, v7, v162
  v_lshlrev_b32 v3, 16, v98
  v_and_b32 v162, 0xffff0000, v98
  v_add_f32 v8, v8, v3
  v_add_f32 v9, v9, v162
  v_lshlrev_b32 v3, 16, v99
  v_and_b32 v162, 0xffff0000, v99
  v_add_f32 v10, v10, v3
  v_add_f32 v11, v11, v162
  v_lshlrev_b32 v3, 16, v100
  v_and_b32 v162, 0xffff0000, v100
  v_add_f32 v4, v4, v3
  v_add_f32 v5, v5, v162
  v_lshlrev_b32 v3, 16, v101
  v_and_b32 v162, 0xffff0000, v101
  v_add_f32 v6, v6, v3
  v_add_f32 v7, v7, v162
  v_lshlrev_b32 v3, 16, v102
  v_and_b32 v162, 0xffff0000, v102
  v_add_f32 v8, v8, v3
  v_add_f32 v9, v9, v162
  v_lshlrev_b32 v3, 16, v103
  v_and_b32 v162, 0xffff0000, v103
  v_add_f32 v10, v10, v3
  v_add_f32 v11, v11, v162
  v_lshlrev_b32 v3, 16, v104
  v_and_b32 v162, 0xffff0000, v104
  v_add_f32 v4, v4, v3
  v_add_f32 v5, v5, v162
  v_lshlrev_b32 v3, 16, v105
  v_and_b32 v162, 0xffff0000, v105
  v_add_f32 v6, v6, v3
  v_add_f32 v7, v7, v162
  v_lshlrev_b32 v3, 16, v106
  v_and_b32 v162, 0xffff0000, v106
  v_add_f32 v8, v8, v3
  v_add_f32 v9, v9, v162
  v_lshlrev_b32 v3, 16, v107
  v_and_b32 v162, 0xffff0000, v107
  v_add_f32 v10, v10, v3
  v_add_f32 v11, v11, v162
  v_lshlrev_b32 v3, 16, v108
  v_and_b32 v162, 0xffff0000, v108
  v_add_f32 v4, v4, v3
  v_add_f32 v5, v5, v162
  v_lshlrev_b32 v3, 16, v109
  v_and_b32 v162, 0xffff0000, v109
  v_add_f32 v6, v6, v3
  v_add_f32 v7, v7, v162
  v_lshlrev_b32 v3, 16, v110
  v_and_b32 v162, 0xffff0000, v110
  v_add_f32 v8, v8, v3
  v_add_f32 v9, v9, v162
  v_lshlrev_b32 v3, 16, v111
  v_and_b32 v162, 0xffff0000, v111
  v_add_f32 v10, v10, v3
  v_add_f32 v11, v11, v162
  v_lshlrev_b32 v3, 16, v112
  v_and_b32 v162, 0xffff0000, v112
  v_add_f32 v4, v4, v3
  v_add_f32 v5, v5, v162
  v_lshlrev_b32 v3, 16, v113
  v_and_b32 v162, 0xffff0000, v113
  v_add_f32 v6, v6, v3
  v_add_f32 v7, v7, v162
  v_lshlrev_b32 v3, 16, v114
  v_and_b32 v162, 0xffff0000, v114
  v_add_f32 v8, v8, v3
  v_add_f32 v9, v9, v162
  v_lshlrev_b32 v3, 16, v115
  v_and_b32 v162, 0xffff0000, v115
  v_add_f32 v10, v10, v3
  v_add_f32 v11, v11, v162
  v_lshlrev_b32 v3, 16, v116
  v_and_b32 v162, 0xffff0000, v116
  v_add_f32 v4, v4, v3
  v_add_f32 v5, v5, v162
  v_lshlrev_b32 v3, 16, v117
  v_and_b32 v162, 0xffff0000, v117
  v_add_f32 v6, v6, v3
  v_add_f32 v7, v7, v162
  v_lshlrev_b32 v3, 16, v118
  v_and_b32 v162, 0xffff0000, v118
  v_add_f32 v8, v8, v3
  v_add_f32 v9, v9, v162
  v_lshlrev_b32 v3, 16, v119
  v_and_b32 v162, 0xffff0000, v119
  v_add_f32 v10, v10, v3
  v_add_f32 v11, v11, v162
  s_nop 1
  v_add_f32_dpp v4, v4, v4 row_ror:8 row_mask:0xf bank_mask:0xf
  s_nop 1
  v_add_f32_dpp v5, v5, v5 row_ror:8 row_mask:0xf bank_mask:0xf
  s_nop 1
  v_add_f32_dpp v6, v6, v6 row_ror:8 row_mask:0xf bank_mask:0xf
  s_nop 1
  v_add_f32_dpp v7, v7, v7 row_ror:8 row_mask:0xf bank_mask:0xf
  s_nop 1
  v_add_f32_dpp v8, v8, v8 row_ror:8 row_mask:0xf bank_mask:0xf
  s_nop 1
  v_add_f32_dpp v9, v9, v9 row_ror:8 row_mask:0xf bank_mask:0xf
  s_nop 1
  v_add_f32_dpp v10, v10, v10 row_ror:8 row_mask:0xf bank_mask:0xf
  s_nop 1
  v_add_f32_dpp v11, v11, v11 row_ror:8 row_mask:0xf bank_mask:0xf
  v_mov_b32 v3, v4
  s_nop 1
  v_permlane16_swap_b32 v3, v4
  v_add_f32 v4, v4, v3
  v_mov_b32 v3, v5
  s_nop 1
  v_permlane16_swap_b32 v3, v5
  v_add_f32 v5, v5, v3
  v_mov_b32 v3, v6
  s_nop 1
  v_permlane16_swap_b32 v3, v6
  v_add_f32 v6, v6, v3
  v_mov_b32 v3, v7
  s_nop 1
  v_permlane16_swap_b32 v3, v7
  v_add_f32 v7, v7, v3
  v_mov_b32 v3, v8
  s_nop 1
  v_permlane16_swap_b32 v3, v8
  v_add_f32 v8, v8, v3
  v_mov_b32 v3, v9
  s_nop 1
  v_permlane16_swap_b32 v3, v9
  v_add_f32 v9, v9, v3
  v_mov_b32 v3, v10
  s_nop 1
  v_permlane16_swap_b32 v3, v10
  v_add_f32 v10, v10, v3
  v_mov_b32 v3, v11
  s_nop 1
  v_permlane16_swap_b32 v3, v11
  v_add_f32 v11, v11, v3
  v_mov_b32 v3, v4
  s_nop 1
  v_permlane32_swap_b32 v3, v4
  v_add_f32 v4, v4, v3
  v_mov_b32 v3, v5
  s_nop 1
  v_permlane32_swap_b32 v3, v5
  v_add_f32 v5, v5, v3
  v_mov_b32 v3, v6
  s_nop 1
  v_permlane32_swap_b32 v3, v6
  v_add_f32 v6, v6, v3
  v_mov_b32 v3, v7
  s_nop 1
  v_permlane32_swap_b32 v3, v7
  v_add_f32 v7, v7, v3
  v_mov_b32 v3, v8
  s_nop 1
  v_permlane32_swap_b32 v3, v8
  v_add_f32 v8, v8, v3
  v_mov_b32 v3, v9
  s_nop 1
  v_permlane32_swap_b32 v3, v9
  v_add_f32 v9, v9, v3
  v_mov_b32 v3, v10
  s_nop 1
  v_permlane32_swap_b32 v3, v10
  v_add_f32 v10, v10, v3
  v_mov_b32 v3, v11
  s_nop 1
  v_permlane32_swap_b32 v3, v11
  v_add_f32 v11, v11, v3
  v_and_b32 v3, 7, v165
  v_lshlrev_b32 v3, 5, v3
  s_lshl_b32 s27, s24, 8
  v_add_u32 v3, s27, v3
  ds_write_b128 v3, v[4:7]
  ds_write_b128 v3, v[8:11] offset:16
  s_waitcnt lgkmcnt(0)
  s_barrier
  v_lshlrev_b32 v3, 2, v165
  ds_read_b32 v12, v3 offset:0
  ds_read_b32 v13, v3 offset:256
  ds_read_b32 v14, v3 offset:512
  ds_read_b32 v15, v3 offset:768
  ds_read_b32 v16, v3 offset:1024
  ds_read_b32 v17, v3 offset:1280
  ds_read_b32 v18, v3 offset:1536
  ds_read_b32 v19, v3 offset:1792
  s_waitcnt lgkmcnt(0)
  v_add_f32 v12, v12, v13
  v_add_f32 v12, v12, v14
  v_add_f32 v12, v12, v15
  v_add_f32 v12, v12, v16
  v_add_f32 v12, v12, v17
  v_add_f32 v12, v12, v18
  v_add_f32 v12, v12, v19
  s_lshl_b32 s27, s2, 8
  buffer_store_dword v12, v3, s[60:63], s27 offen sc1
qkv_kernel_signal:
  s_waitcnt vmcnt(0)
  s_barrier
  s_cmp_lg_u32 s24, 0
  s_cbranch_scc1 qkv_kernel_jobc
  v_mov_b32 v3, 1
  v_mov_b32 v162, 0
  s_mov_b64 exec, 1
  buffer_atomic_add v3, v162, s[56:59], 0 offen sc1
  s_mov_b64 exec, -1
qkv_kernel_jobc:
  s_cmp_lt_u32 s2, 27
  s_cbranch_scc1 qkv_kernel_end
  s_add_u32 s32, s8, 9437184
  s_addc_u32 s33, s9, 0
  s_mov_b32 s34, 737280
  s_mov_b32 s35, 0x00020000
  v_lshrrev_b32 v162, 2, v165
  v_and_b32 v163, 3, v165
  s_mov_b32 s46, 46080
  v_mul_lo_u32 v162, v162, s46
  v_lshl_add_u32 v163, v163, 4, v162
  v_mov_b32 v192, 0x3f803f80
  v_mov_b32 v193, 0
  v_mov_b32 v194, 0
  v_dot2_f32_bf16 v193, v176, v192, v193
  v_dot2_f32_bf16 v193, v177, v192, v193
  v_dot2_f32_bf16 v193, v178, v192, v193
  v_dot2_f32_bf16 v193, v179, v192, v193
  v_dot2_f32_bf16 v194, v180, v192, v194
  v_dot2_f32_bf16 v194, v181, v192, v194
  s_nop 2
  v_mul_f32 v194, 0.5, v194
  v_mul_f32 v194, 0.5, v194
  v_add_f32 v193, v193, v194
  s_nop 1
  v_add_f32_dpp v193, v193, v193 quad_perm:[1,0,3,2] row_mask:0xf bank_mask:0xf
  s_nop 1
  v_add_f32_dpp v193, v193, v193 quad_perm:[2,3,0,1] row_mask:0xf bank_mask:0xf
  s_nop 1
  v_add_f32_dpp v193, v193, v193 row_half_mirror row_mask:0xf bank_mask:0xf
  s_nop 1
  v_add_f32_dpp v193, v193, v193 row_mirror row_mask:0xf bank_mask:0xf
  v_mov_b32 v195, v193
  s_nop 1
  v_permlane16_swap_b32 v195, v193
  v_add_f32 v193, v193, v195
  v_mov_b32 v195, v193
  s_nop 1
  v_permlane32_swap_b32 v195, v193
  v_add_f32 v193, v193, v195
  v_mul_f32 v193, 0x3ae38e39, v193
  v_cvt_pk_bf16_f32 v182, v193, v193
  v_lshlrev_b32 v195, 16, v182
  v_sub_f32 v195, v193, v195
  v_cvt_pk_bf16_f32 v182, v193, v195
  v_mov_b32 v183, 0
  s_lshl_b32 s47, s86, 6
  buffer_store_dwordx4 v[176:179], v163, s[32:35], s47 offen sc1
  s_lshl_b32 s47, s86, 4
  s_add_u32 s47, s47, 36864
  buffer_store_dwordx4 v[180:183], v162, s[32:35], s47 offen sc1
  s_cmp_ge_u32 s87, 576
  s_cbranch_scc1 qkv_kernel_end
  v_mov_b32 v192, 0x3f803f80
  v_mov_b32 v193, 0
  v_mov_b32 v194, 0
  v_dot2_f32_bf16 v193, v184, v192, v193
  v_dot2_f32_bf16 v193, v185, v192, v193
  v_dot2_f32_bf16 v193, v186, v192, v193
  v_dot2_f32_bf16 v193, v187, v192, v193
  v_dot2_f32_bf16 v194, v188, v192, v194
  v_dot2_f32_bf16 v194, v189, v192, v194
  s_nop 2
  v_mul_f32 v194, 0.5, v194
  v_mul_f32 v194, 0.5, v194
  v_add_f32 v193, v193, v194
  s_nop 1
  v_add_f32_dpp v193, v193, v193 quad_perm:[1,0,3,2] row_mask:0xf bank_mask:0xf
  s_nop 1
  v_add_f32_dpp v193, v193, v193 quad_perm:[2,3,0,1] row_mask:0xf bank_mask:0xf
  s_nop 1
  v_add_f32_dpp v193, v193, v193 row_half_mirror row_mask:0xf bank_mask:0xf
  s_nop 1
  v_add_f32_dpp v193, v193, v193 row_mirror row_mask:0xf bank_mask:0xf
  v_mov_b32 v195, v193
  s_nop 1
  v_permlane16_swap_b32 v195, v193
  v_add_f32 v193, v193, v195
  v_mov_b32 v195, v193
  s_nop 1
  v_permlane32_swap_b32 v195, v193
  v_add_f32 v193, v193, v195
  v_mul_f32 v193, 0x3ae38e39, v193
  v_cvt_pk_bf16_f32 v190, v193, v193
  v_lshlrev_b32 v195, 16, v190
  v_sub_f32 v195, v193, v195
  v_cvt_pk_bf16_f32 v190, v193, v195
  v_mov_b32 v191, 0
  s_lshl_b32 s47, s87, 6
  buffer_store_dwordx4 v[184:187], v163, s[32:35], s47 offen sc1
  s_lshl_b32 s47, s87, 4
  s_add_u32 s47, s47, 36864
  buffer_store_dwordx4 v[188:191], v162, s[32:35], s47 offen sc1
qkv_kernel_end:
  s_endpgm
.section .rodata,"a"
.p2align 6
.amdhsa_kernel qkv_kernel
.amdhsa_next_free_vgpr 196
.amdhsa_next_free_sgpr 100
.amdhsa_accum_offset 196
.amdhsa_group_segment_fixed_size 0
.amdhsa_kernarg_size 80
.amdhsa_user_sgpr_count 2
.amdhsa_user_sgpr_kernarg_segment_ptr 1
.amdhsa_system_sgpr_workgroup_id_x 1
.amdhsa_float_denorm_mode_32 3
.amdhsa_ieee_mode 0
.end_amdhsa_kernel
.text
.globl attn_kernel
.p2align 8
.type attn_kernel,@function
attn_kernel:
  s_cmp_ge_u32 s2, 256
  s_cbranch_scc1 attn_kernel_end
  s_getpc_b64 s[94:95]
attn_kernel_pc:
  s_sub_u32 s94, s94, attn_kernel_pc-code_begin
  s_subb_u32 s95, s95, 0
  v_lshlrev_b32 v189, 7, v0
  v_min_u32 v189, code_end-code_begin-4, v189
  global_load_dword v237, v189, s[94:95]
  s_load_dwordx2 s[8:9], s[0:1], 72
  s_load_dwordx4 s[44:47], s[0:1], 32
  s_load_dwordx2 s[48:49], s[0:1], 48
  v_lshrrev_b32 v189, 6, v0
  v_and_b32 v186, 63, v0
  v_readfirstlane_b32 s24, v189
  s_and_b32 s25, s2, 7
  s_lshl_b32 s25, s25, 2
  s_bfe_u32 s26, s2, 0x20003
  s_add_u32 s25, s25, s26
  s_lshr_b32 s26, s2, 5
  s_lshl_b32 s26, s26, 3
  s_and_b32 s36, s24, 3
  s_lshl_b32 s36, s36, 1
  s_add_u32 s26, s26, s36
  s_lshr_b32 s37, s24, 2
  v_and_b32 v188, 31, v186
  v_lshlrev_b32 v182, 4, v186
  v_lshlrev_b32 v185, 4, v186
  v_lshlrev_b32 v190, 2, v188
  s_mul_i32 s29, s25, 155648
  s_lshl_b32 s30, s24, 10
  s_add_u32 s29, s29, s30
  s_add_u32 s29, s29, 3145728
  s_lshl_b32 s27, s25, 6
  s_add_u32 s27, s27, s26
  s_waitcnt lgkmcnt(0)
  s_mov_b32 s12, s8
  s_mov_b32 s13, s9
  s_mov_b32 s14, 8388608
  s_mov_b32 s15, 0x00020000
  s_cmp_lt_u32 s24, 4
  s_mov_b32 s33, 73728
  s_cselect_b32 s33, 0, s33
  s_add_u32 m0, s30, s33
  s_add_u32 s31, s29, s33
  buffer_load_dwordx4 v185, s[12:15], s31 offen lds
  s_cmp_lt_u32 s24, 4
  s_mov_b32 s33, 81920
  s_cselect_b32 s33, 8192, s33
  s_add_u32 m0, s30, s33
  s_add_u32 s31, s29, s33
  buffer_load_dwordx4 v185, s[12:15], s31 offen lds
  s_lshl_b32 s28, s27, 10
  buffer_load_dwordx4 v[4:7], v182, s[12:15], s28 offen offset:0
  s_lshl_b32 s28, s27, 7
  s_add_u32 s28, s28, 2097152
  buffer_load_dword v12, v190, s[12:15], s28 offen offset:0
  s_lshl_b32 s28, s27, 10
  buffer_load_dwordx4 v[8:11], v182, s[12:15], s28 offen offset:1024
  s_lshl_b32 s28, s27, 7
  s_add_u32 s28, s28, 2097152
  buffer_load_dword v16, v190, s[12:15], s28 offen offset:128
  s_add_u32 s16, s8, 10485760
  s_addc_u32 s17, s9, 0
  s_mov_b32 s18, 2359296
  s_mov_b32 s19, 0x00020000
  v_lshrrev_b32 v187, 5, v186
  v_add_u32 v183, 8192, v190
  v_bfe_u32 v189, v186, 2, 2
  v_lshl_add_u32 v189, v187, 2, v189
  v_mul_u32_u24 v189, 40, v189
  v_and_b32 v190, 3, v186
  v_lshlrev_b32 v190, 3, v190
  v_bfe_u32 v191, v186, 4, 1
  v_cmp_eq_u32 vcc, 1, v191
  v_mov_b32 v192, 32
  s_nop 0
  v_cndmask_b32 v190, v190, v192, vcc
  v_add_u32 v184, v189, v190
  v_add_u32 v184, 9216, v184
  s_mul_i32 s38, s37, 77824
  v_add_u32 v182, s38, v182
  v_add_u32 v183, s38, v183
  v_add_u32 v184, s38, v184
  v_mov_b32 v29, 0x00003f80
  v_mov_b32 v30, 0
  v_mov_b32 v31, 0
  v_mov_b32 v33, 0x00003f80
  v_mov_b32 v34, 0
  v_mov_b32 v35, 0
  v_mov_b32 v13, 0
  v_mov_b32 v14, 0
  v_mov_b32 v15, 0
  v_mov_b32 v148, 0
  v_mov_b32 v149, 0
  v_mov_b32 v150, 0
  v_mov_b32 v151, 0
  v_mov_b32 v152, 0
  v_mov_b32 v153, 0
  v_mov_b32 v154, 0
  v_mov_b32 v155, 0
  v_mov_b32 v156, 0
  v_mov_b32 v157, 0
  v_mov_b32 v158, 0
  v_mov_b32 v159, 0
  v_mov_b32 v160, 0
  v_mov_b32 v161, 0
  v_mov_b32 v162, 0
  v_mov_b32 v163, 0
  v_mov_b32 v124, 0
  v_mov_b32 v125, 0
  v_mov_b32 v126, 0
  v_mov_b32 v127, 0
  v_mov_b32 v128, 0
  v_mov_b32 v129, 0
  v_mov_b32 v130, 0
  v_mov_b32 v131, 0
  v_mov_b32 v17, 0
  v_mov_b32 v18, 0
  v_mov_b32 v19, 0
  v_mov_b32 v164, 0
  v_mov_b32 v165, 0
  v_mov_b32 v166, 0
  v_mov_b32 v167, 0
  v_mov_b32 v168, 0
  v_mov_b32 v169, 0
  v_mov_b32 v170, 0
  v_mov_b32 v171, 0
  v_mov_b32 v172, 0
  v_mov_b32 v173, 0
  v_mov_b32 v174, 0
  v_mov_b32 v175, 0
  v_mov_b32 v176, 0
  v_mov_b32 v177, 0
  v_mov_b32 v178, 0
  v_mov_b32 v179, 0
  v_mov_b32 v140, 0
  v_mov_b32 v141, 0
  v_mov_b32 v142, 0
  v_mov_b32 v143, 0
  v_mov_b32 v144, 0
  v_mov_b32 v145, 0
  v_mov_b32 v146, 0
  v_mov_b32 v147, 0
  v_mov_b32 v44, 0
  v_mov_b32 v45, 0
  v_mov_b32 v46, 0
  v_mov_b32 v47, 0
  v_mov_b32 v48, 0
  v_mov_b32 v49, 0
  v_mov_b32 v50, 0
  v_mov_b32 v51, 0
  v_cmp_gt_u32 s[34:35], 32, v186
  s_add_u32 s52, s8, 20971520
  s_addc_u32 s53, s9, 0
  s_mov_b32 s54, 10616832
  s_mov_b32 s55, 0x00020000
  s_add_u32 s56, s8, 33554432
  s_addc_u32 s57, s9, 0
  s_mov_b32 s58, 5308416
  s_mov_b32 s59, 0x00020000
  s_mov_b32 s60, s48
  s_mov_b32 s61, s49
  s_mov_b32 s62, 5308416
  s_mov_b32 s63, 0x00020000
  s_lshl_b32 s40, s2, 3
  s_add_u32 s40, s40, s24
  s_lshr_b32 s41, s40, 2
  s_mul_i32 s42, s41, 1821
  s_lshr_b32 s42, s42, 16
  s_mul_i32 s43, s42, 36
  s_sub_u32 s43, s41, s43
  s_lshl_b32 s42, s42, 2
  s_and_b32 s50, s40, 3
  s_add_u32 s42, s42, s50
  s_mul_i32 s50, s43, 147456
  s_lshl_b32 s51, s42, 5
  s_add_u32 s72, s50, s51
  s_mul_i32 s50, s42, 36864
  s_lshl_b32 s51, s43, 10
  s_add_u32 s73, s50, s51
  v_lshrrev_b32 v189, 2, v186
  v_and_b32 v190, 3, v186
  s_mov_b32 s50, 9216
  v_mul_lo_u32 v191, v189, s50
  v_and_b32 v192, 1, v190
  v_lshl_add_u32 v191, v192, 4, v191
  v_cmp_gt_u32 vcc, 2, v190
  v_mov_b32 v228, s46
  v_mov_b32 v192, s44
  v_cndmask_b32 v228, v228, v192, vcc
  v_mov_b32 v229, s47
  v_mov_b32 v192, s45
  v_cndmask_b32 v229, v229, v192, vcc
  v_add_u32 v191, s72, v191
  v_add_co_u32 v228, vcc, v228, v191
  s_nop 1
  v_addc_co_u32 v229, vcc, 0, v229, vcc
  s_and_b32 s50, s40, 3
  s_bfe_u32 s51, s40, 0x20002
  s_lshr_b32 s74, s40, 4
  s_mul_i32 s75, s74, 18432
  s_mul_i32 s43, s51, 288
  s_add_u32 s75, s75, s43
  s_lshl_b32 s43, s50, 6
  s_add_u32 s75, s75, s43
  s_lshr_b32 s76, s74, 2
  s_mul_i32 s43, s51, 72
  s_add_u32 s76, s76, s43
  s_mul_i32 s76, s76, 18432
  s_lshl_b32 s43, s50, 12
  s_add_u32 s76, s76, s43
  s_and_b32 s43, s74, 3
  s_lshl_b32 s43, s43, 10
  s_add_u32 s76, s76, s43
  v_lshrrev_b32 v189, 2, v186
  v_and_b32 v190, 3, v186
  v_mul_u32_u24 v232, 1152, v189
  v_lshl_add_u32 v232, v190, 4, v232
  v_mov_b32 v233, v232
  s_mov_b32 s77, 0x7f000000
  s_mov_b32 s78, 0x7f000000
  s_sub_u32 s79, s40, 288
  s_cmp_lt_u32 s79, 512
  s_cbranch_scc0 attn_kernel_x1
  s_and_b32 s50, s79, 3
  s_bfe_u32 s51, s79, 0x20002
  s_lshr_b32 s74, s79, 4
  s_add_u32 s74, s74, 256
  s_mul_i32 s77, s74, 18432
  s_mul_i32 s43, s51, 288
  s_add_u32 s77, s77, s43
  s_lshl_b32 s43, s50, 6
  s_add_u32 s77, s77, s43
  s_lshr_b32 s78, s74, 2
  s_mul_i32 s43, s51, 72
  s_add_u32 s78, s78, s43
  s_mul_i32 s78, s78, 18432
  s_lshl_b32 s43, s50, 12
  s_add_u32 s78, s78, s43
  s_and_b32 s43, s74, 3
  s_lshl_b32 s43, s43, 10
  s_add_u32 s78, s78, s43
attn_kernel_x1:
  s_sub_u32 s79, s40, 800
  s_cmp_lt_u32 s79, 576
  s_cbranch_scc0 attn_kernel_x2
  s_and_b32 s50, s79, 3
  s_lshr_b32 s51, s79, 2
  s_mul_i32 s77, s51, 36864
  s_mul_i32 s43, s50, 288
  s_add_u32 s77, s77, s43
  s_add_u32 s77, s77, 256
  s_lshr_b32 s78, s51, 1
  s_mul_i32 s43, s50, 72
  s_add_u32 s78, s78, s43
  s_mul_i32 s78, s78, 18432
  s_add_u32 s78, s78, 16384
  s_and_b32 s43, s51, 1
  s_lshl_b32 s43, s43, 10
  s_add_u32 s78, s78, s43
  v_lshrrev_b32 v189, 1, v186
  v_and_b32 v190, 1, v186
  v_mul_u32_u24 v233, 1152, v189
  v_lshl_add_u32 v233, v190, 4, v233
attn_kernel_x2:
  s_cmp_lt_u32 s41, 504
  s_cselect_b32 s73, s73, 2130706432
  s_cmp_lt_u32 s24, 4
  s_mov_b32 s33, 0
  s_cselect_b32 s33, 16384, s33
  s_add_u32 m0, s30, s33
  s_add_u32 s31, s29, s33
  buffer_load_dwordx4 v185, s[12:15], s31 offen lds
  s_cmp_lt_u32 s24, 4
  s_mov_b32 s33, 8192
  s_cselect_b32 s33, 73728, s33
  s_add_u32 m0, s30, s33
  s_add_u32 s31, s29, s33
  buffer_load_dwordx4 v185, s[12:15], s31 offen lds
  s_cmp_lt_u32 s24, 4
  s_mov_b32 s33, 16384
  s_cselect_b32 s33, 81920, s33
  s_add_u32 m0, s30, s33
  s_add_u32 s31, s29, s33
  buffer_load_dwordx4 v185, s[12:15], s31 offen lds
  s_cmp_lt_u32 s24, 4
  s_mov_b32 s33, 90112
  s_cselect_b32 s33, 90112, s33
  s_add_u32 m0, s30, s33
  s_add_u32 s31, s29, s33
  buffer_load_dwordx4 v185, s[12:15], s31 offen lds
  s_waitcnt vmcnt(4)
  s_barrier
  v_cndmask_b32 v12, 0, v12, s[34:35]
  v_cndmask_b32 v16, 0, v16, s[34:35]
  ds_read_b128 v[20:23], v182 offset:0
  ds_read_b32 v28, v183 offset:0
  ds_read_b128 v[24:27], v182 offset:1024
  ds_read_b32 v32, v183 offset:128
  s_waitcnt lgkmcnt(0)
  v_mfma_f32_32x32x16_bf16 v[52:67], v[20:23], v[4:7], 0
  v_mfma_f32_32x32x16_bf16 v[52:67], v[28:31], v[12:15], v[52:67]
  v_mfma_f32_32x32x16_bf16 v[84:99], v[20:23], v[8:11], 0
  v_mfma_f32_32x32x16_bf16 v[84:99], v[28:31], v[16:19], v[84:99]
  s_add_u32 m0, s30, 24576
  s_add_u32 s31, s29, 24576
  buffer_load_dwordx4 v185, s[12:15], s31 offen lds
  s_add_u32 m0, s30, 32768
  s_add_u32 s31, s29, 32768
  buffer_load_dwordx4 v185, s[12:15], s31 offen lds
  s_nop 5
  v_max3_f32 v189, v52, v53, v54
  v_max3_f32 v189, v189, v55, v56
  v_max3_f32 v189, v189, v57, v58
  v_max3_f32 v189, v189, v59, v60
  v_max3_f32 v189, v189, v61, v62
  v_max3_f32 v189, v189, v63, v64
  v_max3_f32 v189, v189, v65, v66
  v_max_f32 v189, v189, v67
  v_mov_b32 v190, v189
  s_nop 1
  v_permlane32_swap_b32 v190, v189
  v_max_f32 v189, v189, v190
  v_sub_f32 v189, 0, v189
  v_cvt_pk_bf16_f32 v189, v189, 0
  v_cndmask_b32 v13, 0, v189, s[34:35]
  v_lshlrev_b32 v180, 16, v189
  v_max3_f32 v189, v84, v85, v86
  v_max3_f32 v189, v189, v87, v88
  v_max3_f32 v189, v189, v89, v90
  v_max3_f32 v189, v189, v91, v92
  v_max3_f32 v189, v189, v93, v94
  v_max3_f32 v189, v189, v95, v96
  v_max3_f32 v189, v189, v97, v98
  v_max_f32 v189, v189, v99
  v_mov_b32 v190, v189
  s_nop 1
  v_permlane32_swap_b32 v190, v189
  v_max_f32 v189, v189, v190
  v_sub_f32 v189, 0, v189
  v_cvt_pk_bf16_f32 v189, v189, 0
  v_cndmask_b32 v17, 0, v189, s[34:35]
  v_lshlrev_b32 v181, 16, v189
  s_nop 1
  v_mfma_f32_32x32x16_bf16 v[52:67], v[20:23], v[4:7], 0
  v_mfma_f32_32x32x16_bf16 v[52:67], v[28:31], v[12:15], v[52:67]
  v_mfma_f32_32x32x16_bf16 v[84:99], v[20:23], v[8:11], 0
  v_mfma_f32_32x32x16_bf16 v[84:99], v[28:31], v[16:19], v[84:99]
  s_waitcnt vmcnt(2)
  s_barrier
  s_nop 9
  s_setprio 3
  v_mfma_f32_32x32x16_bf16 v[68:83], v[24:27], v[4:7], 0
  ds_read_b128 v[20:23], v182 offset:2048
  ds_read_b32 v28, v183 offset:256
  ds_read_b64_tr_b16 v[36:37], v184 offset:0
  ds_read_b64_tr_b16 v[38:39], v184 offset:320
  ds_read_b64_tr_b16 v[40:41], v184 offset:640
  ds_read_b64_tr_b16 v[42:43], v184 offset:960
  v_exp_f32 v52, v52
  s_add_u32 m0, s30, 98304
  v_exp_f32 v53, v53
  s_add_u32 s31, s29, 98304
  v_exp_f32 v54, v54
  buffer_load_dwordx4 v185, s[12:15], s31 offen lds
  v_exp_f32 v55, v55
  s_add_u32 m0, s30, 106496
  v_cvt_pk_bf16_f32 v116, v52, v53
  v_cvt_pk_bf16_f32 v117, v54, v55
  v_mfma_f32_32x32x16_bf16 v[148:163], v[44:47], v[124:127], v[148:163]
  v_exp_f32 v56, v56
  s_add_u32 s31, s29, 106496
  v_exp_f32 v57, v57
  buffer_load_dwordx4 v185, s[12:15], s31 offen lds
  v_exp_f32 v58, v58
  v_exp_f32 v59, v59
  v_cvt_pk_bf16_f32 v118, v56, v57
  v_cvt_pk_bf16_f32 v119, v58, v59
  v_mfma_f32_32x32x16_bf16 v[68:83], v[32:35], v[12:15], v[68:83]
  v_exp_f32 v60, v60
  v_exp_f32 v61, v61
  v_exp_f32 v62, v62
  v_exp_f32 v63, v63
  v_cvt_pk_bf16_f32 v120, v60, v61
  v_cvt_pk_bf16_f32 v121, v62, v63
  v_mfma_f32_32x32x16_bf16 v[148:163], v[48:51], v[128:131], v[148:163]
  v_exp_f32 v64, v64
  v_exp_f32 v65, v65
  v_exp_f32 v66, v66
  v_exp_f32 v67, v67
  v_cvt_pk_bf16_f32 v122, v64, v65
  v_cvt_pk_bf16_f32 v123, v66, v67
  v_mfma_f32_32x32x16_bf16 v[100:115], v[24:27], v[8:11], 0
  v_exp_f32 v84, v84
  v_exp_f32 v85, v85
  v_exp_f32 v86, v86
  v_exp_f32 v87, v87
  v_cvt_pk_bf16_f32 v132, v84, v85
  v_cvt_pk_bf16_f32 v133, v86, v87
  v_mfma_f32_32x32x16_bf16 v[164:179], v[44:47], v[140:143], v[164:179]
  v_exp_f32 v88, v88
  v_exp_f32 v89, v89
  v_exp_f32 v90, v90
  v_exp_f32 v91, v91
  v_cvt_pk_bf16_f32 v134, v88, v89
  v_cvt_pk_bf16_f32 v135, v90, v91
  v_mfma_f32_32x32x16_bf16 v[100:115], v[32:35], v[16:19], v[100:115]
  v_exp_f32 v92, v92
  v_exp_f32 v93, v93
  v_exp_f32 v94, v94
  v_exp_f32 v95, v95
  v_cvt_pk_bf16_f32 v136, v92, v93
  v_cvt_pk_bf16_f32 v137, v94, v95
  v_mfma_f32_32x32x16_bf16 v[164:179], v[48:51], v[144:147], v[164:179]
  v_exp_f32 v96, v96
  v_exp_f32 v97, v97
  v_exp_f32 v98, v98
  v_exp_f32 v99, v99
  s_waitcnt lgkmcnt(0)
  v_cvt_pk_bf16_f32 v138, v96, v97
  v_cvt_pk_bf16_f32 v139, v98, v99
  v_mfma_f32_32x32x16_bf16 v[52:67], v[20:23], v[4:7], 0
  ds_read_b128 v[24:27], v182 offset:3072
  ds_read_b32 v32, v183 offset:384
  ds_read_b64_tr_b16 v[44:45], v184 offset:1280
  ds_read_b64_tr_b16 v[46:47], v184 offset:1600
  ds_read_b64_tr_b16 v[48:49], v184 offset:1920
  ds_read_b64_tr_b16 v[50:51], v184 offset:2240
  v_exp_f32 v68, v68
  s_add_u32 m0, s30, 114688
  v_exp_f32 v69, v69
  s_add_u32 s31, s29, 114688
  v_exp_f32 v70, v70
  buffer_load_dwordx4 v185, s[12:15], s31 offen lds
  v_exp_f32 v71, v71
  s_add_u32 m0, s30, 40960
  v_cvt_pk_bf16_f32 v124, v68, v69
  v_cvt_pk_bf16_f32 v125, v70, v71
  v_mfma_f32_32x32x16_bf16 v[148:163], v[36:39], v[116:119], v[148:163]
  v_exp_f32 v72, v72
  s_add_u32 s31, s29, 40960
  v_exp_f32 v73, v73
  buffer_load_dwordx4 v185, s[12:15], s31 offen lds
  v_exp_f32 v74, v74
  v_exp_f32 v75, v75
  v_cvt_pk_bf16_f32 v126, v72, v73
  v_cvt_pk_bf16_f32 v127, v74, v75
  v_mfma_f32_32x32x16_bf16 v[52:67], v[28:31], v[12:15], v[52:67]
  v_exp_f32 v76, v76
  v_exp_f32 v77, v77
  v_exp_f32 v78, v78
  v_exp_f32 v79, v79
  v_cvt_pk_bf16_f32 v128, v76, v77
  v_cvt_pk_bf16_f32 v129, v78, v79
  v_mfma_f32_32x32x16_bf16 v[148:163], v[40:43], v[120:123], v[148:163]
  v_exp_f32 v80, v80
  v_exp_f32 v81, v81
  v_exp_f32 v82, v82
  v_exp_f32 v83, v83
  v_cvt_pk_bf16_f32 v130, v80, v81
  v_cvt_pk_bf16_f32 v131, v82, v83
  v_mfma_f32_32x32x16_bf16 v[84:99], v[20:23], v[8:11], 0
  v_exp_f32 v100, v100
  v_exp_f32 v101, v101
  v_exp_f32 v102, v102
  v_exp_f32 v103, v103
  v_cvt_pk_bf16_f32 v140, v100, v101
  v_cvt_pk_bf16_f32 v141, v102, v103
  v_mfma_f32_32x32x16_bf16 v[164:179], v[36:39], v[132:135], v[164:179]
  v_exp_f32 v104, v104
  v_exp_f32 v105, v105
  v_exp_f32 v106, v106
  v_exp_f32 v107, v107
  v_cvt_pk_bf16_f32 v142, v104, v105
  v_cvt_pk_bf16_f32 v143, v106, v107
  v_mfma_f32_32x32x16_bf16 v[84:99], v[28:31], v[16:19], v[84:99]
  v_exp_f32 v108, v108
  v_exp_f32 v109, v109
  v_exp_f32 v110, v110
  v_exp_f32 v111, v111
  v_cvt_pk_bf16_f32 v144, v108, v109
  v_cvt_pk_bf16_f32 v145, v110, v111
  v_mfma_f32_32x32x16_bf16 v[164:179], v[40:43], v[136:139], v[164:179]
  v_exp_f32 v112, v112
  v_exp_f32 v113, v113
  v_exp_f32 v114, v114
  v_exp_f32 v115, v115
  s_waitcnt lgkmcnt(0)
  v_cvt_pk_bf16_f32 v146, v112, v113
  v_cvt_pk_bf16_f32 v147, v114, v115
  v_mfma_f32_32x32x16_bf16 v[68:83], v[24:27], v[4:7], 0
  ds_read_b128 v[20:23], v182 offset:4096
  ds_read_b32 v28, v183 offset:512
  ds_read_b64_tr_b16 v[36:37], v184 offset:2560
  ds_read_b64_tr_b16 v[38:39], v184 offset:2880
  ds_read_b64_tr_b16 v[40:41], v184 offset:3200
  ds_read_b64_tr_b16 v[42:43], v184 offset:3520
  v_exp_f32 v52, v52
  s_add_u32 m0, s30, 49152
  v_exp_f32 v53, v53
  s_add_u32 s31, s29, 49152
  v_exp_f32 v54, v54
  buffer_load_dwordx4 v185, s[12:15], s31 offen lds
  v_exp_f32 v55, v55
  s_add_u32 m0, s30, 57344
  v_cvt_pk_bf16_f32 v116, v52, v53
  v_cvt_pk_bf16_f32 v117, v54, v55
  v_mfma_f32_32x32x16_bf16 v[148:163], v[44:47], v[124:127], v[148:163]
  v_exp_f32 v56, v56
  s_add_u32 s31, s29, 57344
  v_exp_f32 v57, v57
  buffer_load_dwordx4 v185, s[12:15], s31 offen lds
  v_exp_f32 v58, v58
  v_exp_f32 v59, v59
  v_cvt_pk_bf16_f32 v118, v56, v57
  v_cvt_pk_bf16_f32 v119, v58, v59
  v_mfma_f32_32x32x16_bf16 v[68:83], v[32:35], v[12:15], v[68:83]
  v_exp_f32 v60, v60
  v_exp_f32 v61, v61
  v_exp_f32 v62, v62
  v_exp_f32 v63, v63
  v_cvt_pk_bf16_f32 v120, v60, v61
  v_cvt_pk_bf16_f32 v121, v62, v63
  v_mfma_f32_32x32x16_bf16 v[148:163], v[48:51], v[128:131], v[148:163]
  v_exp_f32 v64, v64
  v_exp_f32 v65, v65
  v_exp_f32 v66, v66
  v_exp_f32 v67, v67
  v_cvt_pk_bf16_f32 v122, v64, v65
  v_cvt_pk_bf16_f32 v123, v66, v67
  v_mfma_f32_32x32x16_bf16 v[100:115], v[24:27], v[8:11], 0
  v_exp_f32 v84, v84
  v_exp_f32 v85, v85
  v_exp_f32 v86, v86
  v_exp_f32 v87, v87
  v_cvt_pk_bf16_f32 v132, v84, v85
  v_cvt_pk_bf16_f32 v133, v86, v87
  v_mfma_f32_32x32x16_bf16 v[164:179], v[44:47], v[140:143], v[164:179]
  v_exp_f32 v88, v88
  v_exp_f32 v89, v89
  v_exp_f32 v90, v90
  v_exp_f32 v91, v91
  v_cvt_pk_bf16_f32 v134, v88, v89
  v_cvt_pk_bf16_f32 v135, v90, v91
  v_mfma_f32_32x32x16_bf16 v[100:115], v[32:35], v[16:19], v[100:115]
  v_exp_f32 v92, v92
  v_exp_f32 v93, v93
  v_exp_f32 v94, v94
  v_exp_f32 v95, v95
  v_cvt_pk_bf16_f32 v136, v92, v93
  v_cvt_pk_bf16_f32 v137, v94, v95
  v_mfma_f32_32x32x16_bf16 v[164:179], v[48:51], v[144:147], v[164:179]
  v_exp_f32 v96, v96
  v_exp_f32 v97, v97
  v_exp_f32 v98, v98
  v_exp_f32 v99, v99
  s_waitcnt lgkmcnt(0)
  v_cvt_pk_bf16_f32 v138, v96, v97
  v_cvt_pk_bf16_f32 v139, v98, v99
  v_mfma_f32_32x32x16_bf16 v[52:67], v[20:23], v[4:7], 0
  ds_read_b128 v[24:27], v182 offset:5120
  ds_read_b32 v32, v183 offset:640
  ds_read_b64_tr_b16 v[44:45], v184 offset:3840
  ds_read_b64_tr_b16 v[46:47], v184 offset:4160
  ds_read_b64_tr_b16 v[48:49], v184 offset:4480
  ds_read_b64_tr_b16 v[50:51], v184 offset:4800
  v_exp_f32 v68, v68
  s_add_u32 m0, s30, 122880
  v_exp_f32 v69, v69
  s_add_u32 s31, s29, 122880
  v_exp_f32 v70, v70
  buffer_load_dwordx4 v185, s[12:15], s31 offen lds
  v_exp_f32 v71, v71
  s_add_u32 m0, s30, 131072
  v_cvt_pk_bf16_f32 v124, v68, v69
  v_cvt_pk_bf16_f32 v125, v70, v71
  v_mfma_f32_32x32x16_bf16 v[148:163], v[36:39], v[116:119], v[148:163]
  v_exp_f32 v72, v72
  s_add_u32 s31, s29, 131072
  v_exp_f32 v73, v73
  buffer_load_dwordx4 v185, s[12:15], s31 offen lds
  v_exp_f32 v74, v74
  v_exp_f32 v75, v75
  v_cvt_pk_bf16_f32 v126, v72, v73
  v_cvt_pk_bf16_f32 v127, v74, v75
  v_mfma_f32_32x32x16_bf16 v[52:67], v[28:31], v[12:15], v[52:67]
  v_exp_f32 v76, v76
  v_exp_f32 v77, v77
  v_exp_f32 v78, v78
  v_exp_f32 v79, v79
  v_cvt_pk_bf16_f32 v128, v76, v77
  v_cvt_pk_bf16_f32 v129, v78, v79
  v_mfma_f32_32x32x16_bf16 v[148:163], v[40:43], v[120:123], v[148:163]
  v_exp_f32 v80, v80
  v_exp_f32 v81, v81
  v_exp_f32 v82, v82
  v_exp_f32 v83, v83
  v_cvt_pk_bf16_f32 v130, v80, v81
  v_cvt_pk_bf16_f32 v131, v82, v83
  v_mfma_f32_32x32x16_bf16 v[84:99], v[20:23], v[8:11], 0
  v_exp_f32 v100, v100
  v_exp_f32 v101, v101
  v_exp_f32 v102, v102
  v_exp_f32 v103, v103
  v_cvt_pk_bf16_f32 v140, v100, v101
  v_cvt_pk_bf16_f32 v141, v102, v103
  v_mfma_f32_32x32x16_bf16 v[164:179], v[36:39], v[132:135], v[164:179]
  v_exp_f32 v104, v104
  v_exp_f32 v105, v105
  v_exp_f32 v106, v106
  v_exp_f32 v107, v107
  v_cvt_pk_bf16_f32 v142, v104, v105
  v_cvt_pk_bf16_f32 v143, v106, v107
  v_mfma_f32_32x32x16_bf16 v[84:99], v[28:31], v[16:19], v[84:99]
  v_exp_f32 v108, v108
  v_exp_f32 v109, v109
  v_exp_f32 v110, v110
  v_exp_f32 v111, v111
  v_cvt_pk_bf16_f32 v144, v108, v109
  v_cvt_pk_bf16_f32 v145, v110, v111
  v_mfma_f32_32x32x16_bf16 v[164:179], v[40:43], v[136:139], v[164:179]
  v_exp_f32 v112, v112
  v_exp_f32 v113, v113
  v_exp_f32 v114, v114
  v_exp_f32 v115, v115
  s_waitcnt lgkmcnt(0)
  v_cvt_pk_bf16_f32 v146, v112, v113
  v_cvt_pk_bf16_f32 v147, v114, v115
  v_mfma_f32_32x32x16_bf16 v[68:83], v[24:27], v[4:7], 0
  ds_read_b128 v[20:23], v182 offset:6144
  ds_read_b32 v28, v183 offset:768
  ds_read_b64_tr_b16 v[36:37], v184 offset:5120
  ds_read_b64_tr_b16 v[38:39], v184 offset:5440
  ds_read_b64_tr_b16 v[40:41], v184 offset:5760
  ds_read_b64_tr_b16 v[42:43], v184 offset:6080
  v_exp_f32 v52, v52
  s_add_u32 m0, s30, 65536
  v_exp_f32 v53, v53
  s_add_u32 s31, s29, 65536
  v_exp_f32 v54, v54
  buffer_load_dwordx4 v185, s[12:15], s31 offen lds
  v_exp_f32 v55, v55
  s_add_u32 m0, s30, 139264
  v_cvt_pk_bf16_f32 v116, v52, v53
  v_cvt_pk_bf16_f32 v117, v54, v55
  v_mfma_f32_32x32x16_bf16 v[148:163], v[44:47], v[124:127], v[148:163]
  v_exp_f32 v56, v56
  s_add_u32 s31, s29, 139264
  v_exp_f32 v57, v57
  buffer_load_dwordx4 v185, s[12:15], s31 offen lds
  v_exp_f32 v58, v58
  v_exp_f32 v59, v59
  v_cvt_pk_bf16_f32 v118, v56, v57
  v_cvt_pk_bf16_f32 v119, v58, v59
  v_mfma_f32_32x32x16_bf16 v[68:83], v[32:35], v[12:15], v[68:83]
  v_exp_f32 v60, v60
  v_exp_f32 v61, v61
  v_exp_f32 v62, v62
  v_exp_f32 v63, v63
  v_cvt_pk_bf16_f32 v120, v60, v61
  v_cvt_pk_bf16_f32 v121, v62, v63
  v_mfma_f32_32x32x16_bf16 v[148:163], v[48:51], v[128:131], v[148:163]
  v_exp_f32 v64, v64
  v_exp_f32 v65, v65
  v_exp_f32 v66, v66
  v_exp_f32 v67, v67
  v_cvt_pk_bf16_f32 v122, v64, v65
  v_cvt_pk_bf16_f32 v123, v66, v67
  v_mfma_f32_32x32x16_bf16 v[100:115], v[24:27], v[8:11], 0
  v_exp_f32 v84, v84
  v_exp_f32 v85, v85
  v_exp_f32 v86, v86
  v_exp_f32 v87, v87
  v_cvt_pk_bf16_f32 v132, v84, v85
  v_cvt_pk_bf16_f32 v133, v86, v87
  v_mfma_f32_32x32x16_bf16 v[164:179], v[44:47], v[140:143], v[164:179]
  v_exp_f32 v88, v88
  v_exp_f32 v89, v89
  v_exp_f32 v90, v90
  v_exp_f32 v91, v91
  v_cvt_pk_bf16_f32 v134, v88, v89
  v_cvt_pk_bf16_f32 v135, v90, v91
  v_mfma_f32_32x32x16_bf16 v[100:115], v[32:35], v[16:19], v[100:115]
  v_exp_f32 v92, v92
  v_exp_f32 v93, v93
  v_exp_f32 v94, v94
  v_exp_f32 v95, v95
  v_cvt_pk_bf16_f32 v136, v92, v93
  v_cvt_pk_bf16_f32 v137, v94, v95
  v_mfma_f32_32x32x16_bf16 v[164:179], v[48:51], v[144:147], v[164:179]
  v_exp_f32 v96, v96
  v_exp_f32 v97, v97
  v_exp_f32 v98, v98
  v_exp_f32 v99, v99
  s_waitcnt lgkmcnt(0)
  v_cvt_pk_bf16_f32 v138, v96, v97
  v_cvt_pk_bf16_f32 v139, v98, v99
  v_mfma_f32_32x32x16_bf16 v[52:67], v[20:23], v[4:7], 0
  ds_read_b128 v[24:27], v182 offset:7168
  ds_read_b32 v32, v183 offset:896
  ds_read_b64_tr_b16 v[44:45], v184 offset:6400
  ds_read_b64_tr_b16 v[46:47], v184 offset:6720
  ds_read_b64_tr_b16 v[48:49], v184 offset:7040
  ds_read_b64_tr_b16 v[50:51], v184 offset:7360
  v_exp_f32 v68, v68
  s_add_u32 m0, s30, 147456
  v_exp_f32 v69, v69
  s_add_u32 s31, s29, 147456
  v_exp_f32 v70, v70
  buffer_load_dwordx4 v185, s[12:15], s31 offen lds
  v_exp_f32 v71, v71
  v_cvt_pk_bf16_f32 v124, v68, v69
  v_cvt_pk_bf16_f32 v125, v70, v71
  v_mfma_f32_32x32x16_bf16 v[148:163], v[36:39], v[116:119], v[148:163]
  v_exp_f32 v72, v72
  v_exp_f32 v73, v73
  v_exp_f32 v74, v74
  v_exp_f32 v75, v75
  v_cvt_pk_bf16_f32 v126, v72, v73
  v_cvt_pk_bf16_f32 v127, v74, v75
  v_mfma_f32_32x32x16_bf16 v[52:67], v[28:31], v[12:15], v[52:67]
  v_exp_f32 v76, v76
  v_exp_f32 v77, v77
  v_exp_f32 v78, v78
  v_exp_f32 v79, v79
  v_cvt_pk_bf16_f32 v128, v76, v77
  v_cvt_pk_bf16_f32 v129, v78, v79
  v_mfma_f32_32x32x16_bf16 v[148:163], v[40:43], v[120:123], v[148:163]
  v_exp_f32 v80, v80
  v_exp_f32 v81, v81
  v_exp_f32 v82, v82
  v_exp_f32 v83, v83
  v_cvt_pk_bf16_f32 v130, v80, v81
  v_cvt_pk_bf16_f32 v131, v82, v83
  v_mfma_f32_32x32x16_bf16 v[84:99], v[20:23], v[8:11], 0
  v_exp_f32 v100, v100
  v_exp_f32 v101, v101
  v_exp_f32 v102, v102
  v_exp_f32 v103, v103
  v_cvt_pk_bf16_f32 v140, v100, v101
  v_cvt_pk_bf16_f32 v141, v102, v103
  v_mfma_f32_32x32x16_bf16 v[164:179], v[36:39], v[132:135], v[164:179]
  v_exp_f32 v104, v104
  v_exp_f32 v105, v105
  v_exp_f32 v106, v106
  v_exp_f32 v107, v107
  v_cvt_pk_bf16_f32 v142, v104, v105
  v_cvt_pk_bf16_f32 v143, v106, v107
  v_mfma_f32_32x32x16_bf16 v[84:99], v[28:31], v[16:19], v[84:99]
  v_exp_f32 v108, v108
  v_exp_f32 v109, v109
  v_exp_f32 v110, v110
  v_exp_f32 v111, v111
  v_cvt_pk_bf16_f32 v144, v108, v109
  v_cvt_pk_bf16_f32 v145, v110, v111
  v_mfma_f32_32x32x16_bf16 v[164:179], v[40:43], v[136:139], v[164:179]
  v_exp_f32 v112, v112
  v_exp_f32 v113, v113
  v_exp_f32 v114, v114
  v_exp_f32 v115, v115
  s_waitcnt lgkmcnt(0)
  v_cvt_pk_bf16_f32 v146, v112, v113
  v_cvt_pk_bf16_f32 v147, v114, v115
  s_waitcnt vmcnt(0)
  s_barrier
  v_mfma_f32_32x32x16_bf16 v[68:83], v[24:27], v[4:7], 0
  ds_read_b128 v[20:23], v182 offset:19456
  ds_read_b32 v28, v183 offset:19456
  ds_read_b64_tr_b16 v[36:37], v184 offset:7680
  ds_read_b64_tr_b16 v[38:39], v184 offset:8000
  ds_read_b64_tr_b16 v[40:41], v184 offset:8320
  ds_read_b64_tr_b16 v[42:43], v184 offset:8640
  v_exp_f32 v52, v52
  v_exp_f32 v53, v53
  v_exp_f32 v54, v54
  v_exp_f32 v55, v55
  v_cvt_pk_bf16_f32 v116, v52, v53
  v_cvt_pk_bf16_f32 v117, v54, v55
  v_mfma_f32_32x32x16_bf16 v[148:163], v[44:47], v[124:127], v[148:163]
  v_exp_f32 v56, v56
  v_exp_f32 v57, v57
  v_exp_f32 v58, v58
  v_exp_f32 v59, v59
  v_cvt_pk_bf16_f32 v118, v56, v57
  v_cvt_pk_bf16_f32 v119, v58, v59
  v_mfma_f32_32x32x16_bf16 v[68:83], v[32:35], v[12:15], v[68:83]
  v_exp_f32 v60, v60
  v_exp_f32 v61, v61
  v_exp_f32 v62, v62
  v_exp_f32 v63, v63
  v_cvt_pk_bf16_f32 v120, v60, v61
  v_cvt_pk_bf16_f32 v121, v62, v63
  v_mfma_f32_32x32x16_bf16 v[148:163], v[48:51], v[128:131], v[148:163]
  v_exp_f32 v64, v64
  v_exp_f32 v65, v65
  v_exp_f32 v66, v66
  v_exp_f32 v67, v67
  v_cvt_pk_bf16_f32 v122, v64, v65
  v_cvt_pk_bf16_f32 v123, v66, v67
  v_mfma_f32_32x32x16_bf16 v[100:115], v[24:27], v[8:11], 0
  v_exp_f32 v84, v84
  v_exp_f32 v85, v85
  v_exp_f32 v86, v86
  v_exp_f32 v87, v87
  v_cvt_pk_bf16_f32 v132, v84, v85
  v_cvt_pk_bf16_f32 v133, v86, v87
  v_mfma_f32_32x32x16_bf16 v[164:179], v[44:47], v[140:143], v[164:179]
  v_exp_f32 v88, v88
  v_exp_f32 v89, v89
  v_exp_f32 v90, v90
  v_exp_f32 v91, v91
  v_cvt_pk_bf16_f32 v134, v88, v89
  v_cvt_pk_bf16_f32 v135, v90, v91
  v_mfma_f32_32x32x16_bf16 v[100:115], v[32:35], v[16:19], v[100:115]
  v_exp_f32 v92, v92
  v_exp_f32 v93, v93
  v_exp_f32 v94, v94
  v_exp_f32 v95, v95
  v_cvt_pk_bf16_f32 v136, v92, v93
  v_cvt_pk_bf16_f32 v137, v94, v95
  v_mfma_f32_32x32x16_bf16 v[164:179], v[48:51], v[144:147], v[164:179]
  v_exp_f32 v96, v96
  v_exp_f32 v97, v97
  v_exp_f32 v98, v98
  v_exp_f32 v99, v99
  s_waitcnt lgkmcnt(0)
  v_cvt_pk_bf16_f32 v138, v96, v97
  v_cvt_pk_bf16_f32 v139, v98, v99
  v_mfma_f32_32x32x16_bf16 v[52:67], v[20:23], v[4:7], 0
  ds_read_b128 v[24:27], v182 offset:20480
  ds_read_b32 v32, v183 offset:19584
  ds_read_b64_tr_b16 v[44:45], v184 offset:8960
  ds_read_b64_tr_b16 v[46:47], v184 offset:9280
  ds_read_b64_tr_b16 v[48:49], v184 offset:9600
  ds_read_b64_tr_b16 v[50:51], v184 offset:9920
  v_exp_f32 v68, v68
  v_exp_f32 v69, v69
  v_exp_f32 v70, v70
  v_exp_f32 v71, v71
  v_cvt_pk_bf16_f32 v124, v68, v69
  v_cvt_pk_bf16_f32 v125, v70, v71
  v_mfma_f32_32x32x16_bf16 v[148:163], v[36:39], v[116:119], v[148:163]
  v_exp_f32 v72, v72
  v_exp_f32 v73, v73
  v_exp_f32 v74, v74
  v_exp_f32 v75, v75
  v_cvt_pk_bf16_f32 v126, v72, v73
  v_cvt_pk_bf16_f32 v127, v74, v75
  v_mfma_f32_32x32x16_bf16 v[52:67], v[28:31], v[12:15], v[52:67]
  v_exp_f32 v76, v76
  v_exp_f32 v77, v77
  v_exp_f32 v78, v78
  v_exp_f32 v79, v79
  v_cvt_pk_bf16_f32 v128, v76, v77
  v_cvt_pk_bf16_f32 v129, v78, v79
  v_mfma_f32_32x32x16_bf16 v[148:163], v[40:43], v[120:123], v[148:163]
  v_exp_f32 v80, v80
  v_exp_f32 v81, v81
  v_exp_f32 v82, v82
  v_exp_f32 v83, v83
  v_cvt_pk_bf16_f32 v130, v80, v81
  v_cvt_pk_bf16_f32 v131, v82, v83
  v_mfma_f32_32x32x16_bf16 v[84:99], v[20:23], v[8:11], 0
  v_exp_f32 v100, v100
  v_exp_f32 v101, v101
  v_exp_f32 v102, v102
  v_exp_f32 v103, v103
  v_cvt_pk_bf16_f32 v140, v100, v101
  v_cvt_pk_bf16_f32 v141, v102, v103
  v_mfma_f32_32x32x16_bf16 v[164:179], v[36:39], v[132:135], v[164:179]
  v_exp_f32 v104, v104
  v_exp_f32 v105, v105
  v_exp_f32 v106, v106
  v_exp_f32 v107, v107
  v_cvt_pk_bf16_f32 v142, v104, v105
  v_cvt_pk_bf16_f32 v143, v106, v107
  v_mfma_f32_32x32x16_bf16 v[84:99], v[28:31], v[16:19], v[84:99]
  v_exp_f32 v108, v108
  v_exp_f32 v109, v109
  v_exp_f32 v110, v110
  v_exp_f32 v111, v111
  v_cvt_pk_bf16_f32 v144, v108, v109
  v_cvt_pk_bf16_f32 v145, v110, v111
  v_mfma_f32_32x32x16_bf16 v[164:179], v[40:43], v[136:139], v[164:179]
  v_exp_f32 v112, v112
  v_exp_f32 v113, v113
  v_exp_f32 v114, v114
  v_exp_f32 v115, v115
  s_waitcnt lgkmcnt(0)
  v_cvt_pk_bf16_f32 v146, v112, v113
  v_cvt_pk_bf16_f32 v147, v114, v115
  v_add_u32 v182, 19456, v182
  v_add_u32 v183, 19456, v183
  v_add_u32 v184, 19456, v184
  v_mfma_f32_32x32x16_bf16 v[68:83], v[24:27], v[4:7], 0
  ds_read_b128 v[20:23], v182 offset:2048
  ds_read_b32 v28, v183 offset:256
  ds_read_b64_tr_b16 v[36:37], v184 offset:0
  ds_read_b64_tr_b16 v[38:39], v184 offset:320
  ds_read_b64_tr_b16 v[40:41], v184 offset:640
  ds_read_b64_tr_b16 v[42:43], v184 offset:960
  v_exp_f32 v52, v52
  global_load_dwordx4 v[196:199], v[228:229], off
  v_exp_f32 v53, v53
  v_add_co_u32 v230, vcc, 1792, v228
  v_exp_f32 v54, v54
  s_nop 0
  v_exp_f32 v55, v55
  s_nop 0
  v_cvt_pk_bf16_f32 v116, v52, v53
  v_cvt_pk_bf16_f32 v117, v54, v55
  v_mfma_f32_32x32x16_bf16 v[148:163], v[44:47], v[124:127], v[148:163]
  v_exp_f32 v56, v56
  v_addc_co_u32 v231, vcc, 0, v229, vcc
  v_exp_f32 v57, v57
  global_load_dwordx4 v[200:203], v[230:231], off
  v_exp_f32 v58, v58
  v_add_co_u32 v230, vcc, 3584, v228
  v_exp_f32 v59, v59
  s_nop 0
  v_cvt_pk_bf16_f32 v118, v56, v57
  v_cvt_pk_bf16_f32 v119, v58, v59
  v_mfma_f32_32x32x16_bf16 v[68:83], v[32:35], v[12:15], v[68:83]
  v_exp_f32 v60, v60
  s_nop 0
  v_exp_f32 v61, v61
  v_addc_co_u32 v231, vcc, 0, v229, vcc
  v_exp_f32 v62, v62
  global_load_dwordx4 v[204:207], v[230:231], off
  v_exp_f32 v63, v63
  v_add_co_u32 v230, vcc, 5376, v228
  v_cvt_pk_bf16_f32 v120, v60, v61
  v_cvt_pk_bf16_f32 v121, v62, v63
  v_mfma_f32_32x32x16_bf16 v[148:163], v[48:51], v[128:131], v[148:163]
  v_exp_f32 v64, v64
  s_nop 0
  v_exp_f32 v65, v65
  s_nop 0
  v_exp_f32 v66, v66
  v_addc_co_u32 v231, vcc, 0, v229, vcc
  v_exp_f32 v67, v67
  global_load_dwordx4 v[208:211], v[230:231], off
  v_cvt_pk_bf16_f32 v122, v64, v65
  v_cvt_pk_bf16_f32 v123, v66, v67
  v_mfma_f32_32x32x16_bf16 v[100:115], v[24:27], v[8:11], 0
  v_exp_f32 v84, v84
  v_add_co_u32 v230, vcc, 7168, v228
  v_exp_f32 v85, v85
  s_nop 0
  v_exp_f32 v86, v86
  s_nop 0
  v_exp_f32 v87, v87
  v_addc_co_u32 v231, vcc, 0, v229, vcc
  v_cvt_pk_bf16_f32 v132, v84, v85
  v_cvt_pk_bf16_f32 v133, v86, v87
  v_mfma_f32_32x32x16_bf16 v[164:179], v[44:47], v[140:143], v[164:179]
  v_exp_f32 v88, v88
  global_load_dwordx4 v[212:215], v[230:231], off
  v_exp_f32 v89, v89
  s_add_u32 s50, s75, 0
  v_exp_f32 v90, v90
  buffer_load_dwordx4 v[216:219], v232, s[60:63], s50 offen
  v_exp_f32 v91, v91
  s_add_u32 s50, s75, 2359296
  v_cvt_pk_bf16_f32 v134, v88, v89
  v_cvt_pk_bf16_f32 v135, v90, v91
  v_mfma_f32_32x32x16_bf16 v[100:115], v[32:35], v[16:19], v[100:115]
  v_exp_f32 v92, v92
  buffer_load_dwordx4 v[220:223], v232, s[60:63], s50 offen
  v_exp_f32 v93, v93
  v_exp_f32 v94, v94
  v_exp_f32 v95, v95
  v_cvt_pk_bf16_f32 v136, v92, v93
  v_cvt_pk_bf16_f32 v137, v94, v95
  v_mfma_f32_32x32x16_bf16 v[164:179], v[48:51], v[144:147], v[164:179]
  v_exp_f32 v96, v96
  v_exp_f32 v97, v97
  v_exp_f32 v98, v98
  v_exp_f32 v99, v99
  s_waitcnt lgkmcnt(0)
  v_cvt_pk_bf16_f32 v138, v96, v97
  v_cvt_pk_bf16_f32 v139, v98, v99
  v_mfma_f32_32x32x16_bf16 v[52:67], v[20:23], v[4:7], 0
  ds_read_b128 v[24:27], v182 offset:3072
  ds_read_b32 v32, v183 offset:384
  ds_read_b64_tr_b16 v[44:45], v184 offset:1280
  ds_read_b64_tr_b16 v[46:47], v184 offset:1600
  ds_read_b64_tr_b16 v[48:49], v184 offset:1920
  ds_read_b64_tr_b16 v[50:51], v184 offset:2240
  v_exp_f32 v68, v68
  v_exp_f32 v69, v69
  v_exp_f32 v70, v70
  v_exp_f32 v71, v71
  v_cvt_pk_bf16_f32 v124, v68, v69
  v_cvt_pk_bf16_f32 v125, v70, v71
  v_mfma_f32_32x32x16_bf16 v[148:163], v[36:39], v[116:119], v[148:163]
  v_exp_f32 v72, v72
  v_exp_f32 v73, v73
  v_exp_f32 v74, v74
  v_exp_f32 v75, v75
  v_cvt_pk_bf16_f32 v126, v72, v73
  v_cvt_pk_bf16_f32 v127, v74, v75
  v_mfma_f32_32x32x16_bf16 v[52:67], v[28:31], v[12:15], v[52:67]
  v_exp_f32 v76, v76
  v_exp_f32 v77, v77
  v_exp_f32 v78, v78
  v_exp_f32 v79, v79
  v_cvt_pk_bf16_f32 v128, v76, v77
  v_cvt_pk_bf16_f32 v129, v78, v79
  v_mfma_f32_32x32x16_bf16 v[148:163], v[40:43], v[120:123], v[148:163]
  v_exp_f32 v80, v80
  v_exp_f32 v81, v81
  v_exp_f32 v82, v82
  v_exp_f32 v83, v83
  v_cvt_pk_bf16_f32 v130, v80, v81
  v_cvt_pk_bf16_f32 v131, v82, v83
  v_mfma_f32_32x32x16_bf16 v[84:99], v[20:23], v[8:11], 0
  v_exp_f32 v100, v100
  v_exp_f32 v101, v101
  v_exp_f32 v102, v102
  v_exp_f32 v103, v103
  v_cvt_pk_bf16_f32 v140, v100, v101
  v_cvt_pk_bf16_f32 v141, v102, v103
  v_mfma_f32_32x32x16_bf16 v[164:179], v[36:39], v[132:135], v[164:179]
  v_exp_f32 v104, v104
  v_exp_f32 v105, v105
  v_exp_f32 v106, v106
  v_exp_f32 v107, v107
  v_cvt_pk_bf16_f32 v142, v104, v105
  v_cvt_pk_bf16_f32 v143, v106, v107
  v_mfma_f32_32x32x16_bf16 v[84:99], v[28:31], v[16:19], v[84:99]
  v_exp_f32 v108, v108
  v_exp_f32 v109, v109
  v_exp_f32 v110, v110
  v_exp_f32 v111, v111
  v_cvt_pk_bf16_f32 v144, v108, v109
  v_cvt_pk_bf16_f32 v145, v110, v111
  v_mfma_f32_32x32x16_bf16 v[164:179], v[40:43], v[136:139], v[164:179]
  v_exp_f32 v112, v112
  v_exp_f32 v113, v113
  v_exp_f32 v114, v114
  v_exp_f32 v115, v115
  s_waitcnt lgkmcnt(0)
  v_cvt_pk_bf16_f32 v146, v112, v113
  v_cvt_pk_bf16_f32 v147, v114, v115
  v_mfma_f32_32x32x16_bf16 v[68:83], v[24:27], v[4:7], 0
  ds_read_b128 v[20:23], v182 offset:4096
  ds_read_b32 v28, v183 offset:512
  ds_read_b64_tr_b16 v[36:37], v184 offset:2560
  ds_read_b64_tr_b16 v[38:39], v184 offset:2880
  ds_read_b64_tr_b16 v[40:41], v184 offset:3200
  ds_read_b64_tr_b16 v[42:43], v184 offset:3520
  v_exp_f32 v52, v52
  v_exp_f32 v53, v53
  v_exp_f32 v54, v54
  v_exp_f32 v55, v55
  v_cvt_pk_bf16_f32 v116, v52, v53
  v_cvt_pk_bf16_f32 v117, v54, v55
  v_mfma_f32_32x32x16_bf16 v[148:163], v[44:47], v[124:127], v[148:163]
  v_exp_f32 v56, v56
  v_exp_f32 v57, v57
  v_exp_f32 v58, v58
  v_exp_f32 v59, v59
  v_cvt_pk_bf16_f32 v118, v56, v57
  v_cvt_pk_bf16_f32 v119, v58, v59
  v_mfma_f32_32x32x16_bf16 v[68:83], v[32:35], v[12:15], v[68:83]
  v_exp_f32 v60, v60
  v_exp_f32 v61, v61
  v_exp_f32 v62, v62
  v_exp_f32 v63, v63
  v_cvt_pk_bf16_f32 v120, v60, v61
  v_cvt_pk_bf16_f32 v121, v62, v63
  v_mfma_f32_32x32x16_bf16 v[148:163], v[48:51], v[128:131], v[148:163]
  v_exp_f32 v64, v64
  v_exp_f32 v65, v65
  v_exp_f32 v66, v66
  v_exp_f32 v67, v67
  v_cvt_pk_bf16_f32 v122, v64, v65
  v_cvt_pk_bf16_f32 v123, v66, v67
  v_mfma_f32_32x32x16_bf16 v[100:115], v[24:27], v[8:11], 0
  v_exp_f32 v84, v84
  v_exp_f32 v85, v85
  v_exp_f32 v86, v86
  v_exp_f32 v87, v87
  v_cvt_pk_bf16_f32 v132, v84, v85
  v_cvt_pk_bf16_f32 v133, v86, v87
  v_mfma_f32_32x32x16_bf16 v[164:179], v[44:47], v[140:143], v[164:179]
  v_exp_f32 v88, v88
  v_exp_f32 v89, v89
  v_exp_f32 v90, v90
  v_exp_f32 v91, v91
  v_cvt_pk_bf16_f32 v134, v88, v89
  v_cvt_pk_bf16_f32 v135, v90, v91
  v_mfma_f32_32x32x16_bf16 v[100:115], v[32:35], v[16:19], v[100:115]
  v_exp_f32 v92, v92
  v_exp_f32 v93, v93
  v_exp_f32 v94, v94
  v_exp_f32 v95, v95
  v_cvt_pk_bf16_f32 v136, v92, v93
  v_cvt_pk_bf16_f32 v137, v94, v95
  v_mfma_f32_32x32x16_bf16 v[164:179], v[48:51], v[144:147], v[164:179]
  v_exp_f32 v96, v96
  v_exp_f32 v97, v97
  v_exp_f32 v98, v98
  v_exp_f32 v99, v99
  s_waitcnt lgkmcnt(0)
  v_cvt_pk_bf16_f32 v138, v96, v97
  v_cvt_pk_bf16_f32 v139, v98, v99
  v_mfma_f32_32x32x16_bf16 v[52:67], v[20:23], v[4:7], 0
  ds_read_b128 v[24:27], v182 offset:5120
  ds_read_b32 v32, v183 offset:640
  ds_read_b64_tr_b16 v[44:45], v184 offset:3840
  ds_read_b64_tr_b16 v[46:47], v184 offset:4160
  ds_read_b64_tr_b16 v[48:49], v184 offset:4480
  ds_read_b64_tr_b16 v[50:51], v184 offset:4800
  v_exp_f32 v68, v68
  v_exp_f32 v69, v69
  v_exp_f32 v70, v70
  v_exp_f32 v71, v71
  v_cvt_pk_bf16_f32 v124, v68, v69
  v_cvt_pk_bf16_f32 v125, v70, v71
  v_mfma_f32_32x32x16_bf16 v[148:163], v[36:39], v[116:119], v[148:163]
  v_exp_f32 v72, v72
  v_exp_f32 v73, v73
  v_exp_f32 v74, v74
  v_exp_f32 v75, v75
  v_cvt_pk_bf16_f32 v126, v72, v73
  v_cvt_pk_bf16_f32 v127, v74, v75
  v_mfma_f32_32x32x16_bf16 v[52:67], v[28:31], v[12:15], v[52:67]
  v_exp_f32 v76, v76
  v_exp_f32 v77, v77
  v_exp_f32 v78, v78
  v_exp_f32 v79, v79
  v_cvt_pk_bf16_f32 v128, v76, v77
  v_cvt_pk_bf16_f32 v129, v78, v79
  v_mfma_f32_32x32x16_bf16 v[148:163], v[40:43], v[120:123], v[148:163]
  v_exp_f32 v80, v80
  v_exp_f32 v81, v81
  v_exp_f32 v82, v82
  v_exp_f32 v83, v83
  v_cvt_pk_bf16_f32 v130, v80, v81
  v_cvt_pk_bf16_f32 v131, v82, v83
  v_mfma_f32_32x32x16_bf16 v[84:99], v[20:23], v[8:11], 0
  v_exp_f32 v100, v100
  v_exp_f32 v101, v101
  v_exp_f32 v102, v102
  v_exp_f32 v103, v103
  v_cvt_pk_bf16_f32 v140, v100, v101
  v_cvt_pk_bf16_f32 v141, v102, v103
  v_mfma_f32_32x32x16_bf16 v[164:179], v[36:39], v[132:135], v[164:179]
  v_exp_f32 v104, v104
  v_exp_f32 v105, v105
  v_exp_f32 v106, v106
  v_exp_f32 v107, v107
  v_cvt_pk_bf16_f32 v142, v104, v105
  v_cvt_pk_bf16_f32 v143, v106, v107
  v_mfma_f32_32x32x16_bf16 v[84:99], v[28:31], v[16:19], v[84:99]
  v_exp_f32 v108, v108
  v_exp_f32 v109, v109
  v_exp_f32 v110, v110
  v_exp_f32 v111, v111
  v_cvt_pk_bf16_f32 v144, v108, v109
  v_cvt_pk_bf16_f32 v145, v110, v111
  v_mfma_f32_32x32x16_bf16 v[164:179], v[40:43], v[136:139], v[164:179]
  v_exp_f32 v112, v112
  v_exp_f32 v113, v113
  v_exp_f32 v114, v114
  v_exp_f32 v115, v115
  s_waitcnt lgkmcnt(0)
  v_cvt_pk_bf16_f32 v146, v112, v113
  v_cvt_pk_bf16_f32 v147, v114, v115
  v_mfma_f32_32x32x16_bf16 v[68:83], v[24:27], v[4:7], 0
  ds_read_b128 v[20:23], v182 offset:6144
  ds_read_b32 v28, v183 offset:768
  ds_read_b64_tr_b16 v[36:37], v184 offset:5120
  ds_read_b64_tr_b16 v[38:39], v184 offset:5440
  ds_read_b64_tr_b16 v[40:41], v184 offset:5760
  ds_read_b64_tr_b16 v[42:43], v184 offset:6080
  v_exp_f32 v52, v52
  v_exp_f32 v53, v53
  v_exp_f32 v54, v54
  v_exp_f32 v55, v55
  v_cvt_pk_bf16_f32 v116, v52, v53
  v_cvt_pk_bf16_f32 v117, v54, v55
  v_mfma_f32_32x32x16_bf16 v[148:163], v[44:47], v[124:127], v[148:163]
  v_exp_f32 v56, v56
  v_exp_f32 v57, v57
  v_exp_f32 v58, v58
  v_exp_f32 v59, v59
  v_cvt_pk_bf16_f32 v118, v56, v57
  v_cvt_pk_bf16_f32 v119, v58, v59
  v_mfma_f32_32x32x16_bf16 v[68:83], v[32:35], v[12:15], v[68:83]
  v_exp_f32 v60, v60
  v_exp_f32 v61, v61
  v_exp_f32 v62, v62
  v_exp_f32 v63, v63
  v_cvt_pk_bf16_f32 v120, v60, v61
  v_cvt_pk_bf16_f32 v121, v62, v63
  v_mfma_f32_32x32x16_bf16 v[148:163], v[48:51], v[128:131], v[148:163]
  v_exp_f32 v64, v64
  v_exp_f32 v65, v65
  v_exp_f32 v66, v66
  v_exp_f32 v67, v67
  v_cvt_pk_bf16_f32 v122, v64, v65
  v_cvt_pk_bf16_f32 v123, v66, v67
  v_mfma_f32_32x32x16_bf16 v[100:115], v[24:27], v[8:11], 0
  v_exp_f32 v84, v84
  v_exp_f32 v85, v85
  v_exp_f32 v86, v86
  v_exp_f32 v87, v87
  v_cvt_pk_bf16_f32 v132, v84, v85
  v_cvt_pk_bf16_f32 v133, v86, v87
  v_mfma_f32_32x32x16_bf16 v[164:179], v[44:47], v[140:143], v[164:179]
  v_exp_f32 v88, v88
  v_exp_f32 v89, v89
  v_exp_f32 v90, v90
  v_exp_f32 v91, v91
  v_cvt_pk_bf16_f32 v134, v88, v89
  v_cvt_pk_bf16_f32 v135, v90, v91
  v_mfma_f32_32x32x16_bf16 v[100:115], v[32:35], v[16:19], v[100:115]
  v_exp_f32 v92, v92
  v_exp_f32 v93, v93
  v_exp_f32 v94, v94
  v_exp_f32 v95, v95
  v_cvt_pk_bf16_f32 v136, v92, v93
  v_cvt_pk_bf16_f32 v137, v94, v95
  v_mfma_f32_32x32x16_bf16 v[164:179], v[48:51], v[144:147], v[164:179]
  v_exp_f32 v96, v96
  v_exp_f32 v97, v97
  v_exp_f32 v98, v98
  v_exp_f32 v99, v99
  s_waitcnt lgkmcnt(0)
  v_cvt_pk_bf16_f32 v138, v96, v97
  v_cvt_pk_bf16_f32 v139, v98, v99
  v_mfma_f32_32x32x16_bf16 v[52:67], v[20:23], v[4:7], 0
  ds_read_b128 v[24:27], v182 offset:7168
  ds_read_b32 v32, v183 offset:896
  ds_read_b64_tr_b16 v[44:45], v184 offset:6400
  ds_read_b64_tr_b16 v[46:47], v184 offset:6720
  ds_read_b64_tr_b16 v[48:49], v184 offset:7040
  ds_read_b64_tr_b16 v[50:51], v184 offset:7360
  v_exp_f32 v68, v68
  v_exp_f32 v69, v69
  v_exp_f32 v70, v70
  v_exp_f32 v71, v71
  v_cvt_pk_bf16_f32 v124, v68, v69
  v_cvt_pk_bf16_f32 v125, v70, v71
  v_mfma_f32_32x32x16_bf16 v[148:163], v[36:39], v[116:119], v[148:163]
  v_exp_f32 v72, v72
  v_exp_f32 v73, v73
  v_exp_f32 v74, v74
  v_exp_f32 v75, v75
  v_cvt_pk_bf16_f32 v126, v72, v73
  v_cvt_pk_bf16_f32 v127, v74, v75
  v_mfma_f32_32x32x16_bf16 v[52:67], v[28:31], v[12:15], v[52:67]
  v_exp_f32 v76, v76
  v_exp_f32 v77, v77
  v_exp_f32 v78, v78
  v_exp_f32 v79, v79
  v_cvt_pk_bf16_f32 v128, v76, v77
  v_cvt_pk_bf16_f32 v129, v78, v79
  v_mfma_f32_32x32x16_bf16 v[148:163], v[40:43], v[120:123], v[148:163]
  v_exp_f32 v80, v80
  v_exp_f32 v81, v81
  v_exp_f32 v82, v82
  v_exp_f32 v83, v83
  v_cvt_pk_bf16_f32 v130, v80, v81
  v_cvt_pk_bf16_f32 v131, v82, v83
  v_mfma_f32_32x32x16_bf16 v[84:99], v[20:23], v[8:11], 0
  v_exp_f32 v100, v100
  v_exp_f32 v101, v101
  v_exp_f32 v102, v102
  v_exp_f32 v103, v103
  v_cvt_pk_bf16_f32 v140, v100, v101
  v_cvt_pk_bf16_f32 v141, v102, v103
  v_mfma_f32_32x32x16_bf16 v[164:179], v[36:39], v[132:135], v[164:179]
  v_exp_f32 v104, v104
  v_exp_f32 v105, v105
  v_exp_f32 v106, v106
  v_exp_f32 v107, v107
  v_cvt_pk_bf16_f32 v142, v104, v105
  v_cvt_pk_bf16_f32 v143, v106, v107
  v_mfma_f32_32x32x16_bf16 v[84:99], v[28:31], v[16:19], v[84:99]
  v_exp_f32 v108, v108
  v_exp_f32 v109, v109
  v_exp_f32 v110, v110
  v_exp_f32 v111, v111
  v_cvt_pk_bf16_f32 v144, v108, v109
  v_cvt_pk_bf16_f32 v145, v110, v111
  v_mfma_f32_32x32x16_bf16 v[164:179], v[40:43], v[136:139], v[164:179]
  v_exp_f32 v112, v112
  v_exp_f32 v113, v113
  v_exp_f32 v114, v114
  v_exp_f32 v115, v115
  s_waitcnt lgkmcnt(0)
  v_cvt_pk_bf16_f32 v146, v112, v113
  v_cvt_pk_bf16_f32 v147, v114, v115
  v_mfma_f32_32x32x16_bf16 v[68:83], v[24:27], v[4:7], 0
  ds_read_b128 v[20:23], v182 offset:19456
  ds_read_b32 v28, v183 offset:19456
  ds_read_b64_tr_b16 v[36:37], v184 offset:7680
  ds_read_b64_tr_b16 v[38:39], v184 offset:8000
  ds_read_b64_tr_b16 v[40:41], v184 offset:8320
  ds_read_b64_tr_b16 v[42:43], v184 offset:8640
  v_exp_f32 v52, v52
  v_exp_f32 v53, v53
  v_exp_f32 v54, v54
  v_exp_f32 v55, v55
  v_cvt_pk_bf16_f32 v116, v52, v53
  v_cvt_pk_bf16_f32 v117, v54, v55
  v_mfma_f32_32x32x16_bf16 v[148:163], v[44:47], v[124:127], v[148:163]
  v_exp_f32 v56, v56
  v_exp_f32 v57, v57
  v_exp_f32 v58, v58
  v_exp_f32 v59, v59
  v_cvt_pk_bf16_f32 v118, v56, v57
  v_cvt_pk_bf16_f32 v119, v58, v59
  v_mfma_f32_32x32x16_bf16 v[68:83], v[32:35], v[12:15], v[68:83]
  v_exp_f32 v60, v60
  v_exp_f32 v61, v61
  v_exp_f32 v62, v62
  v_exp_f32 v63, v63
  v_cvt_pk_bf16_f32 v120, v60, v61
  v_cvt_pk_bf16_f32 v121, v62, v63
  v_mfma_f32_32x32x16_bf16 v[148:163], v[48:51], v[128:131], v[148:163]
  v_exp_f32 v64, v64
  v_exp_f32 v65, v65
  v_exp_f32 v66, v66
  v_exp_f32 v67, v67
  v_cvt_pk_bf16_f32 v122, v64, v65
  v_cvt_pk_bf16_f32 v123, v66, v67
  v_mfma_f32_32x32x16_bf16 v[100:115], v[24:27], v[8:11], 0
  v_exp_f32 v84, v84
  v_exp_f32 v85, v85
  v_exp_f32 v86, v86
  v_exp_f32 v87, v87
  v_cvt_pk_bf16_f32 v132, v84, v85
  v_cvt_pk_bf16_f32 v133, v86, v87
  v_mfma_f32_32x32x16_bf16 v[164:179], v[44:47], v[140:143], v[164:179]
  v_exp_f32 v88, v88
  v_exp_f32 v89, v89
  v_exp_f32 v90, v90
  v_exp_f32 v91, v91
  v_cvt_pk_bf16_f32 v134, v88, v89
  v_cvt_pk_bf16_f32 v135, v90, v91
  v_mfma_f32_32x32x16_bf16 v[100:115], v[32:35], v[16:19], v[100:115]
  v_exp_f32 v92, v92
  v_exp_f32 v93, v93
  v_exp_f32 v94, v94
  v_exp_f32 v95, v95
  v_cvt_pk_bf16_f32 v136, v92, v93
  v_cvt_pk_bf16_f32 v137, v94, v95
  v_mfma_f32_32x32x16_bf16 v[164:179], v[48:51], v[144:147], v[164:179]
  v_exp_f32 v96, v96
  v_exp_f32 v97, v97
  v_exp_f32 v98, v98
  v_exp_f32 v99, v99
  s_waitcnt lgkmcnt(0)
  v_cvt_pk_bf16_f32 v138, v96, v97
  v_cvt_pk_bf16_f32 v139, v98, v99
  v_mfma_f32_32x32x16_bf16 v[52:67], v[20:23], v[4:7], 0
  ds_read_b128 v[24:27], v182 offset:20480
  ds_read_b32 v32, v183 offset:19584
  ds_read_b64_tr_b16 v[44:45], v184 offset:8960
  ds_read_b64_tr_b16 v[46:47], v184 offset:9280
  ds_read_b64_tr_b16 v[48:49], v184 offset:9600
  ds_read_b64_tr_b16 v[50:51], v184 offset:9920
  v_exp_f32 v68, v68
  v_exp_f32 v69, v69
  v_exp_f32 v70, v70
  v_exp_f32 v71, v71
  v_cvt_pk_bf16_f32 v124, v68, v69
  v_cvt_pk_bf16_f32 v125, v70, v71
  v_mfma_f32_32x32x16_bf16 v[148:163], v[36:39], v[116:119], v[148:163]
  v_exp_f32 v72, v72
  v_exp_f32 v73, v73
  v_exp_f32 v74, v74
  v_exp_f32 v75, v75
  v_cvt_pk_bf16_f32 v126, v72, v73
  v_cvt_pk_bf16_f32 v127, v74, v75
  v_mfma_f32_32x32x16_bf16 v[52:67], v[28:31], v[12:15], v[52:67]
  v_exp_f32 v76, v76
  v_exp_f32 v77, v77
  v_exp_f32 v78, v78
  v_exp_f32 v79, v79
  v_cvt_pk_bf16_f32 v128, v76, v77
  v_cvt_pk_bf16_f32 v129, v78, v79
  v_mfma_f32_32x32x16_bf16 v[148:163], v[40:43], v[120:123], v[148:163]
  v_exp_f32 v80, v80
  v_exp_f32 v81, v81
  v_exp_f32 v82, v82
  v_exp_f32 v83, v83
  v_cvt_pk_bf16_f32 v130, v80, v81
  v_cvt_pk_bf16_f32 v131, v82, v83
  v_mfma_f32_32x32x16_bf16 v[84:99], v[20:23], v[8:11], 0
  v_exp_f32 v100, v100
  v_exp_f32 v101, v101
  v_exp_f32 v102, v102
  v_exp_f32 v103, v103
  v_cvt_pk_bf16_f32 v140, v100, v101
  v_cvt_pk_bf16_f32 v141, v102, v103
  v_mfma_f32_32x32x16_bf16 v[164:179], v[36:39], v[132:135], v[164:179]
  v_exp_f32 v104, v104
  v_exp_f32 v105, v105
  v_exp_f32 v106, v106
  v_exp_f32 v107, v107
  v_cvt_pk_bf16_f32 v142, v104, v105
  v_cvt_pk_bf16_f32 v143, v106, v107
  v_mfma_f32_32x32x16_bf16 v[84:99], v[28:31], v[16:19], v[84:99]
  v_exp_f32 v108, v108
  v_exp_f32 v109, v109
  v_exp_f32 v110, v110
  v_exp_f32 v111, v111
  v_cvt_pk_bf16_f32 v144, v108, v109
  v_cvt_pk_bf16_f32 v145, v110, v111
  v_mfma_f32_32x32x16_bf16 v[164:179], v[40:43], v[136:139], v[164:179]
  v_exp_f32 v112, v112
  v_exp_f32 v113, v113
  v_exp_f32 v114, v114
  v_exp_f32 v115, v115
  s_waitcnt lgkmcnt(0)
  v_cvt_pk_bf16_f32 v146, v112, v113
  v_cvt_pk_bf16_f32 v147, v114, v115
  s_cmp_ge_u32 s41, 72
  s_cbranch_scc1 attn_kernel_xb
  v_add_co_u32 v230, vcc, 8960, v228
  s_nop 1
  v_addc_co_u32 v231, vcc, 0, v229, vcc
  global_load_dwordx4 v[224:227], v[230:231], off
  s_branch attn_kernel_xe
attn_kernel_xb:
  buffer_load_dwordx4 v[224:227], v233, s[60:63], s77 offen
attn_kernel_xe:
  v_add_u32 v182, 19456, v182
  v_add_u32 v183, 19456, v183
  v_add_u32 v184, 19456, v184
  s_setprio 2
  v_mfma_f32_32x32x16_bf16 v[68:83], v[24:27], v[4:7], 0
  ds_read_b128 v[20:23], v182 offset:2048
  ds_read_b32 v28, v183 offset:256
  ds_read_b64_tr_b16 v[36:37], v184 offset:0
  ds_read_b64_tr_b16 v[38:39], v184 offset:320
  ds_read_b64_tr_b16 v[40:41], v184 offset:640
  ds_read_b64_tr_b16 v[42:43], v184 offset:960
  v_exp_f32 v52, v52
  v_exp_f32 v53, v53
  v_exp_f32 v54, v54
  v_exp_f32 v55, v55
  v_cvt_pk_bf16_f32 v116, v52, v53
  v_cvt_pk_bf16_f32 v117, v54, v55
  v_mfma_f32_32x32x16_bf16 v[148:163], v[44:47], v[124:127], v[148:163]
  v_exp_f32 v56, v56
  v_exp_f32 v57, v57
  v_exp_f32 v58, v58
  v_exp_f32 v59, v59
  v_cvt_pk_bf16_f32 v118, v56, v57
  v_cvt_pk_bf16_f32 v119, v58, v59
  v_mfma_f32_32x32x16_bf16 v[68:83], v[32:35], v[12:15], v[68:83]
  v_exp_f32 v60, v60
  v_exp_f32 v61, v61
  v_exp_f32 v62, v62
  v_exp_f32 v63, v63
  v_cvt_pk_bf16_f32 v120, v60, v61
  v_cvt_pk_bf16_f32 v121, v62, v63
  v_mfma_f32_32x32x16_bf16 v[148:163], v[48:51], v[128:131], v[148:163]
  v_exp_f32 v64, v64
  v_exp_f32 v65, v65
  v_exp_f32 v66, v66
  v_exp_f32 v67, v67
  v_cvt_pk_bf16_f32 v122, v64, v65
  v_cvt_pk_bf16_f32 v123, v66, v67
  v_mfma_f32_32x32x16_bf16 v[100:115], v[24:27], v[8:11], 0
  v_exp_f32 v84, v84
  v_exp_f32 v85, v85
  v_exp_f32 v86, v86
  v_exp_f32 v87, v87
  v_cvt_pk_bf16_f32 v132, v84, v85
  v_cvt_pk_bf16_f32 v133, v86, v87
  v_mfma_f32_32x32x16_bf16 v[164:179], v[44:47], v[140:143], v[164:179]
  v_exp_f32 v88, v88
  v_exp_f32 v89, v89
  v_exp_f32 v90, v90
  v_exp_f32 v91, v91
  v_cvt_pk_bf16_f32 v134, v88, v89
  v_cvt_pk_bf16_f32 v135, v90, v91
  v_mfma_f32_32x32x16_bf16 v[100:115], v[32:35], v[16:19], v[100:115]
  v_exp_f32 v92, v92
  v_exp_f32 v93, v93
  v_exp_f32 v94, v94
  v_exp_f32 v95, v95
  v_cvt_pk_bf16_f32 v136, v92, v93
  v_cvt_pk_bf16_f32 v137, v94, v95
  v_mfma_f32_32x32x16_bf16 v[164:179], v[48:51], v[144:147], v[164:179]
  v_exp_f32 v96, v96
  v_exp_f32 v97, v97
  v_exp_f32 v98, v98
  v_exp_f32 v99, v99
  s_waitcnt lgkmcnt(0)
  v_cvt_pk_bf16_f32 v138, v96, v97
  v_cvt_pk_bf16_f32 v139, v98, v99
  v_mfma_f32_32x32x16_bf16 v[52:67], v[20:23], v[4:7], 0
  ds_read_b128 v[24:27], v182 offset:3072
  ds_read_b32 v32, v183 offset:384
  ds_read_b64_tr_b16 v[44:45], v184 offset:1280
  ds_read_b64_tr_b16 v[46:47], v184 offset:1600
  ds_read_b64_tr_b16 v[48:49], v184 offset:1920
  ds_read_b64_tr_b16 v[50:51], v184 offset:2240
  v_exp_f32 v68, v68
  v_exp_f32 v69, v69
  v_exp_f32 v70, v70
  v_exp_f32 v71, v71
  v_cvt_pk_bf16_f32 v124, v68, v69
  v_cvt_pk_bf16_f32 v125, v70, v71
  v_mfma_f32_32x32x16_bf16 v[148:163], v[36:39], v[116:119], v[148:163]
  v_exp_f32 v72, v72
  v_exp_f32 v73, v73
  v_exp_f32 v74, v74
  v_exp_f32 v75, v75
  v_cvt_pk_bf16_f32 v126, v72, v73
  v_cvt_pk_bf16_f32 v127, v74, v75
  v_mfma_f32_32x32x16_bf16 v[52:67], v[28:31], v[12:15], v[52:67]
  v_exp_f32 v76, v76
  v_exp_f32 v77, v77
  v_exp_f32 v78, v78
  v_exp_f32 v79, v79
  v_cvt_pk_bf16_f32 v128, v76, v77
  v_cvt_pk_bf16_f32 v129, v78, v79
  v_mfma_f32_32x32x16_bf16 v[148:163], v[40:43], v[120:123], v[148:163]
  v_exp_f32 v80, v80
  v_exp_f32 v81, v81
  v_exp_f32 v82, v82
  v_exp_f32 v83, v83
  v_cvt_pk_bf16_f32 v130, v80, v81
  v_cvt_pk_bf16_f32 v131, v82, v83
  v_mfma_f32_32x32x16_bf16 v[84:99], v[20:23], v[8:11], 0
  v_exp_f32 v100, v100
  v_exp_f32 v101, v101
  v_exp_f32 v102, v102
  v_exp_f32 v103, v103
  v_cvt_pk_bf16_f32 v140, v100, v101
  v_cvt_pk_bf16_f32 v141, v102, v103
  v_mfma_f32_32x32x16_bf16 v[164:179], v[36:39], v[132:135], v[164:179]
  v_exp_f32 v104, v104
  v_exp_f32 v105, v105
  v_exp_f32 v106, v106
  v_exp_f32 v107, v107
  v_cvt_pk_bf16_f32 v142, v104, v105
  v_cvt_pk_bf16_f32 v143, v106, v107
  v_mfma_f32_32x32x16_bf16 v[84:99], v[28:31], v[16:19], v[84:99]
  v_exp_f32 v108, v108
  v_exp_f32 v109, v109
  v_exp_f32 v110, v110
  v_exp_f32 v111, v111
  v_cvt_pk_bf16_f32 v144, v108, v109
  v_cvt_pk_bf16_f32 v145, v110, v111
  v_mfma_f32_32x32x16_bf16 v[164:179], v[40:43], v[136:139], v[164:179]
  v_exp_f32 v112, v112
  v_exp_f32 v113, v113
  v_exp_f32 v114, v114
  v_exp_f32 v115, v115
  s_waitcnt lgkmcnt(0)
  v_cvt_pk_bf16_f32 v146, v112, v113
  v_cvt_pk_bf16_f32 v147, v114, v115
  v_mfma_f32_32x32x16_bf16 v[68:83], v[24:27], v[4:7], 0
  ds_read_b128 v[20:23], v182 offset:4096
  ds_read_b32 v28, v183 offset:512
  ds_read_b64_tr_b16 v[36:37], v184 offset:2560
  ds_read_b64_tr_b16 v[38:39], v184 offset:2880
  ds_read_b64_tr_b16 v[40:41], v184 offset:3200
  ds_read_b64_tr_b16 v[42:43], v184 offset:3520
  v_exp_f32 v52, v52
  v_exp_f32 v53, v53
  v_exp_f32 v54, v54
  v_exp_f32 v55, v55
  v_cvt_pk_bf16_f32 v116, v52, v53
  v_cvt_pk_bf16_f32 v117, v54, v55
  v_mfma_f32_32x32x16_bf16 v[148:163], v[44:47], v[124:127], v[148:163]
  v_exp_f32 v56, v56
  v_exp_f32 v57, v57
  v_exp_f32 v58, v58
  v_exp_f32 v59, v59
  v_cvt_pk_bf16_f32 v118, v56, v57
  v_cvt_pk_bf16_f32 v119, v58, v59
  v_mfma_f32_32x32x16_bf16 v[68:83], v[32:35], v[12:15], v[68:83]
  v_exp_f32 v60, v60
  v_exp_f32 v61, v61
  v_exp_f32 v62, v62
  v_exp_f32 v63, v63
  v_cvt_pk_bf16_f32 v120, v60, v61
  v_cvt_pk_bf16_f32 v121, v62, v63
  v_mfma_f32_32x32x16_bf16 v[148:163], v[48:51], v[128:131], v[148:163]
  v_exp_f32 v64, v64
  v_exp_f32 v65, v65
  v_exp_f32 v66, v66
  v_exp_f32 v67, v67
  v_cvt_pk_bf16_f32 v122, v64, v65
  v_cvt_pk_bf16_f32 v123, v66, v67
  v_mfma_f32_32x32x16_bf16 v[100:115], v[24:27], v[8:11], 0
  v_exp_f32 v84, v84
  v_exp_f32 v85, v85
  v_exp_f32 v86, v86
  v_exp_f32 v87, v87
  v_cvt_pk_bf16_f32 v132, v84, v85
  v_cvt_pk_bf16_f32 v133, v86, v87
  v_mfma_f32_32x32x16_bf16 v[164:179], v[44:47], v[140:143], v[164:179]
  v_exp_f32 v88, v88
  v_exp_f32 v89, v89
  v_exp_f32 v90, v90
  v_exp_f32 v91, v91
  v_cvt_pk_bf16_f32 v134, v88, v89
  v_cvt_pk_bf16_f32 v135, v90, v91
  v_mfma_f32_32x32x16_bf16 v[100:115], v[32:35], v[16:19], v[100:115]
  v_exp_f32 v92, v92
  v_exp_f32 v93, v93
  v_exp_f32 v94, v94
  v_exp_f32 v95, v95
  v_cvt_pk_bf16_f32 v136, v92, v93
  v_cvt_pk_bf16_f32 v137, v94, v95
  v_mfma_f32_32x32x16_bf16 v[164:179], v[48:51], v[144:147], v[164:179]
  v_exp_f32 v96, v96
  v_exp_f32 v97, v97
  v_exp_f32 v98, v98
  v_exp_f32 v99, v99
  s_waitcnt lgkmcnt(0)
  v_cvt_pk_bf16_f32 v138, v96, v97
  v_cvt_pk_bf16_f32 v139, v98, v99
  v_mfma_f32_32x32x16_bf16 v[52:67], v[20:23], v[4:7], 0
  ds_read_b128 v[24:27], v182 offset:5120
  ds_read_b32 v32, v183 offset:640
  ds_read_b64_tr_b16 v[44:45], v184 offset:3840
  ds_read_b64_tr_b16 v[46:47], v184 offset:4160
  ds_read_b64_tr_b16 v[48:49], v184 offset:4480
  ds_read_b64_tr_b16 v[50:51], v184 offset:4800
  v_exp_f32 v68, v68
  v_exp_f32 v69, v69
  v_exp_f32 v70, v70
  v_exp_f32 v71, v71
  v_cvt_pk_bf16_f32 v124, v68, v69
  v_cvt_pk_bf16_f32 v125, v70, v71
  v_mfma_f32_32x32x16_bf16 v[148:163], v[36:39], v[116:119], v[148:163]
  v_exp_f32 v72, v72
  v_exp_f32 v73, v73
  v_exp_f32 v74, v74
  v_exp_f32 v75, v75
  v_cvt_pk_bf16_f32 v126, v72, v73
  v_cvt_pk_bf16_f32 v127, v74, v75
  v_mfma_f32_32x32x16_bf16 v[52:67], v[28:31], v[12:15], v[52:67]
  v_exp_f32 v76, v76
  v_exp_f32 v77, v77
  v_exp_f32 v78, v78
  v_exp_f32 v79, v79
  v_cvt_pk_bf16_f32 v128, v76, v77
  v_cvt_pk_bf16_f32 v129, v78, v79
  v_mfma_f32_32x32x16_bf16 v[148:163], v[40:43], v[120:123], v[148:163]
  v_exp_f32 v80, v80
  v_exp_f32 v81, v81
  v_exp_f32 v82, v82
  v_exp_f32 v83, v83
  v_cvt_pk_bf16_f32 v130, v80, v81
  v_cvt_pk_bf16_f32 v131, v82, v83
  v_mfma_f32_32x32x16_bf16 v[84:99], v[20:23], v[8:11], 0
  v_exp_f32 v100, v100
  v_exp_f32 v101, v101
  v_exp_f32 v102, v102
  v_exp_f32 v103, v103
  v_cvt_pk_bf16_f32 v140, v100, v101
  v_cvt_pk_bf16_f32 v141, v102, v103
  v_mfma_f32_32x32x16_bf16 v[164:179], v[36:39], v[132:135], v[164:179]
  v_exp_f32 v104, v104
  v_exp_f32 v105, v105
  v_exp_f32 v106, v106
  v_exp_f32 v107, v107
  v_cvt_pk_bf16_f32 v142, v104, v105
  v_cvt_pk_bf16_f32 v143, v106, v107
  v_mfma_f32_32x32x16_bf16 v[84:99], v[28:31], v[16:19], v[84:99]
  v_exp_f32 v108, v108
  v_exp_f32 v109, v109
  v_exp_f32 v110, v110
  v_exp_f32 v111, v111
  v_cvt_pk_bf16_f32 v144, v108, v109
  v_cvt_pk_bf16_f32 v145, v110, v111
  v_mfma_f32_32x32x16_bf16 v[164:179], v[40:43], v[136:139], v[164:179]
  v_exp_f32 v112, v112
  v_exp_f32 v113, v113
  v_exp_f32 v114, v114
  v_exp_f32 v115, v115
  s_waitcnt lgkmcnt(0)
  v_cvt_pk_bf16_f32 v146, v112, v113
  v_cvt_pk_bf16_f32 v147, v114, v115
  v_mfma_f32_32x32x16_bf16 v[68:83], v[24:27], v[4:7], 0
  ds_read_b128 v[20:23], v182 offset:6144
  ds_read_b32 v28, v183 offset:768
  ds_read_b64_tr_b16 v[36:37], v184 offset:5120
  ds_read_b64_tr_b16 v[38:39], v184 offset:5440
  ds_read_b64_tr_b16 v[40:41], v184 offset:5760
  ds_read_b64_tr_b16 v[42:43], v184 offset:6080
  v_exp_f32 v52, v52
  v_exp_f32 v53, v53
  v_exp_f32 v54, v54
  v_exp_f32 v55, v55
  v_cvt_pk_bf16_f32 v116, v52, v53
  v_cvt_pk_bf16_f32 v117, v54, v55
  v_mfma_f32_32x32x16_bf16 v[148:163], v[44:47], v[124:127], v[148:163]
  v_exp_f32 v56, v56
  v_exp_f32 v57, v57
  v_exp_f32 v58, v58
  v_exp_f32 v59, v59
  v_cvt_pk_bf16_f32 v118, v56, v57
  v_cvt_pk_bf16_f32 v119, v58, v59
  v_mfma_f32_32x32x16_bf16 v[68:83], v[32:35], v[12:15], v[68:83]
  v_exp_f32 v60, v60
  v_exp_f32 v61, v61
  v_exp_f32 v62, v62
  v_exp_f32 v63, v63
  v_cvt_pk_bf16_f32 v120, v60, v61
  v_cvt_pk_bf16_f32 v121, v62, v63
  v_mfma_f32_32x32x16_bf16 v[148:163], v[48:51], v[128:131], v[148:163]
  v_exp_f32 v64, v64
  v_exp_f32 v65, v65
  v_exp_f32 v66, v66
  v_exp_f32 v67, v67
  v_cvt_pk_bf16_f32 v122, v64, v65
  v_cvt_pk_bf16_f32 v123, v66, v67
  v_mfma_f32_32x32x16_bf16 v[100:115], v[24:27], v[8:11], 0
  v_exp_f32 v84, v84
  v_exp_f32 v85, v85
  v_exp_f32 v86, v86
  v_exp_f32 v87, v87
  v_cvt_pk_bf16_f32 v132, v84, v85
  v_cvt_pk_bf16_f32 v133, v86, v87
  v_mfma_f32_32x32x16_bf16 v[164:179], v[44:47], v[140:143], v[164:179]
  v_exp_f32 v88, v88
  v_exp_f32 v89, v89
  v_exp_f32 v90, v90
  v_exp_f32 v91, v91
  v_cvt_pk_bf16_f32 v134, v88, v89
  v_cvt_pk_bf16_f32 v135, v90, v91
  v_mfma_f32_32x32x16_bf16 v[100:115], v[32:35], v[16:19], v[100:115]
  v_exp_f32 v92, v92
  v_exp_f32 v93, v93
  v_exp_f32 v94, v94
  v_exp_f32 v95, v95
  v_cvt_pk_bf16_f32 v136, v92, v93
  v_cvt_pk_bf16_f32 v137, v94, v95
  v_mfma_f32_32x32x16_bf16 v[164:179], v[48:51], v[144:147], v[164:179]
  v_exp_f32 v96, v96
  v_exp_f32 v97, v97
  v_exp_f32 v98, v98
  v_exp_f32 v99, v99
  s_waitcnt lgkmcnt(0)
  v_cvt_pk_bf16_f32 v138, v96, v97
  v_cvt_pk_bf16_f32 v139, v98, v99
  v_mfma_f32_32x32x16_bf16 v[52:67], v[20:23], v[4:7], 0
  ds_read_b128 v[24:27], v182 offset:7168
  ds_read_b32 v32, v183 offset:896
  ds_read_b64_tr_b16 v[44:45], v184 offset:6400
  ds_read_b64_tr_b16 v[46:47], v184 offset:6720
  ds_read_b64_tr_b16 v[48:49], v184 offset:7040
  ds_read_b64_tr_b16 v[50:51], v184 offset:7360
  v_exp_f32 v68, v68
  v_exp_f32 v69, v69
  v_exp_f32 v70, v70
  v_exp_f32 v71, v71
  v_cvt_pk_bf16_f32 v124, v68, v69
  v_cvt_pk_bf16_f32 v125, v70, v71
  v_mfma_f32_32x32x16_bf16 v[148:163], v[36:39], v[116:119], v[148:163]
  v_exp_f32 v72, v72
  v_exp_f32 v73, v73
  v_exp_f32 v74, v74
  v_exp_f32 v75, v75
  v_cvt_pk_bf16_f32 v126, v72, v73
  v_cvt_pk_bf16_f32 v127, v74, v75
  v_mfma_f32_32x32x16_bf16 v[52:67], v[28:31], v[12:15], v[52:67]
  v_exp_f32 v76, v76
  v_exp_f32 v77, v77
  v_exp_f32 v78, v78
  v_exp_f32 v79, v79
  v_cvt_pk_bf16_f32 v128, v76, v77
  v_cvt_pk_bf16_f32 v129, v78, v79
  v_mfma_f32_32x32x16_bf16 v[148:163], v[40:43], v[120:123], v[148:163]
  v_exp_f32 v80, v80
  v_exp_f32 v81, v81
  v_exp_f32 v82, v82
  v_exp_f32 v83, v83
  v_cvt_pk_bf16_f32 v130, v80, v81
  v_cvt_pk_bf16_f32 v131, v82, v83
  v_mfma_f32_32x32x16_bf16 v[84:99], v[20:23], v[8:11], 0
  v_exp_f32 v100, v100
  v_exp_f32 v101, v101
  v_exp_f32 v102, v102
  v_exp_f32 v103, v103
  v_cvt_pk_bf16_f32 v140, v100, v101
  v_cvt_pk_bf16_f32 v141, v102, v103
  v_mfma_f32_32x32x16_bf16 v[164:179], v[36:39], v[132:135], v[164:179]
  v_exp_f32 v104, v104
  v_exp_f32 v105, v105
  v_exp_f32 v106, v106
  v_exp_f32 v107, v107
  v_cvt_pk_bf16_f32 v142, v104, v105
  v_cvt_pk_bf16_f32 v143, v106, v107
  v_mfma_f32_32x32x16_bf16 v[84:99], v[28:31], v[16:19], v[84:99]
  v_exp_f32 v108, v108
  v_exp_f32 v109, v109
  v_exp_f32 v110, v110
  v_exp_f32 v111, v111
  v_cvt_pk_bf16_f32 v144, v108, v109
  v_cvt_pk_bf16_f32 v145, v110, v111
  v_mfma_f32_32x32x16_bf16 v[164:179], v[40:43], v[136:139], v[164:179]
  v_exp_f32 v112, v112
  v_exp_f32 v113, v113
  v_exp_f32 v114, v114
  v_exp_f32 v115, v115
  s_waitcnt lgkmcnt(0)
  v_cvt_pk_bf16_f32 v146, v112, v113
  v_cvt_pk_bf16_f32 v147, v114, v115
  v_mfma_f32_32x32x16_bf16 v[68:83], v[24:27], v[4:7], 0
  ds_read_b128 v[20:23], v182 offset:19456
  ds_read_b32 v28, v183 offset:19456
  ds_read_b64_tr_b16 v[36:37], v184 offset:7680
  ds_read_b64_tr_b16 v[38:39], v184 offset:8000
  ds_read_b64_tr_b16 v[40:41], v184 offset:8320
  ds_read_b64_tr_b16 v[42:43], v184 offset:8640
  v_exp_f32 v52, v52
  v_exp_f32 v53, v53
  v_exp_f32 v54, v54
  v_exp_f32 v55, v55
  v_cvt_pk_bf16_f32 v116, v52, v53
  v_cvt_pk_bf16_f32 v117, v54, v55
  v_mfma_f32_32x32x16_bf16 v[148:163], v[44:47], v[124:127], v[148:163]
  v_exp_f32 v56, v56
  v_exp_f32 v57, v57
  v_exp_f32 v58, v58
  v_exp_f32 v59, v59
  v_cvt_pk_bf16_f32 v118, v56, v57
  v_cvt_pk_bf16_f32 v119, v58, v59
  v_mfma_f32_32x32x16_bf16 v[68:83], v[32:35], v[12:15], v[68:83]
  v_exp_f32 v60, v60
  v_exp_f32 v61, v61
  v_exp_f32 v62, v62
  v_exp_f32 v63, v63
  v_cvt_pk_bf16_f32 v120, v60, v61
  v_cvt_pk_bf16_f32 v121, v62, v63
  v_mfma_f32_32x32x16_bf16 v[148:163], v[48:51], v[128:131], v[148:163]
  v_exp_f32 v64, v64
  v_exp_f32 v65, v65
  v_exp_f32 v66, v66
  v_exp_f32 v67, v67
  v_cvt_pk_bf16_f32 v122, v64, v65
  v_cvt_pk_bf16_f32 v123, v66, v67
  v_mfma_f32_32x32x16_bf16 v[100:115], v[24:27], v[8:11], 0
  v_exp_f32 v84, v84
  v_exp_f32 v85, v85
  v_exp_f32 v86, v86
  v_exp_f32 v87, v87
  v_cvt_pk_bf16_f32 v132, v84, v85
  v_cvt_pk_bf16_f32 v133, v86, v87
  v_mfma_f32_32x32x16_bf16 v[164:179], v[44:47], v[140:143], v[164:179]
  v_exp_f32 v88, v88
  v_exp_f32 v89, v89
  v_exp_f32 v90, v90
  v_exp_f32 v91, v91
  v_cvt_pk_bf16_f32 v134, v88, v89
  v_cvt_pk_bf16_f32 v135, v90, v91
  v_mfma_f32_32x32x16_bf16 v[100:115], v[32:35], v[16:19], v[100:115]
  v_exp_f32 v92, v92
  v_exp_f32 v93, v93
  v_exp_f32 v94, v94
  v_exp_f32 v95, v95
  v_cvt_pk_bf16_f32 v136, v92, v93
  v_cvt_pk_bf16_f32 v137, v94, v95
  v_mfma_f32_32x32x16_bf16 v[164:179], v[48:51], v[144:147], v[164:179]
  v_exp_f32 v96, v96
  v_exp_f32 v97, v97
  v_exp_f32 v98, v98
  v_exp_f32 v99, v99
  s_waitcnt lgkmcnt(0)
  v_cvt_pk_bf16_f32 v138, v96, v97
  v_cvt_pk_bf16_f32 v139, v98, v99
  v_mfma_f32_32x32x16_bf16 v[52:67], v[20:23], v[4:7], 0
  ds_read_b128 v[24:27], v182 offset:20480
  ds_read_b32 v32, v183 offset:19584
  ds_read_b64_tr_b16 v[44:45], v184 offset:8960
  ds_read_b64_tr_b16 v[46:47], v184 offset:9280
  ds_read_b64_tr_b16 v[48:49], v184 offset:9600
  ds_read_b64_tr_b16 v[50:51], v184 offset:9920
  v_exp_f32 v68, v68
  v_exp_f32 v69, v69
  v_exp_f32 v70, v70
  v_exp_f32 v71, v71
  v_cvt_pk_bf16_f32 v124, v68, v69
  v_cvt_pk_bf16_f32 v125, v70, v71
  v_mfma_f32_32x32x16_bf16 v[148:163], v[36:39], v[116:119], v[148:163]
  v_exp_f32 v72, v72
  v_exp_f32 v73, v73
  v_exp_f32 v74, v74
  v_exp_f32 v75, v75
  v_cvt_pk_bf16_f32 v126, v72, v73
  v_cvt_pk_bf16_f32 v127, v74, v75
  v_mfma_f32_32x32x16_bf16 v[52:67], v[28:31], v[12:15], v[52:67]
  v_exp_f32 v76, v76
  v_exp_f32 v77, v77
  v_exp_f32 v78, v78
  v_exp_f32 v79, v79
  v_cvt_pk_bf16_f32 v128, v76, v77
  v_cvt_pk_bf16_f32 v129, v78, v79
  v_mfma_f32_32x32x16_bf16 v[148:163], v[40:43], v[120:123], v[148:163]
  v_exp_f32 v80, v80
  v_exp_f32 v81, v81
  v_exp_f32 v82, v82
  v_exp_f32 v83, v83
  v_cvt_pk_bf16_f32 v130, v80, v81
  v_cvt_pk_bf16_f32 v131, v82, v83
  v_mfma_f32_32x32x16_bf16 v[84:99], v[20:23], v[8:11], 0
  v_exp_f32 v100, v100
  v_exp_f32 v101, v101
  v_exp_f32 v102, v102
  v_exp_f32 v103, v103
  v_cvt_pk_bf16_f32 v140, v100, v101
  v_cvt_pk_bf16_f32 v141, v102, v103
  v_mfma_f32_32x32x16_bf16 v[164:179], v[36:39], v[132:135], v[164:179]
  v_exp_f32 v104, v104
  v_exp_f32 v105, v105
  v_exp_f32 v106, v106
  v_exp_f32 v107, v107
  v_cvt_pk_bf16_f32 v142, v104, v105
  v_cvt_pk_bf16_f32 v143, v106, v107
  v_mfma_f32_32x32x16_bf16 v[84:99], v[28:31], v[16:19], v[84:99]
  v_exp_f32 v108, v108
  v_exp_f32 v109, v109
  v_exp_f32 v110, v110
  v_exp_f32 v111, v111
  v_cvt_pk_bf16_f32 v144, v108, v109
  v_cvt_pk_bf16_f32 v145, v110, v111
  v_mfma_f32_32x32x16_bf16 v[164:179], v[40:43], v[136:139], v[164:179]
  v_exp_f32 v112, v112
  v_exp_f32 v113, v113
  v_exp_f32 v114, v114
  v_exp_f32 v115, v115
  s_waitcnt lgkmcnt(0)
  v_cvt_pk_bf16_f32 v146, v112, v113
  v_cvt_pk_bf16_f32 v147, v114, v115
  v_add_u32 v182, 19456, v182
  v_add_u32 v183, 19456, v183
  v_add_u32 v184, 19456, v184
  s_setprio 1
  s_waitcnt vmcnt(0)
  s_cmp_ge_u32 s41, 72
  s_cbranch_scc1 attn_kernel_notail2
  s_add_u32 s50, s73, 10321920
  buffer_store_dwordx4 v[224:227], v185, s[52:55], s50 offen sc1
attn_kernel_notail2:
  v_mfma_f32_32x32x16_bf16 v[68:83], v[24:27], v[4:7], 0
  ds_read_b128 v[20:23], v182 offset:2048
  ds_read_b32 v28, v183 offset:256
  ds_read_b64_tr_b16 v[36:37], v184 offset:0
  ds_read_b64_tr_b16 v[38:39], v184 offset:320
  ds_read_b64_tr_b16 v[40:41], v184 offset:640
  ds_read_b64_tr_b16 v[42:43], v184 offset:960
  v_exp_f32 v52, v52
  s_add_u32 s50, s73, 0
  v_exp_f32 v53, v53
  buffer_store_dwordx4 v[196:199], v185, s[52:55], s50 offen sc1
  v_exp_f32 v54, v54
  s_add_u32 s50, s73, 2064384
  v_exp_f32 v55, v55
  buffer_store_dwordx4 v[200:203], v185, s[52:55], s50 offen sc1
  v_cvt_pk_bf16_f32 v116, v52, v53
  v_cvt_pk_bf16_f32 v117, v54, v55
  v_mfma_f32_32x32x16_bf16 v[148:163], v[44:47], v[124:127], v[148:163]
  v_exp_f32 v56, v56
  s_add_u32 s50, s73, 4128768
  v_exp_f32 v57, v57
  buffer_store_dwordx4 v[204:207], v185, s[52:55], s50 offen sc1
  v_exp_f32 v58, v58
  s_add_u32 s50, s73, 6193152
  v_exp_f32 v59, v59
  buffer_store_dwordx4 v[208:211], v185, s[52:55], s50 offen sc1
  v_cvt_pk_bf16_f32 v118, v56, v57
  v_cvt_pk_bf16_f32 v119, v58, v59
  v_mfma_f32_32x32x16_bf16 v[68:83], v[32:35], v[12:15], v[68:83]
  v_exp_f32 v60, v60
  s_add_u32 s50, s73, 8257536
  v_exp_f32 v61, v61
  buffer_store_dwordx4 v[212:215], v185, s[52:55], s50 offen sc1
  v_exp_f32 v62, v62
  s_add_u32 s50, s76, 0
  v_exp_f32 v63, v63
  buffer_store_dwordx4 v[216:219], v185, s[56:59], s50 offen sc1
  v_cvt_pk_bf16_f32 v120, v60, v61
  v_cvt_pk_bf16_f32 v121, v62, v63
  v_mfma_f32_32x32x16_bf16 v[148:163], v[48:51], v[128:131], v[148:163]
  v_exp_f32 v64, v64
  s_add_u32 s50, s76, 589824
  v_exp_f32 v65, v65
  buffer_store_dwordx4 v[220:223], v185, s[56:59], s50 offen sc1
  v_exp_f32 v66, v66
  buffer_store_dwordx4 v[224:227], v185, s[56:59], s78 offen sc1
  v_exp_f32 v67, v67
  v_cvt_pk_bf16_f32 v122, v64, v65
  v_cvt_pk_bf16_f32 v123, v66, v67
  v_mfma_f32_32x32x16_bf16 v[100:115], v[24:27], v[8:11], 0
  v_exp_f32 v84, v84
  v_exp_f32 v85, v85
  v_exp_f32 v86, v86
  v_exp_f32 v87, v87
  v_cvt_pk_bf16_f32 v132, v84, v85
  v_cvt_pk_bf16_f32 v133, v86, v87
  v_mfma_f32_32x32x16_bf16 v[164:179], v[44:47], v[140:143], v[164:179]
  v_exp_f32 v88, v88
  v_exp_f32 v89, v89
  v_exp_f32 v90, v90
  v_exp_f32 v91, v91
  v_cvt_pk_bf16_f32 v134, v88, v89
  v_cvt_pk_bf16_f32 v135, v90, v91
  v_mfma_f32_32x32x16_bf16 v[100:115], v[32:35], v[16:19], v[100:115]
  v_exp_f32 v92, v92
  v_exp_f32 v93, v93
  v_exp_f32 v94, v94
  v_exp_f32 v95, v95
  v_cvt_pk_bf16_f32 v136, v92, v93
  v_cvt_pk_bf16_f32 v137, v94, v95
  v_mfma_f32_32x32x16_bf16 v[164:179], v[48:51], v[144:147], v[164:179]
  v_exp_f32 v96, v96
  v_exp_f32 v97, v97
  v_exp_f32 v98, v98
  v_exp_f32 v99, v99
  s_waitcnt lgkmcnt(0)
  v_cvt_pk_bf16_f32 v138, v96, v97
  v_cvt_pk_bf16_f32 v139, v98, v99
  v_mfma_f32_32x32x16_bf16 v[52:67], v[20:23], v[4:7], 0
  ds_read_b128 v[24:27], v182 offset:3072
  ds_read_b32 v32, v183 offset:384
  ds_read_b64_tr_b16 v[44:45], v184 offset:1280
  ds_read_b64_tr_b16 v[46:47], v184 offset:1600
  ds_read_b64_tr_b16 v[48:49], v184 offset:1920
  ds_read_b64_tr_b16 v[50:51], v184 offset:2240
  v_exp_f32 v68, v68
  v_exp_f32 v69, v69
  v_exp_f32 v70, v70
  v_exp_f32 v71, v71
  v_cvt_pk_bf16_f32 v124, v68, v69
  v_cvt_pk_bf16_f32 v125, v70, v71
  v_mfma_f32_32x32x16_bf16 v[148:163], v[36:39], v[116:119], v[148:163]
  v_exp_f32 v72, v72
  v_exp_f32 v73, v73
  v_exp_f32 v74, v74
  v_exp_f32 v75, v75
  v_cvt_pk_bf16_f32 v126, v72, v73
  v_cvt_pk_bf16_f32 v127, v74, v75
  v_mfma_f32_32x32x16_bf16 v[52:67], v[28:31], v[12:15], v[52:67]
  v_exp_f32 v76, v76
  v_exp_f32 v77, v77
  v_exp_f32 v78, v78
  v_exp_f32 v79, v79
  v_cvt_pk_bf16_f32 v128, v76, v77
  v_cvt_pk_bf16_f32 v129, v78, v79
  v_mfma_f32_32x32x16_bf16 v[148:163], v[40:43], v[120:123], v[148:163]
  v_exp_f32 v80, v80
  v_exp_f32 v81, v81
  v_exp_f32 v82, v82
  v_exp_f32 v83, v83
  v_cvt_pk_bf16_f32 v130, v80, v81
  v_cvt_pk_bf16_f32 v131, v82, v83
  v_mfma_f32_32x32x16_bf16 v[84:99], v[20:23], v[8:11], 0
  v_exp_f32 v100, v100
  v_exp_f32 v101, v101
  v_exp_f32 v102, v102
  v_exp_f32 v103, v103
  v_cvt_pk_bf16_f32 v140, v100, v101
  v_cvt_pk_bf16_f32 v141, v102, v103
  v_mfma_f32_32x32x16_bf16 v[164:179], v[36:39], v[132:135], v[164:179]
  v_exp_f32 v104, v104
  v_exp_f32 v105, v105
  v_exp_f32 v106, v106
  v_exp_f32 v107, v107
  v_cvt_pk_bf16_f32 v142, v104, v105
  v_cvt_pk_bf16_f32 v143, v106, v107
  v_mfma_f32_32x32x16_bf16 v[84:99], v[28:31], v[16:19], v[84:99]
  v_exp_f32 v108, v108
  v_exp_f32 v109, v109
  v_exp_f32 v110, v110
  v_exp_f32 v111, v111
  v_cvt_pk_bf16_f32 v144, v108, v109
  v_cvt_pk_bf16_f32 v145, v110, v111
  v_mfma_f32_32x32x16_bf16 v[164:179], v[40:43], v[136:139], v[164:179]
  v_exp_f32 v112, v112
  v_exp_f32 v113, v113
  v_exp_f32 v114, v114
  v_exp_f32 v115, v115
  s_waitcnt lgkmcnt(0)
  v_cvt_pk_bf16_f32 v146, v112, v113
  v_cvt_pk_bf16_f32 v147, v114, v115
  v_mfma_f32_32x32x16_bf16 v[68:83], v[24:27], v[4:7], 0
  ds_read_b128 v[20:23], v182 offset:4096
  ds_read_b32 v28, v183 offset:512
  ds_read_b64_tr_b16 v[36:37], v184 offset:2560
  ds_read_b64_tr_b16 v[38:39], v184 offset:2880
  ds_read_b64_tr_b16 v[40:41], v184 offset:3200
  ds_read_b64_tr_b16 v[42:43], v184 offset:3520
  v_exp_f32 v52, v52
  v_exp_f32 v53, v53
  v_exp_f32 v54, v54
  v_exp_f32 v55, v55
  v_cvt_pk_bf16_f32 v116, v52, v53
  v_cvt_pk_bf16_f32 v117, v54, v55
  v_mfma_f32_32x32x16_bf16 v[148:163], v[44:47], v[124:127], v[148:163]
  v_exp_f32 v56, v56
  v_exp_f32 v57, v57
  v_exp_f32 v58, v58
  v_exp_f32 v59, v59
  v_cvt_pk_bf16_f32 v118, v56, v57
  v_cvt_pk_bf16_f32 v119, v58, v59
  v_mfma_f32_32x32x16_bf16 v[68:83], v[32:35], v[12:15], v[68:83]
  v_exp_f32 v60, v60
  v_exp_f32 v61, v61
  v_exp_f32 v62, v62
  v_exp_f32 v63, v63
  v_cvt_pk_bf16_f32 v120, v60, v61
  v_cvt_pk_bf16_f32 v121, v62, v63
  v_mfma_f32_32x32x16_bf16 v[148:163], v[48:51], v[128:131], v[148:163]
  v_exp_f32 v64, v64
  v_exp_f32 v65, v65
  v_exp_f32 v66, v66
  v_exp_f32 v67, v67
  v_cvt_pk_bf16_f32 v122, v64, v65
  v_cvt_pk_bf16_f32 v123, v66, v67
  v_mfma_f32_32x32x16_bf16 v[100:115], v[24:27], v[8:11], 0
  v_exp_f32 v84, v84
  v_exp_f32 v85, v85
  v_exp_f32 v86, v86
  v_exp_f32 v87, v87
  v_cvt_pk_bf16_f32 v132, v84, v85
  v_cvt_pk_bf16_f32 v133, v86, v87
  v_mfma_f32_32x32x16_bf16 v[164:179], v[44:47], v[140:143], v[164:179]
  v_exp_f32 v88, v88
  v_exp_f32 v89, v89
  v_exp_f32 v90, v90
  v_exp_f32 v91, v91
  v_cvt_pk_bf16_f32 v134, v88, v89
  v_cvt_pk_bf16_f32 v135, v90, v91
  v_mfma_f32_32x32x16_bf16 v[100:115], v[32:35], v[16:19], v[100:115]
  v_exp_f32 v92, v92
  v_exp_f32 v93, v93
  v_exp_f32 v94, v94
  v_exp_f32 v95, v95
  v_cvt_pk_bf16_f32 v136, v92, v93
  v_cvt_pk_bf16_f32 v137, v94, v95
  v_mfma_f32_32x32x16_bf16 v[164:179], v[48:51], v[144:147], v[164:179]
  v_exp_f32 v96, v96
  v_exp_f32 v97, v97
  v_exp_f32 v98, v98
  v_exp_f32 v99, v99
  s_waitcnt lgkmcnt(0)
  v_cvt_pk_bf16_f32 v138, v96, v97
  v_cvt_pk_bf16_f32 v139, v98, v99
  v_mfma_f32_32x32x16_bf16 v[52:67], v[20:23], v[4:7], 0
  ds_read_b128 v[24:27], v182 offset:5120
  ds_read_b32 v32, v183 offset:640
  ds_read_b64_tr_b16 v[44:45], v184 offset:3840
  ds_read_b64_tr_b16 v[46:47], v184 offset:4160
  ds_read_b64_tr_b16 v[48:49], v184 offset:4480
  ds_read_b64_tr_b16 v[50:51], v184 offset:4800
  v_exp_f32 v68, v68
  v_exp_f32 v69, v69
  v_exp_f32 v70, v70
  v_exp_f32 v71, v71
  v_cvt_pk_bf16_f32 v124, v68, v69
  v_cvt_pk_bf16_f32 v125, v70, v71
  v_mfma_f32_32x32x16_bf16 v[148:163], v[36:39], v[116:119], v[148:163]
  v_exp_f32 v72, v72
  v_exp_f32 v73, v73
  v_exp_f32 v74, v74
  v_exp_f32 v75, v75
  v_cvt_pk_bf16_f32 v126, v72, v73
  v_cvt_pk_bf16_f32 v127, v74, v75
  v_mfma_f32_32x32x16_bf16 v[52:67], v[28:31], v[12:15], v[52:67]
  v_exp_f32 v76, v76
  v_exp_f32 v77, v77
  v_exp_f32 v78, v78
  v_exp_f32 v79, v79
  v_cvt_pk_bf16_f32 v128, v76, v77
  v_cvt_pk_bf16_f32 v129, v78, v79
  v_mfma_f32_32x32x16_bf16 v[148:163], v[40:43], v[120:123], v[148:163]
  v_exp_f32 v80, v80
  v_exp_f32 v81, v81
  v_exp_f32 v82, v82
  v_exp_f32 v83, v83
  v_cvt_pk_bf16_f32 v130, v80, v81
  v_cvt_pk_bf16_f32 v131, v82, v83
  v_mfma_f32_32x32x16_bf16 v[84:99], v[20:23], v[8:11], 0
  v_exp_f32 v100, v100
  v_exp_f32 v101, v101
  v_exp_f32 v102, v102
  v_exp_f32 v103, v103
  v_cvt_pk_bf16_f32 v140, v100, v101
  v_cvt_pk_bf16_f32 v141, v102, v103
  v_mfma_f32_32x32x16_bf16 v[164:179], v[36:39], v[132:135], v[164:179]
  v_exp_f32 v104, v104
  v_exp_f32 v105, v105
  v_exp_f32 v106, v106
  v_exp_f32 v107, v107
  v_cvt_pk_bf16_f32 v142, v104, v105
  v_cvt_pk_bf16_f32 v143, v106, v107
  v_mfma_f32_32x32x16_bf16 v[84:99], v[28:31], v[16:19], v[84:99]
  v_exp_f32 v108, v108
  v_exp_f32 v109, v109
  v_exp_f32 v110, v110
  v_exp_f32 v111, v111
  v_cvt_pk_bf16_f32 v144, v108, v109
  v_cvt_pk_bf16_f32 v145, v110, v111
  v_mfma_f32_32x32x16_bf16 v[164:179], v[40:43], v[136:139], v[164:179]
  v_exp_f32 v112, v112
  v_exp_f32 v113, v113
  v_exp_f32 v114, v114
  v_exp_f32 v115, v115
  s_waitcnt lgkmcnt(0)
  v_cvt_pk_bf16_f32 v146, v112, v113
  v_cvt_pk_bf16_f32 v147, v114, v115
  v_mfma_f32_32x32x16_bf16 v[68:83], v[24:27], v[4:7], 0
  ds_read_b128 v[20:23], v182 offset:6144
  ds_read_b32 v28, v183 offset:768
  ds_read_b64_tr_b16 v[36:37], v184 offset:5120
  ds_read_b64_tr_b16 v[38:39], v184 offset:5440
  ds_read_b64_tr_b16 v[40:41], v184 offset:5760
  ds_read_b64_tr_b16 v[42:43], v184 offset:6080
  v_exp_f32 v52, v52
  v_exp_f32 v53, v53
  v_exp_f32 v54, v54
  v_exp_f32 v55, v55
  v_cvt_pk_bf16_f32 v116, v52, v53
  v_cvt_pk_bf16_f32 v117, v54, v55
  v_mfma_f32_32x32x16_bf16 v[148:163], v[44:47], v[124:127], v[148:163]
  v_exp_f32 v56, v56
  v_exp_f32 v57, v57
  v_exp_f32 v58, v58
  v_exp_f32 v59, v59
  v_cvt_pk_bf16_f32 v118, v56, v57
  v_cvt_pk_bf16_f32 v119, v58, v59
  v_mfma_f32_32x32x16_bf16 v[68:83], v[32:35], v[12:15], v[68:83]
  v_exp_f32 v60, v60
  v_exp_f32 v61, v61
  v_exp_f32 v62, v62
  v_exp_f32 v63, v63
  v_cvt_pk_bf16_f32 v120, v60, v61
  v_cvt_pk_bf16_f32 v121, v62, v63
  v_mfma_f32_32x32x16_bf16 v[148:163], v[48:51], v[128:131], v[148:163]
  v_exp_f32 v64, v64
  v_exp_f32 v65, v65
  v_exp_f32 v66, v66
  v_exp_f32 v67, v67
  v_cvt_pk_bf16_f32 v122, v64, v65
  v_cvt_pk_bf16_f32 v123, v66, v67
  v_mfma_f32_32x32x16_bf16 v[100:115], v[24:27], v[8:11], 0
  v_exp_f32 v84, v84
  v_exp_f32 v85, v85
  v_exp_f32 v86, v86
  v_exp_f32 v87, v87
  v_cvt_pk_bf16_f32 v132, v84, v85
  v_cvt_pk_bf16_f32 v133, v86, v87
  v_mfma_f32_32x32x16_bf16 v[164:179], v[44:47], v[140:143], v[164:179]
  v_exp_f32 v88, v88
  v_exp_f32 v89, v89
  v_exp_f32 v90, v90
  v_exp_f32 v91, v91
  v_cvt_pk_bf16_f32 v134, v88, v89
  v_cvt_pk_bf16_f32 v135, v90, v91
  v_mfma_f32_32x32x16_bf16 v[100:115], v[32:35], v[16:19], v[100:115]
  v_exp_f32 v92, v92
  v_exp_f32 v93, v93
  v_exp_f32 v94, v94
  v_exp_f32 v95, v95
  v_cvt_pk_bf16_f32 v136, v92, v93
  v_cvt_pk_bf16_f32 v137, v94, v95
  v_mfma_f32_32x32x16_bf16 v[164:179], v[48:51], v[144:147], v[164:179]
  v_exp_f32 v96, v96
  v_exp_f32 v97, v97
  v_exp_f32 v98, v98
  v_exp_f32 v99, v99
  s_waitcnt lgkmcnt(0)
  v_cvt_pk_bf16_f32 v138, v96, v97
  v_cvt_pk_bf16_f32 v139, v98, v99
  s_setprio 0
  v_mfma_f32_32x32x16_bf16 v[52:67], v[20:23], v[4:7], 0
  ds_read_b128 v[24:27], v182 offset:7168
  ds_read_b32 v32, v183 offset:896
  ds_read_b64_tr_b16 v[44:45], v184 offset:6400
  ds_read_b64_tr_b16 v[46:47], v184 offset:6720
  ds_read_b64_tr_b16 v[48:49], v184 offset:7040
  ds_read_b64_tr_b16 v[50:51], v184 offset:7360
  v_exp_f32 v68, v68
  v_exp_f32 v69, v69
  v_exp_f32 v70, v70
  v_exp_f32 v71, v71
  v_cvt_pk_bf16_f32 v124, v68, v69
  v_cvt_pk_bf16_f32 v125, v70, v71
  v_mfma_f32_32x32x16_bf16 v[148:163], v[36:39], v[116:119], v[148:163]
  v_exp_f32 v72, v72
  v_exp_f32 v73, v73
  v_exp_f32 v74, v74
  v_exp_f32 v75, v75
  v_cvt_pk_bf16_f32 v126, v72, v73
  v_cvt_pk_bf16_f32 v127, v74, v75
  v_mfma_f32_32x32x16_bf16 v[52:67], v[28:31], v[12:15], v[52:67]
  v_exp_f32 v76, v76
  v_exp_f32 v77, v77
  v_exp_f32 v78, v78
  v_exp_f32 v79, v79
  v_cvt_pk_bf16_f32 v128, v76, v77
  v_cvt_pk_bf16_f32 v129, v78, v79
  v_mfma_f32_32x32x16_bf16 v[148:163], v[40:43], v[120:123], v[148:163]
  v_exp_f32 v80, v80
  v_exp_f32 v81, v81
  v_exp_f32 v82, v82
  v_exp_f32 v83, v83
  v_cvt_pk_bf16_f32 v130, v80, v81
  v_cvt_pk_bf16_f32 v131, v82, v83
  v_mfma_f32_32x32x16_bf16 v[84:99], v[20:23], v[8:11], 0
  v_exp_f32 v100, v100
  v_exp_f32 v101, v101
  v_exp_f32 v102, v102
  v_exp_f32 v103, v103
  v_cvt_pk_bf16_f32 v140, v100, v101
  v_cvt_pk_bf16_f32 v141, v102, v103
  v_mfma_f32_32x32x16_bf16 v[164:179], v[36:39], v[132:135], v[164:179]
  v_exp_f32 v104, v104
  v_exp_f32 v105, v105
  v_exp_f32 v106, v106
  v_exp_f32 v107, v107
  v_cvt_pk_bf16_f32 v142, v104, v105
  v_cvt_pk_bf16_f32 v143, v106, v107
  v_mfma_f32_32x32x16_bf16 v[84:99], v[28:31], v[16:19], v[84:99]
  v_exp_f32 v108, v108
  v_exp_f32 v109, v109
  v_exp_f32 v110, v110
  v_exp_f32 v111, v111
  v_cvt_pk_bf16_f32 v144, v108, v109
  v_cvt_pk_bf16_f32 v145, v110, v111
  v_mfma_f32_32x32x16_bf16 v[164:179], v[40:43], v[136:139], v[164:179]
  v_exp_f32 v112, v112
  v_exp_f32 v113, v113
  v_exp_f32 v114, v114
  v_exp_f32 v115, v115
  s_waitcnt lgkmcnt(0)
  v_cvt_pk_bf16_f32 v146, v112, v113
  v_cvt_pk_bf16_f32 v147, v114, v115
  v_mfma_f32_32x32x16_bf16 v[68:83], v[24:27], v[4:7], 0
  ds_read_b64_tr_b16 v[36:37], v184 offset:7680
  ds_read_b64_tr_b16 v[38:39], v184 offset:8000
  ds_read_b64_tr_b16 v[40:41], v184 offset:8320
  ds_read_b64_tr_b16 v[42:43], v184 offset:8640
  v_exp_f32 v52, v52
  v_exp_f32 v53, v53
  v_exp_f32 v54, v54
  v_exp_f32 v55, v55
  v_cvt_pk_bf16_f32 v116, v52, v53
  v_cvt_pk_bf16_f32 v117, v54, v55
  v_mfma_f32_32x32x16_bf16 v[148:163], v[44:47], v[124:127], v[148:163]
  v_exp_f32 v56, v56
  v_exp_f32 v57, v57
  v_exp_f32 v58, v58
  v_exp_f32 v59, v59
  v_cvt_pk_bf16_f32 v118, v56, v57
  v_cvt_pk_bf16_f32 v119, v58, v59
  v_mfma_f32_32x32x16_bf16 v[68:83], v[32:35], v[12:15], v[68:83]
  v_exp_f32 v60, v60
  v_exp_f32 v61, v61
  v_exp_f32 v62, v62
  v_exp_f32 v63, v63
  v_cvt_pk_bf16_f32 v120, v60, v61
  v_cvt_pk_bf16_f32 v121, v62, v63
  v_mfma_f32_32x32x16_bf16 v[148:163], v[48:51], v[128:131], v[148:163]
  v_exp_f32 v64, v64
  v_exp_f32 v65, v65
  v_exp_f32 v66, v66
  v_exp_f32 v67, v67
  v_cvt_pk_bf16_f32 v122, v64, v65
  v_cvt_pk_bf16_f32 v123, v66, v67
  v_mfma_f32_32x32x16_bf16 v[100:115], v[24:27], v[8:11], 0
  v_exp_f32 v84, v84
  v_exp_f32 v85, v85
  v_exp_f32 v86, v86
  v_exp_f32 v87, v87
  v_cvt_pk_bf16_f32 v132, v84, v85
  v_cvt_pk_bf16_f32 v133, v86, v87
  v_mfma_f32_32x32x16_bf16 v[164:179], v[44:47], v[140:143], v[164:179]
  v_exp_f32 v88, v88
  v_exp_f32 v89, v89
  v_exp_f32 v90, v90
  v_exp_f32 v91, v91
  v_cvt_pk_bf16_f32 v134, v88, v89
  v_cvt_pk_bf16_f32 v135, v90, v91
  v_mfma_f32_32x32x16_bf16 v[100:115], v[32:35], v[16:19], v[100:115]
  v_exp_f32 v92, v92
  v_exp_f32 v93, v93
  v_exp_f32 v94, v94
  v_exp_f32 v95, v95
  v_cvt_pk_bf16_f32 v136, v92, v93
  v_cvt_pk_bf16_f32 v137, v94, v95
  v_mfma_f32_32x32x16_bf16 v[164:179], v[48:51], v[144:147], v[164:179]
  v_exp_f32 v96, v96
  v_exp_f32 v97, v97
  v_exp_f32 v98, v98
  v_exp_f32 v99, v99
  s_waitcnt lgkmcnt(0)
  v_cvt_pk_bf16_f32 v138, v96, v97
  v_cvt_pk_bf16_f32 v139, v98, v99
  ds_read_b64_tr_b16 v[44:45], v184 offset:8960
  ds_read_b64_tr_b16 v[46:47], v184 offset:9280
  ds_read_b64_tr_b16 v[48:49], v184 offset:9600
  ds_read_b64_tr_b16 v[50:51], v184 offset:9920
  v_exp_f32 v68, v68
  v_exp_f32 v69, v69
  v_exp_f32 v70, v70
  v_exp_f32 v71, v71
  v_cvt_pk_bf16_f32 v124, v68, v69
  v_cvt_pk_bf16_f32 v125, v70, v71
  v_mfma_f32_32x32x16_bf16 v[148:163], v[36:39], v[116:119], v[148:163]
  v_exp_f32 v72, v72
  v_exp_f32 v73, v73
  v_exp_f32 v74, v74
  v_exp_f32 v75, v75
  v_cvt_pk_bf16_f32 v126, v72, v73
  v_cvt_pk_bf16_f32 v127, v74, v75
  v_exp_f32 v76, v76
  v_exp_f32 v77, v77
  v_exp_f32 v78, v78
  v_exp_f32 v79, v79
  v_cvt_pk_bf16_f32 v128, v76, v77
  v_cvt_pk_bf16_f32 v129, v78, v79
  v_mfma_f32_32x32x16_bf16 v[148:163], v[40:43], v[120:123], v[148:163]
  v_exp_f32 v80, v80
  v_exp_f32 v81, v81
  v_exp_f32 v82, v82
  v_exp_f32 v83, v83
  v_cvt_pk_bf16_f32 v130, v80, v81
  v_cvt_pk_bf16_f32 v131, v82, v83
  v_exp_f32 v100, v100
  v_exp_f32 v101, v101
  v_exp_f32 v102, v102
  v_exp_f32 v103, v103
  v_cvt_pk_bf16_f32 v140, v100, v101
  v_cvt_pk_bf16_f32 v141, v102, v103
  v_mfma_f32_32x32x16_bf16 v[164:179], v[36:39], v[132:135], v[164:179]
  v_exp_f32 v104, v104
  v_exp_f32 v105, v105
  v_exp_f32 v106, v106
  v_exp_f32 v107, v107
  v_cvt_pk_bf16_f32 v142, v104, v105
  v_cvt_pk_bf16_f32 v143, v106, v107
  v_exp_f32 v108, v108
  v_exp_f32 v109, v109
  v_exp_f32 v110, v110
  v_exp_f32 v111, v111
  v_cvt_pk_bf16_f32 v144, v108, v109
  v_cvt_pk_bf16_f32 v145, v110, v111
  v_mfma_f32_32x32x16_bf16 v[164:179], v[40:43], v[136:139], v[164:179]
  v_exp_f32 v112, v112
  v_exp_f32 v113, v113
  v_exp_f32 v114, v114
  v_exp_f32 v115, v115
  s_waitcnt lgkmcnt(0)
  v_cvt_pk_bf16_f32 v146, v112, v113
  v_cvt_pk_bf16_f32 v147, v114, v115
  s_nop 1
  v_mfma_f32_32x32x16_bf16 v[148:163], v[44:47], v[124:127], v[148:163]
  v_mfma_f32_32x32x16_bf16 v[148:163], v[48:51], v[128:131], v[148:163]
  v_mfma_f32_32x32x16_bf16 v[164:179], v[44:47], v[140:143], v[164:179]
  v_mfma_f32_32x32x16_bf16 v[164:179], v[48:51], v[144:147], v[164:179]
  s_nop 11
  s_mov_b32 s36, 0x5f800000
  v_cmp_gt_f32 vcc, s36, v158
  v_cmp_gt_f32 s[38:39], s36, v174
  s_nop 1
  s_and_b64 vcc, vcc, s[38:39]
  s_cmp_eq_u64 vcc, exec
  s_cbranch_scc0 attn_kernel_slow
attn_kernel_fin:
  s_barrier
  s_mul_i32 s38, s24, 3072
  v_lshlrev_b32 v191, 4, v186
  v_add_u32 v192, s38, v191
  s_xor_b32 s39, s24, 4
  s_mul_i32 s39, s39, 3072
  v_add_u32 v191, s39, v191
  s_cmp_eq_u32 s37, 0
  s_cbranch_scc0 attn_kernel_m1
  v_mov_b32 v175, v181
  ds_write_b128 v192, v[164:167] offset:0
  ds_write_b128 v192, v[168:171] offset:1024
  ds_write_b128 v192, v[172:175] offset:2048
  s_waitcnt lgkmcnt(0)
  s_barrier
  ds_read_b128 v[52:55], v191 offset:0
  ds_read_b128 v[56:59], v191 offset:1024
  ds_read_b128 v[60:63], v191 offset:2048
  s_waitcnt lgkmcnt(0)
  v_min_f32 v189, v180, v63
  v_sub_f32 v190, v189, v180
  v_sub_f32 v189, v189, v63
  v_exp_f32 v190, v190
  v_exp_f32 v189, v189
  s_nop 0
  v_mul_f32 v52, v189, v52
  v_fma_f32 v52, v148, v190, v52
  v_mul_f32 v53, v189, v53
  v_fma_f32 v53, v149, v190, v53
  v_mul_f32 v54, v189, v54
  v_fma_f32 v54, v150, v190, v54
  v_mul_f32 v55, v189, v55
  v_fma_f32 v55, v151, v190, v55
  v_mul_f32 v56, v189, v56
  v_fma_f32 v56, v152, v190, v56
  v_mul_f32 v57, v189, v57
  v_fma_f32 v57, v153, v190, v57
  v_mul_f32 v58, v189, v58
  v_fma_f32 v58, v154, v190, v58
  v_mul_f32 v59, v189, v59
  v_fma_f32 v59, v155, v190, v59
  v_mul_f32 v60, v189, v60
  v_fma_f32 v60, v156, v190, v60
  v_mul_f32 v61, v189, v61
  v_fma_f32 v61, v157, v190, v61
  v_mul_f32 v62, v189, v62
  v_fma_f32 v62, v158, v190, v62
  s_branch attn_kernel_m2
attn_kernel_m1:
  v_mov_b32 v159, v180
  ds_write_b128 v192, v[148:151] offset:0
  ds_write_b128 v192, v[152:155] offset:1024
  ds_write_b128 v192, v[156:159] offset:2048
  s_waitcnt lgkmcnt(0)
  s_barrier
  ds_read_b128 v[52:55], v191 offset:0
  ds_read_b128 v[56:59], v191 offset:1024
  ds_read_b128 v[60:63], v191 offset:2048
  s_waitcnt lgkmcnt(0)
  v_min_f32 v189, v181, v63
  v_sub_f32 v190, v189, v181
  v_sub_f32 v189, v189, v63
  v_exp_f32 v190, v190
  v_exp_f32 v189, v189
  s_nop 0
  v_mul_f32 v52, v189, v52
  v_fma_f32 v52, v164, v190, v52
  v_mul_f32 v53, v189, v53
  v_fma_f32 v53, v165, v190, v53
  v_mul_f32 v54, v189, v54
  v_fma_f32 v54, v166, v190, v54
  v_mul_f32 v55, v189, v55
  v_fma_f32 v55, v167, v190, v55
  v_mul_f32 v56, v189, v56
  v_fma_f32 v56, v168, v190, v56
  v_mul_f32 v57, v189, v57
  v_fma_f32 v57, v169, v190, v57
  v_mul_f32 v58, v189, v58
  v_fma_f32 v58, v170, v190, v58
  v_mul_f32 v59, v189, v59
  v_fma_f32 v59, v171, v190, v59
  v_mul_f32 v60, v189, v60
  v_fma_f32 v60, v172, v190, v60
  v_mul_f32 v61, v189, v61
  v_fma_f32 v61, v173, v190, v61
  v_mul_f32 v62, v189, v62
  v_fma_f32 v62, v174, v190, v62
attn_kernel_m2:
  v_rcp_f32 v189, v62
  s_nop 0
  v_mul_f32 v52, v189, v52
  v_mul_f32 v53, v189, v53
  v_mul_f32 v54, v189, v54
  v_mul_f32 v55, v189, v55
  v_mul_f32 v56, v189, v56
  v_mul_f32 v57, v189, v57
  v_mul_f32 v58, v189, v58
  v_mul_f32 v59, v189, v59
  v_mul_f32 v60, v189, v60
  v_mul_f32 v61, v189, v61
  v_cvt_pk_bf16_f32 v116, v52, v53
  v_cvt_pk_bf16_f32 v117, v54, v55
  v_cvt_pk_bf16_f32 v118, v56, v57
  v_cvt_pk_bf16_f32 v119, v58, v59
  v_cvt_pk_bf16_f32 v120, v60, v61
  s_add_u32 s26, s26, s37
  s_mul_i32 s28, s26, 36
  s_add_u32 s29, s28, s25
  s_lshl_b32 s29, s29, 10
  buffer_store_dwordx4 v[116:119], v185, s[16:19], s29 offen
  s_lshr_b32 s30, s25, 3
  s_add_u32 s28, s28, s30
  s_add_u32 s28, s28, 32
  s_lshl_b32 s28, s28, 10
  s_bfe_u32 s30, s25, 0x10002
  s_lshl_b32 s30, s30, 9
  s_add_u32 s28, s28, s30
  s_and_b32 s30, s25, 3
  s_lshl_b32 s30, s30, 2
  s_add_u32 s28, s28, s30
  v_lshlrev_b32 v190, 4, v188
  buffer_store_dword v120, v190, s[16:19], s28 offen
  s_endpgm
attn_kernel_slow:
  v_subrev_u32 v182, 58368, v182
  v_subrev_u32 v183, 58368, v183
  v_subrev_u32 v184, 58368, v184
  v_mov_b32 v13, 0
  v_mov_b32 v148, 0
  v_mov_b32 v149, 0
  v_mov_b32 v150, 0
  v_mov_b32 v151, 0
  v_mov_b32 v152, 0
  v_mov_b32 v153, 0
  v_mov_b32 v154, 0
  v_mov_b32 v155, 0
  v_mov_b32 v156, 0
  v_mov_b32 v157, 0
  v_mov_b32 v158, 0
  v_mov_b32 v159, 0
  v_mov_b32 v160, 0
  v_mov_b32 v161, 0
  v_mov_b32 v162, 0
  v_mov_b32 v163, 0
  v_mov_b32 v180, 0xff7fffff
  v_mov_b32 v17, 0
  v_mov_b32 v164, 0
  v_mov_b32 v165, 0
  v_mov_b32 v166, 0
  v_mov_b32 v167, 0
  v_mov_b32 v168, 0
  v_mov_b32 v169, 0
  v_mov_b32 v170, 0
  v_mov_b32 v171, 0
  v_mov_b32 v172, 0
  v_mov_b32 v173, 0
  v_mov_b32 v174, 0
  v_mov_b32 v175, 0
  v_mov_b32 v176, 0
  v_mov_b32 v177, 0
  v_mov_b32 v178, 0
  v_mov_b32 v179, 0
  v_mov_b32 v181, 0xff7fffff
  s_mov_b32 s33, 0
attn_kernel_sloop:
  ds_read_b128 v[20:23], v182 offset:0
  ds_read_b32 v28, v183 offset:0
  ds_read_b64_tr_b16 v[36:37], v184 offset:0
  ds_read_b64_tr_b16 v[38:39], v184 offset:320
  ds_read_b64_tr_b16 v[40:41], v184 offset:640
  ds_read_b64_tr_b16 v[42:43], v184 offset:960
  s_waitcnt lgkmcnt(0)
  v_mfma_f32_32x32x16_bf16 v[52:67], v[20:23], v[4:7], 0
  v_mfma_f32_32x32x16_bf16 v[52:67], v[28:31], v[12:15], v[52:67]
  s_nop 11
  v_max3_f32 v189, v52, v53, v54
  v_max3_f32 v189, v189, v55, v56
  v_max3_f32 v189, v189, v57, v58
  v_max3_f32 v189, v189, v59, v60
  v_max3_f32 v189, v189, v61, v62
  v_max3_f32 v189, v189, v63, v64
  v_max3_f32 v189, v189, v65, v66
  v_max3_f32 v189, v189, v67, v180
  v_mov_b32 v190, v189
  s_nop 1
  v_permlane32_swap_b32 v190, v189
  v_max_f32 v189, v189, v190
  v_sub_f32 v190, v180, v189
  v_exp_f32 v190, v190
  v_mov_b32 v180, v189
  v_mul_f32 v148, v190, v148
  v_mul_f32 v149, v190, v149
  v_mul_f32 v150, v190, v150
  v_mul_f32 v151, v190, v151
  v_mul_f32 v152, v190, v152
  v_mul_f32 v153, v190, v153
  v_mul_f32 v154, v190, v154
  v_mul_f32 v155, v190, v155
  v_mul_f32 v156, v190, v156
  v_mul_f32 v157, v190, v157
  v_mul_f32 v158, v190, v158
  v_mul_f32 v159, v190, v159
  v_mul_f32 v160, v190, v160
  v_mul_f32 v161, v190, v161
  v_mul_f32 v162, v190, v162
  v_mul_f32 v163, v190, v163
  v_sub_f32 v52, v52, v189
  v_sub_f32 v53, v53, v189
  v_sub_f32 v54, v54, v189
  v_sub_f32 v55, v55, v189
  v_sub_f32 v56, v56, v189
  v_sub_f32 v57, v57, v189
  v_sub_f32 v58, v58, v189
  v_sub_f32 v59, v59, v189
  v_sub_f32 v60, v60, v189
  v_sub_f32 v61, v61, v189
  v_sub_f32 v62, v62, v189
  v_sub_f32 v63, v63, v189
  v_sub_f32 v64, v64, v189
  v_sub_f32 v65, v65, v189
  v_sub_f32 v66, v66, v189
  v_sub_f32 v67, v67, v189
  v_exp_f32 v52, v52
  v_exp_f32 v53, v53
  v_exp_f32 v54, v54
  v_exp_f32 v55, v55
  v_exp_f32 v56, v56
  v_exp_f32 v57, v57
  v_exp_f32 v58, v58
  v_exp_f32 v59, v59
  v_exp_f32 v60, v60
  v_exp_f32 v61, v61
  v_exp_f32 v62, v62
  v_exp_f32 v63, v63
  v_exp_f32 v64, v64
  v_exp_f32 v65, v65
  v_exp_f32 v66, v66
  v_exp_f32 v67, v67
  s_nop 0
  v_cvt_pk_bf16_f32 v116, v52, v53
  v_cvt_pk_bf16_f32 v117, v54, v55
  v_cvt_pk_bf16_f32 v118, v56, v57
  v_cvt_pk_bf16_f32 v119, v58, v59
  v_cvt_pk_bf16_f32 v120, v60, v61
  v_cvt_pk_bf16_f32 v121, v62, v63
  v_cvt_pk_bf16_f32 v122, v64, v65
  v_cvt_pk_bf16_f32 v123, v66, v67
  s_nop 1
  v_mfma_f32_32x32x16_bf16 v[148:163], v[36:39], v[116:119], v[148:163]
  v_mfma_f32_32x32x16_bf16 v[148:163], v[40:43], v[120:123], v[148:163]
  v_mfma_f32_32x32x16_bf16 v[84:99], v[20:23], v[8:11], 0
  v_mfma_f32_32x32x16_bf16 v[84:99], v[28:31], v[16:19], v[84:99]
  s_nop 11
  v_max3_f32 v189, v84, v85, v86
  v_max3_f32 v189, v189, v87, v88
  v_max3_f32 v189, v189, v89, v90
  v_max3_f32 v189, v189, v91, v92
  v_max3_f32 v189, v189, v93, v94
  v_max3_f32 v189, v189, v95, v96
  v_max3_f32 v189, v189, v97, v98
  v_max3_f32 v189, v189, v99, v181
  v_mov_b32 v190, v189
  s_nop 1
  v_permlane32_swap_b32 v190, v189
  v_max_f32 v189, v189, v190
  v_sub_f32 v190, v181, v189
  v_exp_f32 v190, v190
  v_mov_b32 v181, v189
  v_mul_f32 v164, v190, v164
  v_mul_f32 v165, v190, v165
  v_mul_f32 v166, v190, v166
  v_mul_f32 v167, v190, v167
  v_mul_f32 v168, v190, v168
  v_mul_f32 v169, v190, v169
  v_mul_f32 v170, v190, v170
  v_mul_f32 v171, v190, v171
  v_mul_f32 v172, v190, v172
  v_mul_f32 v173, v190, v173
  v_mul_f32 v174, v190, v174
  v_mul_f32 v175, v190, v175
  v_mul_f32 v176, v190, v176
  v_mul_f32 v177, v190, v177
  v_mul_f32 v178, v190, v178
  v_mul_f32 v179, v190, v179
  v_sub_f32 v84, v84, v189
  v_sub_f32 v85, v85, v189
  v_sub_f32 v86, v86, v189
  v_sub_f32 v87, v87, v189
  v_sub_f32 v88, v88, v189
  v_sub_f32 v89, v89, v189
  v_sub_f32 v90, v90, v189
  v_sub_f32 v91, v91, v189
  v_sub_f32 v92, v92, v189
  v_sub_f32 v93, v93, v189
  v_sub_f32 v94, v94, v189
  v_sub_f32 v95, v95, v189
  v_sub_f32 v96, v96, v189
  v_sub_f32 v97, v97, v189
  v_sub_f32 v98, v98, v189
  v_sub_f32 v99, v99, v189
  v_exp_f32 v84, v84
  v_exp_f32 v85, v85
  v_exp_f32 v86, v86
  v_exp_f32 v87, v87
  v_exp_f32 v88, v88
  v_exp_f32 v89, v89
  v_exp_f32 v90, v90
  v_exp_f32 v91, v91
  v_exp_f32 v92, v92
  v_exp_f32 v93, v93
  v_exp_f32 v94, v94
  v_exp_f32 v95, v95
  v_exp_f32 v96, v96
  v_exp_f32 v97, v97
  v_exp_f32 v98, v98
  v_exp_f32 v99, v99
  s_nop 0
  v_cvt_pk_bf16_f32 v132, v84, v85
  v_cvt_pk_bf16_f32 v133, v86, v87
  v_cvt_pk_bf16_f32 v134, v88, v89
  v_cvt_pk_bf16_f32 v135, v90, v91
  v_cvt_pk_bf16_f32 v136, v92, v93
  v_cvt_pk_bf16_f32 v137, v94, v95
  v_cvt_pk_bf16_f32 v138, v96, v97
  v_cvt_pk_bf16_f32 v139, v98, v99
  s_nop 1
  v_mfma_f32_32x32x16_bf16 v[164:179], v[36:39], v[132:135], v[164:179]
  v_mfma_f32_32x32x16_bf16 v[164:179], v[40:43], v[136:139], v[164:179]
  s_add_u32 s33, s33, 1
  s_and_b32 s36, s33, 7
  s_cmp_eq_u32 s36, 0
  s_mov_b32 s38, 12288
  s_cselect_b32 s38, s38, 1024
  s_mov_b32 s39, 18560
  s_cselect_b32 s39, s39, 128
  s_mov_b32 s42, 10496
  s_cselect_b32 s42, s42, 1280
  v_add_u32 v182, s38, v182
  v_add_u32 v183, s39, v183
  v_add_u32 v184, s42, v184
  s_nop 7
  s_cmp_lt_u32 s33, 32
  s_cbranch_scc1 attn_kernel_sloop
  s_nop 7
  v_sub_f32 v180, 0, v180
  v_sub_f32 v181, 0, v181
  s_branch attn_kernel_fin
attn_kernel_end:
  s_endpgm
.section .rodata,"a"
.p2align 6
.amdhsa_kernel attn_kernel
.amdhsa_next_free_vgpr 238
.amdhsa_next_free_sgpr 100
.amdhsa_accum_offset 240
.amdhsa_group_segment_fixed_size 0
.amdhsa_kernarg_size 80
.amdhsa_user_sgpr_count 2
.amdhsa_user_sgpr_kernarg_segment_ptr 1
.amdhsa_system_sgpr_workgroup_id_x 1
.amdhsa_float_denorm_mode_32 3
.amdhsa_ieee_mode 0
.end_amdhsa_kernel
.text
.globl oproj_kernel
.p2align 8
.type oproj_kernel,@function
oproj_kernel:
  s_cmp_ge_u32 s2, 256
  s_cbranch_scc1 oproj_kernel_end
  s_getpc_b64 s[94:95]
oproj_kernel_pc:
  s_sub_u32 s94, s94, oproj_kernel_pc-code_begin
  s_subb_u32 s95, s95, 0
  v_lshlrev_b32 v218, 7, v0
  v_min_u32 v218, code_end-code_begin-4, v218
  global_load_dword v226, v218, s[94:95]
  v_lshlrev_b32 v218, 7, v0
  v_add_u32 v218, 32768, v218
  v_min_u32 v218, code_end-code_begin-4, v218
  global_load_dword v226, v218, s[94:95]
  s_load_dwordx2 s[4:5], s[0:1], 0
  s_load_dwordx2 s[8:9], s[0:1], 72
  v_lshrrev_b32 v218, 6, v0
  v_and_b32 v210, 63, v0
  v_readfirstlane_b32 s24, v218
  s_and_b32 s25, s2, 7
  s_lshl_b32 s25, s25, 1
  s_bfe_u32 s26, s2, 0x10003
  s_add_u32 s25, s25, s26
  s_lshr_b32 s26, s2, 4
  s_lshl_b32 s27, s25, 2
  s_add_u32 s27, s27, s24
  v_lshrrev_b32 v211, 5, v210
  v_and_b32 v212, 31, v210
  v_lshlrev_b32 v223, 4, v210
  s_waitcnt lgkmcnt(0)
  s_mov_b32 s12, s4
  s_mov_b32 s13, s5
  s_mov_b32 s14, 2359296
  s_mov_b32 s15, 0x00020000
  s_add_u32 s16, s8, 9437184
  s_addc_u32 s17, s9, 0
  s_mov_b32 s18, 737280
  s_mov_b32 s19, 0x00020000
  s_add_u32 s20, s8, 10485760
  s_addc_u32 s21, s9, 0
  s_mov_b32 s22, 2359296
  s_mov_b32 s23, 0x00020000
  s_add_u32 s28, s8, 8454144
  s_addc_u32 s29, s9, 0
  s_mov_b32 s30, 16384
  s_mov_b32 s31, 0x00020000
  s_mul_i32 s32, s26, 46080
  s_lshl_b32 s33, s24, 10
  s_add_u32 s32, s32, s33
  s_add_u32 m0, s33, 0
  s_add_u32 s34, s32, 0
  buffer_load_dwordx4 v223, s[16:19], s34 offen lds
  s_add_u32 m0, s33, 4096
  s_add_u32 s34, s32, 4096
  buffer_load_dwordx4 v223, s[16:19], s34 offen lds
  s_add_u32 m0, s33, 8192
  s_add_u32 s34, s32, 8192
  buffer_load_dwordx4 v223, s[16:19], s34 offen lds
  s_add_u32 m0, s33, 12288
  s_add_u32 s34, s32, 12288
  buffer_load_dwordx4 v223, s[16:19], s34 offen lds
  s_add_u32 m0, s33, 16384
  s_add_u32 s34, s32, 16384
  buffer_load_dwordx4 v223, s[16:19], s34 offen lds
  s_add_u32 m0, s33, 20480
  s_add_u32 s34, s32, 20480
  buffer_load_dwordx4 v223, s[16:19], s34 offen lds
  s_add_u32 m0, s33, 24576
  s_add_u32 s34, s32, 24576
  buffer_load_dwordx4 v223, s[16:19], s34 offen lds
  s_add_u32 m0, s33, 28672
  s_add_u32 s34, s32, 28672
  buffer_load_dwordx4 v223, s[16:19], s34 offen lds
  s_add_u32 m0, s33, 32768
  s_add_u32 s34, s32, 32768
  buffer_load_dwordx4 v223, s[16:19], s34 offen lds
  s_add_u32 m0, s33, 36864
  s_add_u32 s34, s32, 36864
  buffer_load_dwordx4 v223, s[16:19], s34 offen lds
  s_add_u32 m0, s33, 40960
  s_add_u32 s34, s32, 40960
  buffer_load_dwordx4 v223, s[16:19], s34 offen lds
  s_add_u32 m0, s33, 45056
  s_add_u32 s34, s32, 45056
  buffer_load_dwordx4 v223, s[16:19], s34 offen lds
  s_mul_i32 s35, s27, 36864
  buffer_load_dwordx4 v[4:7], v223, s[20:23], s35 offen offset:0
  buffer_load_dwordx4 v[8:11], v223, s[20:23], s35 offen offset:1024
  buffer_load_dwordx4 v[12:15], v223, s[20:23], s35 offen offset:2048
  buffer_load_dwordx4 v[16:19], v223, s[20:23], s35 offen offset:3072
  s_add_u32 s35, s35, 4096
  buffer_load_dwordx4 v[20:23], v223, s[20:23], s35 offen offset:0
  buffer_load_dwordx4 v[24:27], v223, s[20:23], s35 offen offset:1024
  buffer_load_dwordx4 v[28:31], v223, s[20:23], s35 offen offset:2048
  buffer_load_dwordx4 v[32:35], v223, s[20:23], s35 offen offset:3072
  s_mov_b32 s36, 13108
  s_lshl_b32 s37, s27, 5
  s_mul_i32 s37, s37, 1152
  s_mul_i32 s38, s26, 72
  s_add_u32 s37, s37, s38
  s_mul_i32 s38, s24, 3072
  s_add_u32 s38, s38, 49152
  v_bfe_u32 v218, v210, 2, 2
  v_lshl_add_u32 v218, v211, 2, v218
  v_and_b32 v219, 3, v210
  v_bfe_u32 v220, v210, 4, 1
  v_lshlrev_b32 v213, 6, v218
  v_lshl_add_u32 v213, v220, 5, v213
  v_lshl_add_u32 v213, v219, 3, v213
  v_lshlrev_b32 v214, 4, v218
  v_and_b32 v219, 1, v219
  v_lshl_add_u32 v214, v219, 3, v214
  v_add_u32 v214, 36864, v214
  v_mov_b32 v164, 0
  v_mov_b32 v180, 0
  v_mov_b32 v165, 0
  v_mov_b32 v181, 0
  v_mov_b32 v166, 0
  v_mov_b32 v182, 0
  v_mov_b32 v167, 0
  v_mov_b32 v183, 0
  v_mov_b32 v168, 0
  v_mov_b32 v184, 0
  v_mov_b32 v169, 0
  v_mov_b32 v185, 0
  v_mov_b32 v170, 0
  v_mov_b32 v186, 0
  v_mov_b32 v171, 0
  v_mov_b32 v187, 0
  v_mov_b32 v172, 0
  v_mov_b32 v188, 0
  v_mov_b32 v173, 0
  v_mov_b32 v189, 0
  v_mov_b32 v174, 0
  v_mov_b32 v190, 0
  v_mov_b32 v175, 0
  v_mov_b32 v191, 0
  v_mov_b32 v176, 0
  v_mov_b32 v192, 0
  v_mov_b32 v177, 0
  v_mov_b32 v193, 0
  v_mov_b32 v178, 0
  v_mov_b32 v194, 0
  v_mov_b32 v179, 0
  v_mov_b32 v195, 0
  s_waitcnt vmcnt(8)
  s_barrier
  ds_read_b64_tr_b16 v[148:149], v213 offset:0
  ds_read_b64_tr_b16 v[150:151], v213 offset:512
  ds_read_b64_tr_b16 v[156:157], v214 offset:0
  ds_read_b64_tr_b16 v[158:159], v214 offset:128
  s_add_u32 s35, s35, 4096
  buffer_load_dwordx4 v[36:39], v223, s[20:23], s35 offen offset:0
  buffer_load_dwordx4 v[40:43], v223, s[20:23], s35 offen offset:1024
  buffer_load_dwordx4 v[44:47], v223, s[20:23], s35 offen offset:2048
  buffer_load_dwordx4 v[48:51], v223, s[20:23], s35 offen offset:3072
  s_add_u32 s35, s35, 4096
  buffer_load_dwordx4 v[52:55], v223, s[20:23], s35 offen offset:0
  buffer_load_dwordx4 v[56:59], v223, s[20:23], s35 offen offset:1024
  ds_read_b64_tr_b16 v[152:153], v213 offset:1024
  ds_read_b64_tr_b16 v[154:155], v213 offset:1536
  ds_read_b64_tr_b16 v[160:161], v214 offset:256
  ds_read_b64_tr_b16 v[162:163], v214 offset:384
  s_waitcnt vmcnt(13) lgkmcnt(4)
  v_mfma_f32_32x32x16_bf16 v[164:179], v[148:151], v[4:7], v[164:179]
  buffer_load_dwordx4 v[60:63], v223, s[20:23], s35 offen offset:2048
  v_mfma_f32_32x32x16_bf16 v[180:195], v[156:159], v[4:7], v[180:195]
  ds_read_b64_tr_b16 v[148:149], v213 offset:2048
  ds_read_b64_tr_b16 v[150:151], v213 offset:2560
  ds_read_b64_tr_b16 v[156:157], v214 offset:512
  ds_read_b64_tr_b16 v[158:159], v214 offset:640
  s_waitcnt vmcnt(13) lgkmcnt(4)
  v_mfma_f32_32x32x16_bf16 v[164:179], v[152:155], v[8:11], v[164:179]
  buffer_load_dwordx4 v[64:67], v223, s[20:23], s35 offen offset:3072
  v_mfma_f32_32x32x16_bf16 v[180:195], v[160:163], v[8:11], v[180:195]
  ds_read_b64_tr_b16 v[152:153], v213 offset:3072
  ds_read_b64_tr_b16 v[154:155], v213 offset:3584
  ds_read_b64_tr_b16 v[160:161], v214 offset:768
  ds_read_b64_tr_b16 v[162:163], v214 offset:896
  s_waitcnt vmcnt(13) lgkmcnt(4)
  v_mfma_f32_32x32x16_bf16 v[164:179], v[148:151], v[12:15], v[164:179]
  s_add_u32 s35, s35, 4096
  buffer_load_dwordx4 v[68:71], v223, s[20:23], s35 offen offset:0
  v_mfma_f32_32x32x16_bf16 v[180:195], v[156:159], v[12:15], v[180:195]
  ds_read_b64_tr_b16 v[148:149], v213 offset:4096
  ds_read_b64_tr_b16 v[150:151], v213 offset:4608
  ds_read_b64_tr_b16 v[156:157], v214 offset:1024
  ds_read_b64_tr_b16 v[158:159], v214 offset:1152
  s_waitcnt vmcnt(13) lgkmcnt(4)
  v_mfma_f32_32x32x16_bf16 v[164:179], v[152:155], v[16:19], v[164:179]
  buffer_load_dwordx4 v[72:75], v223, s[20:23], s35 offen offset:1024
  v_mfma_f32_32x32x16_bf16 v[180:195], v[160:163], v[16:19], v[180:195]
  ds_read_b64_tr_b16 v[152:153], v213 offset:5120
  ds_read_b64_tr_b16 v[154:155], v213 offset:5632
  ds_read_b64_tr_b16 v[160:161], v214 offset:1280
  ds_read_b64_tr_b16 v[162:163], v214 offset:1408
  s_waitcnt vmcnt(13) lgkmcnt(4)
  v_mfma_f32_32x32x16_bf16 v[164:179], v[148:151], v[20:23], v[164:179]
  buffer_load_dwordx4 v[76:79], v223, s[20:23], s35 offen offset:2048
  v_mfma_f32_32x32x16_bf16 v[180:195], v[156:159], v[20:23], v[180:195]
  ds_read_b64_tr_b16 v[148:149], v213 offset:6144
  ds_read_b64_tr_b16 v[150:151], v213 offset:6656
  ds_read_b64_tr_b16 v[156:157], v214 offset:1536
  ds_read_b64_tr_b16 v[158:159], v214 offset:1664
  s_waitcnt vmcnt(13) lgkmcnt(4)
  v_mfma_f32_32x32x16_bf16 v[164:179], v[152:155], v[24:27], v[164:179]
  buffer_load_dwordx4 v[80:83], v223, s[20:23], s35 offen offset:3072
  v_mfma_f32_32x32x16_bf16 v[180:195], v[160:163], v[24:27], v[180:195]
  ds_read_b64_tr_b16 v[152:153], v213 offset:7168
  ds_read_b64_tr_b16 v[154:155], v213 offset:7680
  ds_read_b64_tr_b16 v[160:161], v214 offset:1792
  ds_read_b64_tr_b16 v[162:163], v214 offset:1920
  s_waitcnt vmcnt(13) lgkmcnt(4)
  v_mfma_f32_32x32x16_bf16 v[164:179], v[148:151], v[28:31], v[164:179]
  s_add_u32 s35, s35, 4096
  buffer_load_dwordx4 v[84:87], v223, s[20:23], s35 offen offset:0
  v_mfma_f32_32x32x16_bf16 v[180:195], v[156:159], v[28:31], v[180:195]
  ds_read_b64_tr_b16 v[148:149], v213 offset:8192
  ds_read_b64_tr_b16 v[150:151], v213 offset:8704
  ds_read_b64_tr_b16 v[156:157], v214 offset:2048
  ds_read_b64_tr_b16 v[158:159], v214 offset:2176
  s_waitcnt vmcnt(13) lgkmcnt(4)
  v_mfma_f32_32x32x16_bf16 v[164:179], v[152:155], v[32:35], v[164:179]
  buffer_load_dwordx4 v[88:91], v223, s[20:23], s35 offen offset:1024
  v_mfma_f32_32x32x16_bf16 v[180:195], v[160:163], v[32:35], v[180:195]
  ds_read_b64_tr_b16 v[152:153], v213 offset:9216
  ds_read_b64_tr_b16 v[154:155], v213 offset:9728
  ds_read_b64_tr_b16 v[160:161], v214 offset:2304
  ds_read_b64_tr_b16 v[162:163], v214 offset:2432
  s_waitcnt vmcnt(13) lgkmcnt(4)
  v_mfma_f32_32x32x16_bf16 v[164:179], v[148:151], v[36:39], v[164:179]
  buffer_load_dwordx4 v[92:95], v223, s[20:23], s35 offen offset:2048
  v_mfma_f32_32x32x16_bf16 v[180:195], v[156:159], v[36:39], v[180:195]
  ds_read_b64_tr_b16 v[148:149], v213 offset:10240
  ds_read_b64_tr_b16 v[150:151], v213 offset:10752
  ds_read_b64_tr_b16 v[156:157], v214 offset:2560
  ds_read_b64_tr_b16 v[158:159], v214 offset:2688
  s_waitcnt vmcnt(13) lgkmcnt(4)
  v_mfma_f32_32x32x16_bf16 v[164:179], v[152:155], v[40:43], v[164:179]
  buffer_load_dwordx4 v[96:99], v223, s[20:23], s35 offen offset:3072
  v_mfma_f32_32x32x16_bf16 v[180:195], v[160:163], v[40:43], v[180:195]
  ds_read_b64_tr_b16 v[152:153], v213 offset:11264
  ds_read_b64_tr_b16 v[154:155], v213 offset:11776
  ds_read_b64_tr_b16 v[160:161], v214 offset:2816
  ds_read_b64_tr_b16 v[162:163], v214 offset:2944
  s_waitcnt vmcnt(13) lgkmcnt(4)
  v_mfma_f32_32x32x16_bf16 v[164:179], v[148:151], v[44:47], v[164:179]
  s_add_u32 s35, s35, 4096
  buffer_load_dwordx4 v[100:103], v223, s[20:23], s35 offen offset:0
  v_mfma_f32_32x32x16_bf16 v[180:195], v[156:159], v[44:47], v[180:195]
  ds_read_b64_tr_b16 v[148:149], v213 offset:12288
  ds_read_b64_tr_b16 v[150:151], v213 offset:12800
  ds_read_b64_tr_b16 v[156:157], v214 offset:3072
  ds_read_b64_tr_b16 v[158:159], v214 offset:3200
  s_waitcnt vmcnt(13) lgkmcnt(4)
  v_mfma_f32_32x32x16_bf16 v[164:179], v[152:155], v[48:51], v[164:179]
  buffer_load_dwordx4 v[104:107], v223, s[20:23], s35 offen offset:1024
  v_mfma_f32_32x32x16_bf16 v[180:195], v[160:163], v[48:51], v[180:195]
  ds_read_b64_tr_b16 v[152:153], v213 offset:13312
  ds_read_b64_tr_b16 v[154:155], v213 offset:13824
  ds_read_b64_tr_b16 v[160:161], v214 offset:3328
  ds_read_b64_tr_b16 v[162:163], v214 offset:3456
  s_waitcnt vmcnt(13) lgkmcnt(4)
  v_mfma_f32_32x32x16_bf16 v[164:179], v[148:151], v[52:55], v[164:179]
  buffer_load_dwordx4 v[108:111], v223, s[20:23], s35 offen offset:2048
  v_mfma_f32_32x32x16_bf16 v[180:195], v[156:159], v[52:55], v[180:195]
  ds_read_b64_tr_b16 v[148:149], v213 offset:14336
  ds_read_b64_tr_b16 v[150:151], v213 offset:14848
  ds_read_b64_tr_b16 v[156:157], v214 offset:3584
  ds_read_b64_tr_b16 v[158:159], v214 offset:3712
  s_waitcnt vmcnt(13) lgkmcnt(4)
  v_mfma_f32_32x32x16_bf16 v[164:179], v[152:155], v[56:59], v[164:179]
  buffer_load_dwordx4 v[112:115], v223, s[20:23], s35 offen offset:3072
  v_mfma_f32_32x32x16_bf16 v[180:195], v[160:163], v[56:59], v[180:195]
  ds_read_b64_tr_b16 v[152:153], v213 offset:15360
  ds_read_b64_tr_b16 v[154:155], v213 offset:15872
  ds_read_b64_tr_b16 v[160:161], v214 offset:3840
  ds_read_b64_tr_b16 v[162:163], v214 offset:3968
  s_waitcnt vmcnt(13) lgkmcnt(4)
  v_mfma_f32_32x32x16_bf16 v[164:179], v[148:151], v[60:63], v[164:179]
  s_add_u32 s35, s35, 4096
  buffer_load_dwordx4 v[116:119], v223, s[20:23], s35 offen offset:0
  v_mfma_f32_32x32x16_bf16 v[180:195], v[156:159], v[60:63], v[180:195]
  ds_read_b64_tr_b16 v[148:149], v213 offset:16384
  ds_read_b64_tr_b16 v[150:151], v213 offset:16896
  ds_read_b64_tr_b16 v[156:157], v214 offset:4096
  ds_read_b64_tr_b16 v[158:159], v214 offset:4224
  s_waitcnt vmcnt(13) lgkmcnt(4)
  v_mfma_f32_32x32x16_bf16 v[164:179], v[152:155], v[64:67], v[164:179]
  buffer_load_dwordx4 v[120:123], v223, s[20:23], s35 offen offset:1024
  v_mfma_f32_32x32x16_bf16 v[180:195], v[160:163], v[64:67], v[180:195]
  ds_read_b64_tr_b16 v[152:153], v213 offset:17408
  ds_read_b64_tr_b16 v[154:155], v213 offset:17920
  ds_read_b64_tr_b16 v[160:161], v214 offset:4352
  ds_read_b64_tr_b16 v[162:163], v214 offset:4480
  s_waitcnt vmcnt(13) lgkmcnt(4)
  v_mfma_f32_32x32x16_bf16 v[164:179], v[148:151], v[68:71], v[164:179]
  buffer_load_dwordx4 v[124:127], v223, s[20:23], s35 offen offset:2048
  v_mfma_f32_32x32x16_bf16 v[180:195], v[156:159], v[68:71], v[180:195]
  ds_read_b64_tr_b16 v[148:149], v213 offset:18432
  ds_read_b64_tr_b16 v[150:151], v213 offset:18944
  ds_read_b64_tr_b16 v[156:157], v214 offset:4608
  ds_read_b64_tr_b16 v[158:159], v214 offset:4736
  s_waitcnt vmcnt(13) lgkmcnt(4)
  v_mfma_f32_32x32x16_bf16 v[164:179], v[152:155], v[72:75], v[164:179]
  buffer_load_dwordx4 v[128:131], v223, s[20:23], s35 offen offset:3072
  v_mfma_f32_32x32x16_bf16 v[180:195], v[160:163], v[72:75], v[180:195]
  ds_read_b64_tr_b16 v[152:153], v213 offset:19456
  ds_read_b64_tr_b16 v[154:155], v213 offset:19968
  ds_read_b64_tr_b16 v[160:161], v214 offset:4864
  ds_read_b64_tr_b16 v[162:163], v214 offset:4992
  s_waitcnt vmcnt(13) lgkmcnt(4)
  v_mfma_f32_32x32x16_bf16 v[164:179], v[148:151], v[76:79], v[164:179]
  s_add_u32 s35, s35, 4096
  buffer_load_dwordx4 v[132:135], v223, s[20:23], s35 offen offset:0
  v_mfma_f32_32x32x16_bf16 v[180:195], v[156:159], v[76:79], v[180:195]
  ds_read_b64_tr_b16 v[148:149], v213 offset:20480
  ds_read_b64_tr_b16 v[150:151], v213 offset:20992
  ds_read_b64_tr_b16 v[156:157], v214 offset:5120
  ds_read_b64_tr_b16 v[158:159], v214 offset:5248
  s_waitcnt vmcnt(13) lgkmcnt(4)
  v_mfma_f32_32x32x16_bf16 v[164:179], v[152:155], v[80:83], v[164:179]
  buffer_load_dwordx4 v[136:139], v223, s[20:23], s35 offen offset:1024
  v_mfma_f32_32x32x16_bf16 v[180:195], v[160:163], v[80:83], v[180:195]
  ds_read_b64_tr_b16 v[152:153], v213 offset:21504
  ds_read_b64_tr_b16 v[154:155], v213 offset:22016
  ds_read_b64_tr_b16 v[160:161], v214 offset:5376
  ds_read_b64_tr_b16 v[162:163], v214 offset:5504
  s_waitcnt vmcnt(13) lgkmcnt(4)
  v_mfma_f32_32x32x16_bf16 v[164:179], v[148:151], v[84:87], v[164:179]
  buffer_load_dwordx4 v[140:143], v223, s[20:23], s35 offen offset:2048
  v_mfma_f32_32x32x16_bf16 v[180:195], v[156:159], v[84:87], v[180:195]
  ds_read_b64_tr_b16 v[148:149], v213 offset:22528
  ds_read_b64_tr_b16 v[150:151], v213 offset:23040
  ds_read_b64_tr_b16 v[156:157], v214 offset:5632
  ds_read_b64_tr_b16 v[158:159], v214 offset:5760
  s_waitcnt vmcnt(13) lgkmcnt(4)
  v_mfma_f32_32x32x16_bf16 v[164:179], v[152:155], v[88:91], v[164:179]
  buffer_load_dwordx4 v[144:147], v223, s[20:23], s35 offen offset:3072
  v_mfma_f32_32x32x16_bf16 v[180:195], v[160:163], v[88:91], v[180:195]
  ds_read_b64_tr_b16 v[152:153], v213 offset:23552
  ds_read_b64_tr_b16 v[154:155], v213 offset:24064
  ds_read_b64_tr_b16 v[160:161], v214 offset:5888
  ds_read_b64_tr_b16 v[162:163], v214 offset:6016
  s_waitcnt vmcnt(13) lgkmcnt(4)
  v_mfma_f32_32x32x16_bf16 v[164:179], v[148:151], v[92:95], v[164:179]
  v_mfma_f32_32x32x16_bf16 v[180:195], v[156:159], v[92:95], v[180:195]
  ds_read_b64_tr_b16 v[148:149], v213 offset:24576
  ds_read_b64_tr_b16 v[150:151], v213 offset:25088
  ds_read_b64_tr_b16 v[156:157], v214 offset:6144
  ds_read_b64_tr_b16 v[158:159], v214 offset:6272
  s_waitcnt vmcnt(12) lgkmcnt(4)
  v_mfma_f32_32x32x16_bf16 v[164:179], v[152:155], v[96:99], v[164:179]
  v_mfma_f32_32x32x16_bf16 v[180:195], v[160:163], v[96:99], v[180:195]
  ds_read_b64_tr_b16 v[152:153], v213 offset:25600
  ds_read_b64_tr_b16 v[154:155], v213 offset:26112
  ds_read_b64_tr_b16 v[160:161], v214 offset:6400
  ds_read_b64_tr_b16 v[162:163], v214 offset:6528
  s_waitcnt vmcnt(11) lgkmcnt(4)
  v_mfma_f32_32x32x16_bf16 v[164:179], v[148:151], v[100:103], v[164:179]
  v_mfma_f32_32x32x16_bf16 v[180:195], v[156:159], v[100:103], v[180:195]
  v_add_u32 v218, 0, v210
  v_mul_lo_u32 v219, v218, s36
  v_lshrrev_b32 v219, 16, v219
  v_mul_u32_u24 v220, 5, v219
  v_sub_u32 v220, v218, v220
  v_min_u32 v219, 31, v219
  v_mul_u32_u24 v219, 1152, v219
  v_lshl_add_u32 v219, v220, 4, v219
  s_add_u32 m0, s38, 0
  s_nop 0
  buffer_load_dwordx4 v219, s[12:15], s37 offen lds
  ds_read_b64_tr_b16 v[148:149], v213 offset:26624
  ds_read_b64_tr_b16 v[150:151], v213 offset:27136
  ds_read_b64_tr_b16 v[156:157], v214 offset:6656
  ds_read_b64_tr_b16 v[158:159], v214 offset:6784
  s_waitcnt vmcnt(11) lgkmcnt(4)
  v_mfma_f32_32x32x16_bf16 v[164:179], v[152:155], v[104:107], v[164:179]
  v_mfma_f32_32x32x16_bf16 v[180:195], v[160:163], v[104:107], v[180:195]
  v_add_u32 v218, 64, v210
  v_mul_lo_u32 v219, v218, s36
  v_lshrrev_b32 v219, 16, v219
  v_mul_u32_u24 v220, 5, v219
  v_sub_u32 v220, v218, v220
  v_min_u32 v219, 31, v219
  v_mul_u32_u24 v219, 1152, v219
  v_lshl_add_u32 v219, v220, 4, v219
  s_add_u32 m0, s38, 1024
  s_nop 0
  buffer_load_dwordx4 v219, s[12:15], s37 offen lds
  ds_read_b64_tr_b16 v[152:153], v213 offset:27648
  ds_read_b64_tr_b16 v[154:155], v213 offset:28160
  ds_read_b64_tr_b16 v[160:161], v214 offset:6912
  ds_read_b64_tr_b16 v[162:163], v214 offset:7040
  s_waitcnt vmcnt(11) lgkmcnt(4)
  v_mfma_f32_32x32x16_bf16 v[164:179], v[148:151], v[108:111], v[164:179]
  v_mfma_f32_32x32x16_bf16 v[180:195], v[156:159], v[108:111], v[180:195]
  v_add_u32 v218, 128, v210
  v_mul_lo_u32 v219, v218, s36
  v_lshrrev_b32 v219, 16, v219
  v_mul_u32_u24 v220, 5, v219
  v_sub_u32 v220, v218, v220
  v_min_u32 v219, 31, v219
  v_mul_u32_u24 v219, 1152, v219
  v_lshl_add_u32 v219, v220, 4, v219
  s_add_u32 m0, s38, 2048
  s_nop 0
  buffer_load_dwordx4 v219, s[12:15], s37 offen lds
  ds_read_b64_tr_b16 v[148:149], v213 offset:28672
  ds_read_b64_tr_b16 v[150:151], v213 offset:29184
  ds_read_b64_tr_b16 v[156:157], v214 offset:7168
  ds_read_b64_tr_b16 v[158:159], v214 offset:7296
  s_waitcnt vmcnt(11) lgkmcnt(4)
  v_mfma_f32_32x32x16_bf16 v[164:179], v[152:155], v[112:115], v[164:179]
  v_mfma_f32_32x32x16_bf16 v[180:195], v[160:163], v[112:115], v[180:195]
  ds_read_b64_tr_b16 v[152:153], v213 offset:29696
  ds_read_b64_tr_b16 v[154:155], v213 offset:30208
  ds_read_b64_tr_b16 v[160:161], v214 offset:7424
  ds_read_b64_tr_b16 v[162:163], v214 offset:7552
  s_waitcnt vmcnt(10) lgkmcnt(4)
  v_mfma_f32_32x32x16_bf16 v[164:179], v[148:151], v[116:119], v[164:179]
  v_mfma_f32_32x32x16_bf16 v[180:195], v[156:159], v[116:119], v[180:195]
  ds_read_b64_tr_b16 v[148:149], v213 offset:30720
  ds_read_b64_tr_b16 v[150:151], v213 offset:31232
  ds_read_b64_tr_b16 v[156:157], v214 offset:7680
  ds_read_b64_tr_b16 v[158:159], v214 offset:7808
  s_waitcnt vmcnt(9) lgkmcnt(4)
  v_mfma_f32_32x32x16_bf16 v[164:179], v[152:155], v[120:123], v[164:179]
  v_mfma_f32_32x32x16_bf16 v[180:195], v[160:163], v[120:123], v[180:195]
  s_lshl_b32 s39, s27, 8
  v_lshlrev_b32 v218, 3, v212
  buffer_load_dword v215, v218, s[28:31], s39 offen
  ds_read_b64_tr_b16 v[152:153], v213 offset:31744
  ds_read_b64_tr_b16 v[154:155], v213 offset:32256
  ds_read_b64_tr_b16 v[160:161], v214 offset:7936
  ds_read_b64_tr_b16 v[162:163], v214 offset:8064
  s_waitcnt vmcnt(9) lgkmcnt(4)
  v_mfma_f32_32x32x16_bf16 v[164:179], v[148:151], v[124:127], v[164:179]
  v_mfma_f32_32x32x16_bf16 v[180:195], v[156:159], v[124:127], v[180:195]
  ds_read_b64_tr_b16 v[148:149], v213 offset:32768
  ds_read_b64_tr_b16 v[150:151], v213 offset:33280
  ds_read_b64_tr_b16 v[156:157], v214 offset:8192
  ds_read_b64_tr_b16 v[158:159], v214 offset:8320
  s_waitcnt vmcnt(8) lgkmcnt(4)
  v_mfma_f32_32x32x16_bf16 v[164:179], v[152:155], v[128:131], v[164:179]
  v_mfma_f32_32x32x16_bf16 v[180:195], v[160:163], v[128:131], v[180:195]
  ds_read_b64_tr_b16 v[152:153], v213 offset:33792
  ds_read_b64_tr_b16 v[154:155], v213 offset:34304
  ds_read_b64_tr_b16 v[160:161], v214 offset:8448
  ds_read_b64_tr_b16 v[162:163], v214 offset:8576
  s_waitcnt vmcnt(7) lgkmcnt(4)
  v_mfma_f32_32x32x16_bf16 v[164:179], v[148:151], v[132:135], v[164:179]
  v_mfma_f32_32x32x16_bf16 v[180:195], v[156:159], v[132:135], v[180:195]
  ds_read_b64_tr_b16 v[148:149], v213 offset:34816
  ds_read_b64_tr_b16 v[150:151], v213 offset:35328
  ds_read_b64_tr_b16 v[156:157], v214 offset:8704
  ds_read_b64_tr_b16 v[158:159], v214 offset:8832
  s_waitcnt vmcnt(6) lgkmcnt(4)
  v_mfma_f32_32x32x16_bf16 v[164:179], v[152:155], v[136:139], v[164:179]
  v_mfma_f32_32x32x16_bf16 v[180:195], v[160:163], v[136:139], v[180:195]
  ds_read_b64_tr_b16 v[152:153], v213 offset:35840
  ds_read_b64_tr_b16 v[154:155], v213 offset:36352
  ds_read_b64_tr_b16 v[160:161], v214 offset:8960
  ds_read_b64_tr_b16 v[162:163], v214 offset:9088
  s_waitcnt vmcnt(5) lgkmcnt(4)
  v_mfma_f32_32x32x16_bf16 v[164:179], v[148:151], v[140:143], v[164:179]
  v_mfma_f32_32x32x16_bf16 v[180:195], v[156:159], v[140:143], v[180:195]
  s_waitcnt vmcnt(4) lgkmcnt(0)
  v_mfma_f32_32x32x16_bf16 v[164:179], v[152:155], v[144:147], v[164:179]
  v_mfma_f32_32x32x16_bf16 v[180:195], v[160:163], v[144:147], v[180:195]
  s_waitcnt vmcnt(0)
  v_mul_u32_u24 v218, 80, v212
  v_lshl_add_u32 v218, v211, 3, v218
  v_add_u32 v218, s38, v218
  ds_read_b64 v[196:197], v218 offset:0
  ds_read_b64 v[198:199], v218 offset:16
  ds_read_b64 v[200:201], v218 offset:32
  ds_read_b64 v[202:203], v218 offset:48
  ds_read_b64 v[204:205], v218 offset:64
  s_nop 7
  v_add_f32 v219, v180, v181
  v_mov_b32 v220, v219
  s_nop 1
  v_permlane32_swap_b32 v219, v220
  v_add_f32 v217, v220, v215
  v_mov_b32 v216, 0
  s_add_u32 s12, s8, 16777216
  s_addc_u32 s13, s9, 0
  s_mov_b32 s14, 2359296
  s_mov_b32 s15, 0x00020000
  s_add_u32 s16, s8, 13631488
  s_addc_u32 s17, s9, 0
  s_mov_b32 s18, 2359296
  s_mov_b32 s19, 0x00020000
  s_add_u32 s20, s8, 19922944
  s_addc_u32 s21, s9, 0
  s_mov_b32 s22, 131072
  s_mov_b32 s23, 0x00020000
  s_mul_i32 s32, s26, 9
  s_mul_i32 s33, s27, 36864
  v_cmp_gt_u32 s[40:41], 32, v210
  s_waitcnt lgkmcnt(0)
  v_mov_b32 v227, 0x7ff00000
  v_lshlrev_b32 v218, 16, v196
  v_and_b32 v219, 0xffff0000, v196
  v_lshlrev_b32 v220, 16, v197
  v_and_b32 v221, 0xffff0000, v197
  v_add_f32 v218, v218, v164
  v_add_f32 v219, v219, v165
  v_add_f32 v220, v220, v166
  v_add_f32 v221, v221, v167
  v_cvt_pk_bf16_f32 v206, v218, v219
  v_cvt_pk_bf16_f32 v207, v220, v221
  v_add_u32 v222, s32, v211
  v_lshlrev_b32 v223, 8, v222
  v_lshl_add_u32 v223, v212, 3, v223
  v_lshlrev_b32 v218, 16, v206
  v_and_b32 v219, 0xffff0000, v206
  v_lshlrev_b32 v220, 16, v207
  v_and_b32 v221, 0xffff0000, v207
  v_sub_f32 v218, v218, v217
  v_sub_f32 v219, v219, v217
  v_sub_f32 v220, v220, v217
  v_sub_f32 v221, v221, v217
  v_fmac_f32 v216, v218, v218
  v_fmac_f32 v216, v219, v219
  v_fmac_f32 v216, v220, v220
  v_fmac_f32 v216, v221, v221
  v_cvt_pk_bf16_f32 v208, v218, v219
  v_cvt_pk_bf16_f32 v209, v220, v221
  v_lshrrev_b32 v218, 2, v222
  v_lshlrev_b32 v218, 10, v218
  v_and_b32 v219, 1, v222
  v_lshl_add_u32 v218, v219, 9, v218
  v_bfe_u32 v219, v222, 1, 1
  v_lshl_add_u32 v218, v219, 3, v218
  v_lshl_add_u32 v218, v212, 4, v218
  buffer_store_dwordx2 v[208:209], v218, s[16:19], s33 offen
  v_lshlrev_b32 v218, 16, v198
  v_and_b32 v219, 0xffff0000, v198
  v_lshlrev_b32 v220, 16, v199
  v_and_b32 v221, 0xffff0000, v199
  v_add_f32 v218, v218, v168
  v_add_f32 v219, v219, v169
  v_add_f32 v220, v220, v170
  v_add_f32 v221, v221, v171
  v_cvt_pk_bf16_f32 v206, v218, v219
  v_cvt_pk_bf16_f32 v207, v220, v221
  v_add_u32 v222, s32, v211
  v_add_u32 v222, 2, v222
  v_lshlrev_b32 v223, 8, v222
  v_lshl_add_u32 v223, v212, 3, v223
  v_lshlrev_b32 v218, 16, v206
  v_and_b32 v219, 0xffff0000, v206
  v_lshlrev_b32 v220, 16, v207
  v_and_b32 v221, 0xffff0000, v207
  v_sub_f32 v218, v218, v217
  v_sub_f32 v219, v219, v217
  v_sub_f32 v220, v220, v217
  v_sub_f32 v221, v221, v217
  v_fmac_f32 v216, v218, v218
  v_fmac_f32 v216, v219, v219
  v_fmac_f32 v216, v220, v220
  v_fmac_f32 v216, v221, v221
  v_cvt_pk_bf16_f32 v208, v218, v219
  v_cvt_pk_bf16_f32 v209, v220, v221
  v_lshrrev_b32 v218, 2, v222
  v_lshlrev_b32 v218, 10, v218
  v_and_b32 v219, 1, v222
  v_lshl_add_u32 v218, v219, 9, v218
  v_bfe_u32 v219, v222, 1, 1
  v_lshl_add_u32 v218, v219, 3, v218
  v_lshl_add_u32 v218, v212, 4, v218
  buffer_store_dwordx2 v[208:209], v218, s[16:19], s33 offen
  v_lshlrev_b32 v218, 16, v200
  v_and_b32 v219, 0xffff0000, v200
  v_lshlrev_b32 v220, 16, v201
  v_and_b32 v221, 0xffff0000, v201
  v_add_f32 v218, v218, v172
  v_add_f32 v219, v219, v173
  v_add_f32 v220, v220, v174
  v_add_f32 v221, v221, v175
  v_cvt_pk_bf16_f32 v206, v218, v219
  v_cvt_pk_bf16_f32 v207, v220, v221
  v_add_u32 v222, s32, v211
  v_add_u32 v222, 4, v222
  v_lshlrev_b32 v223, 8, v222
  v_lshl_add_u32 v223, v212, 3, v223
  v_lshlrev_b32 v218, 16, v206
  v_and_b32 v219, 0xffff0000, v206
  v_lshlrev_b32 v220, 16, v207
  v_and_b32 v221, 0xffff0000, v207
  v_sub_f32 v218, v218, v217
  v_sub_f32 v219, v219, v217
  v_sub_f32 v220, v220, v217
  v_sub_f32 v221, v221, v217
  v_fmac_f32 v216, v218, v218
  v_fmac_f32 v216, v219, v219
  v_fmac_f32 v216, v220, v220
  v_fmac_f32 v216, v221, v221
  v_cvt_pk_bf16_f32 v208, v218, v219
  v_cvt_pk_bf16_f32 v209, v220, v221
  v_lshrrev_b32 v218, 2, v222
  v_lshlrev_b32 v218, 10, v218
  v_and_b32 v219, 1, v222
  v_lshl_add_u32 v218, v219, 9, v218
  v_bfe_u32 v219, v222, 1, 1
  v_lshl_add_u32 v218, v219, 3, v218
  v_lshl_add_u32 v218, v212, 4, v218
  buffer_store_dwordx2 v[208:209], v218, s[16:19], s33 offen
  v_lshlrev_b32 v218, 16, v202
  v_and_b32 v219, 0xffff0000, v202
  v_lshlrev_b32 v220, 16, v203
  v_and_b32 v221, 0xffff0000, v203
  v_add_f32 v218, v218, v176
  v_add_f32 v219, v219, v177
  v_add_f32 v220, v220, v178
  v_add_f32 v221, v221, v179
  v_cvt_pk_bf16_f32 v206, v218, v219
  v_cvt_pk_bf16_f32 v207, v220, v221
  v_add_u32 v222, s32, v211
  v_add_u32 v222, 6, v222
  v_lshlrev_b32 v223, 8, v222
  v_lshl_add_u32 v223, v212, 3, v223
  v_lshlrev_b32 v218, 16, v206
  v_and_b32 v219, 0xffff0000, v206
  v_lshlrev_b32 v220, 16, v207
  v_and_b32 v221, 0xffff0000, v207
  v_sub_f32 v218, v218, v217
  v_sub_f32 v219, v219, v217
  v_sub_f32 v220, v220, v217
  v_sub_f32 v221, v221, v217
  v_fmac_f32 v216, v218, v218
  v_fmac_f32 v216, v219, v219
  v_fmac_f32 v216, v220, v220
  v_fmac_f32 v216, v221, v221
  v_cvt_pk_bf16_f32 v208, v218, v219
  v_cvt_pk_bf16_f32 v209, v220, v221
  v_lshrrev_b32 v218, 2, v222
  v_lshlrev_b32 v218, 10, v218
  v_and_b32 v219, 1, v222
  v_lshl_add_u32 v218, v219, 9, v218
  v_bfe_u32 v219, v222, 1, 1
  v_lshl_add_u32 v218, v219, 3, v218
  v_lshl_add_u32 v218, v212, 4, v218
  buffer_store_dwordx2 v[208:209], v218, s[16:19], s33 offen
  v_lshlrev_b32 v218, 16, v204
  v_and_b32 v219, 0xffff0000, v204
  v_lshlrev_b32 v220, 16, v205
  v_and_b32 v221, 0xffff0000, v205
  v_add_f32 v218, v218, v180
  v_add_f32 v219, v219, v181
  v_add_f32 v220, v220, v182
  v_add_f32 v221, v221, v183
  v_cvt_pk_bf16_f32 v206, v218, v219
  v_cvt_pk_bf16_f32 v207, v220, v221
  v_add_u32 v222, s32, v211
  v_add_u32 v222, 8, v222
  v_lshlrev_b32 v223, 8, v222
  v_lshl_add_u32 v223, v212, 3, v223
  v_cndmask_b32 v223, v227, v223, s[40:41]
  v_lshlrev_b32 v218, 16, v206
  v_and_b32 v219, 0xffff0000, v206
  v_lshlrev_b32 v220, 16, v207
  v_and_b32 v221, 0xffff0000, v207
  v_sub_f32 v218, v218, v217
  v_sub_f32 v219, v219, v217
  v_sub_f32 v220, v220, v217
  v_sub_f32 v221, v221, v217
  v_cndmask_b32 v218, 0, v218, s[40:41]
  v_cndmask_b32 v219, 0, v219, s[40:41]
  v_cndmask_b32 v220, 0, v220, s[40:41]
  v_cndmask_b32 v221, 0, v221, s[40:41]
  v_fmac_f32 v216, v218, v218
  v_fmac_f32 v216, v219, v219
  v_fmac_f32 v216, v220, v220
  v_fmac_f32 v216, v221, v221
  v_cvt_pk_bf16_f32 v208, v218, v219
  v_cvt_pk_bf16_f32 v209, v220, v221
  v_lshrrev_b32 v218, 2, v222
  v_lshlrev_b32 v218, 10, v218
  v_and_b32 v219, 1, v222
  v_lshl_add_u32 v218, v219, 9, v218
  v_bfe_u32 v219, v222, 1, 1
  v_lshl_add_u32 v218, v219, 3, v218
  v_lshl_add_u32 v218, v212, 4, v218
  v_cndmask_b32 v218, v227, v218, s[40:41]
  buffer_store_dwordx2 v[208:209], v218, s[16:19], s33 offen
  v_mov_b32 v218, v216
  s_nop 1
  v_permlane32_swap_b32 v218, v216
  v_add_f32 v216, v216, v218
  s_cmp_lg_u32 s26, 0
  s_cbranch_scc1 oproj_kernel_nomean
  s_add_u32 s12, s8, 8585216
  s_addc_u32 s13, s9, 0
  s_mov_b32 s14, 8192
  s_mov_b32 s15, 0x00020000
  s_lshl_b32 s34, s27, 7
  v_lshlrev_b32 v218, 2, v212
  buffer_store_dword v217, v218, s[12:15], s34 offen
oproj_kernel_nomean:
  s_lshl_b32 s34, s26, 2
  s_lshl_b32 s35, s27, 11
  s_add_u32 s34, s34, s35
  v_lshlrev_b32 v218, 6, v212
  buffer_store_dword v216, v218, s[20:23], s34 offen
oproj_kernel_end:
  s_endpgm
.section .rodata,"a"
.p2align 6
.amdhsa_kernel oproj_kernel
.amdhsa_next_free_vgpr 228
.amdhsa_next_free_sgpr 100
.amdhsa_accum_offset 228
.amdhsa_group_segment_fixed_size 0
.amdhsa_kernarg_size 80
.amdhsa_user_sgpr_count 2
.amdhsa_user_sgpr_kernarg_segment_ptr 1
.amdhsa_system_sgpr_workgroup_id_x 1
.amdhsa_float_denorm_mode_32 3
.amdhsa_ieee_mode 0
.end_amdhsa_kernel
.text
.globl ffn1_kernel
.p2align 8
.type ffn1_kernel,@function
ffn1_kernel:
  s_cmp_ge_u32 s2, 256
  s_cbranch_scc1 ffn1_kernel_end
  s_getpc_b64 s[94:95]
ffn1_kernel_pc:
  s_sub_u32 s94, s94, ffn1_kernel_pc-code_begin
  s_subb_u32 s95, s95, 0
  v_lshlrev_b32 v1, 7, v0
  v_min_u32 v1, code_end-code_begin-4, v1
  global_load_dword a143, v1, s[94:95]
  s_load_dwordx2 s[8:9], s[0:1], 72
  v_lshrrev_b32 v1, 6, v0
  v_and_b32 v60, 63, v0
  v_readfirstlane_b32 s24, v1
  s_and_b32 s25, s2, 7
  s_lshl_b32 s25, s25, 2
  s_bfe_u32 s26, s2, 0x20003
  s_add_u32 s25, s25, s26
  s_lshr_b32 s26, s2, 5
  s_lshl_b32 s27, s26, 3
  s_add_u32 s27, s27, s24
  v_lshlrev_b32 v111, 4, v60
  s_mul_i32 s32, s25, 9
  s_mul_i32 s33, s32, 36864
  s_mul_i32 s34, s24, 5120
  s_lshl_b32 s99, s24, 12
  s_add_u32 s99, s99, 4096
  s_cmp_lt_u32 s24, 4
  s_cselect_b32 s34, s34, s99
  s_lshr_b32 s42, s34, 10
  s_add_u32 s43, s42, 0
  s_mul_i32 s44, s43, 43691
  s_lshr_b32 s44, s44, 19
  s_mul_i32 s45, s44, 12
  s_sub_u32 s45, s43, s45
  s_mul_i32 s44, s44, 36864
  s_lshl_b32 s45, s45, 10
  s_add_u32 s50, s44, s45
  s_add_u32 s43, s42, 1
  s_mul_i32 s44, s43, 43691
  s_lshr_b32 s44, s44, 19
  s_mul_i32 s45, s44, 12
  s_sub_u32 s45, s43, s45
  s_mul_i32 s44, s44, 36864
  s_lshl_b32 s45, s45, 10
  s_add_u32 s51, s44, s45
  s_add_u32 s43, s42, 2
  s_mul_i32 s44, s43, 43691
  s_lshr_b32 s44, s44, 19
  s_mul_i32 s45, s44, 12
  s_sub_u32 s45, s43, s45
  s_mul_i32 s44, s44, 36864
  s_lshl_b32 s45, s45, 10
  s_add_u32 s52, s44, s45
  s_add_u32 s43, s42, 3
  s_mul_i32 s44, s43, 43691
  s_lshr_b32 s44, s44, 19
  s_mul_i32 s45, s44, 12
  s_sub_u32 s45, s43, s45
  s_mul_i32 s44, s44, 36864
  s_lshl_b32 s45, s45, 10
  s_add_u32 s53, s44, s45
  s_add_u32 s43, s42, 4
  s_mul_i32 s44, s43, 43691
  s_lshr_b32 s44, s44, 19
  s_mul_i32 s45, s44, 12
  s_sub_u32 s45, s43, s45
  s_mul_i32 s44, s44, 36864
  s_lshl_b32 s45, s45, 10
  s_add_u32 s54, s44, s45
  s_mov_b32 s39, s33
  s_add_u32 s33, s33, s34
  s_mul_i32 s35, s27, 36864
  s_waitcnt lgkmcnt(0)
  s_add_u32 s12, s8, 20971520
  s_addc_u32 s13, s9, 0
  s_mov_b32 s14, 10616832
  s_mov_b32 s15, 0x00020000
  s_add_u32 s16, s8, 13631488
  s_addc_u32 s17, s9, 0
  s_mov_b32 s18, 2359296
  s_mov_b32 s19, 0x00020000
  s_add_u32 s28, s8, 19922944
  s_addc_u32 s29, s9, 0
  s_mov_b32 s30, 131072
  s_mov_b32 s31, 0x00020000
  s_add_u32 m0, s50, 0
  s_add_u32 s40, s50, s39
  s_nop 0
  buffer_load_dwordx4 v111, s[12:15], s40 offen lds
  s_add_u32 m0, s51, 0
  s_add_u32 s40, s51, s39
  s_nop 0
  buffer_load_dwordx4 v111, s[12:15], s40 offen lds
  s_add_u32 m0, s52, 0
  s_add_u32 s40, s52, s39
  s_nop 0
  buffer_load_dwordx4 v111, s[12:15], s40 offen lds
  s_add_u32 m0, s53, 0
  s_add_u32 s40, s53, s39
  s_nop 0
  buffer_load_dwordx4 v111, s[12:15], s40 offen lds
  s_cmp_ge_u32 s24, 4
  s_cbranch_scc1 ffn1_kernel_sk1
  s_add_u32 m0, s54, 0
  s_add_u32 s40, s54, s39
  s_nop 0
  buffer_load_dwordx4 v111, s[12:15], s40 offen lds
ffn1_kernel_sk1:
  v_lshrrev_b32 v61, 5, v60
  v_and_b32 v62, 31, v60
  buffer_load_dwordx4 a[0:3], v111, s[16:19], s35 offen offset:0 sc1
  buffer_load_dwordx4 a[4:7], v111, s[16:19], s35 offen offset:1024 sc1
  buffer_load_dwordx4 a[8:11], v111, s[16:19], s35 offen offset:2048 sc1
  buffer_load_dwordx4 a[12:15], v111, s[16:19], s35 offen offset:3072 sc1
  s_add_u32 s35, s35, 4096
  buffer_load_dwordx4 a[16:19], v111, s[16:19], s35 offen offset:0 sc1
  buffer_load_dwordx4 a[20:23], v111, s[16:19], s35 offen offset:1024 sc1
  s_add_u32 s20, s8, 39845888
  s_addc_u32 s21, s9, 0
  s_mov_b32 s22, 18874368
  s_mov_b32 s23, 0x00020000
  s_cmp_lg_u32 s2, 0
  s_cbranch_scc1 ffn1_kernel_nozero
  s_add_u32 s44, s8, 20185088
  s_addc_u32 s45, s9, 0
  s_mov_b32 s46, 8192
  s_mov_b32 s47, 0x00020000
  v_lshlrev_b32 v2, 4, v0
  v_mov_b32 v92, 0
  v_mov_b32 v93, 0
  v_mov_b32 v94, 0
  v_mov_b32 v95, 0
  buffer_store_dwordx4 v[92:95], v2, s[44:47], 0 offen
  s_waitcnt vmcnt(0)
ffn1_kernel_nozero:
  v_bfe_u32 v1, v60, 2, 2
  v_lshl_add_u32 v1, v61, 2, v1
  v_lshlrev_b32 v105, 6, v1
  v_bfe_u32 v2, v60, 4, 1
  v_lshl_add_u32 v105, v2, 5, v105
  v_and_b32 v2, 3, v60
  v_lshl_add_u32 v105, v2, 3, v105
  v_add_u32 v107, 36864, v105
  v_add_u32 v109, 73728, v105
  v_add_u32 v110, 110592, v105
  s_waitcnt vmcnt(6)
  s_mul_i32 s37, s27, 288
  s_add_u32 s37, s37, s32
  s_lshl_b32 s37, s37, 10
  s_barrier
  ds_read_b64_tr_b16 v[68:69], v105 offset:0
  ds_read_b64_tr_b16 v[70:71], v105 offset:512
  ds_read_b64_tr_b16 v[72:73], v107 offset:0
  ds_read_b64_tr_b16 v[74:75], v107 offset:512
  ds_read_b64_tr_b16 v[76:77], v109 offset:0
  ds_read_b64_tr_b16 v[78:79], v109 offset:512
  s_waitcnt vmcnt(5) lgkmcnt(4)
  v_mfma_f32_32x32x16_bf16 v[4:19], v[68:71], a[0:3], 0
  ds_read_b64_tr_b16 v[80:81], v105 offset:1024
  ds_read_b64_tr_b16 v[82:83], v105 offset:1536
  s_waitcnt lgkmcnt(4)
  v_mfma_f32_32x32x16_bf16 v[20:35], v[72:75], a[0:3], 0
  ds_read_b64_tr_b16 v[84:85], v107 offset:1024
  ds_read_b64_tr_b16 v[86:87], v107 offset:1536
  s_waitcnt lgkmcnt(4)
  v_mfma_f32_32x32x16_bf16 v[36:51], v[76:79], a[0:3], 0
  ds_read_b64_tr_b16 v[88:89], v109 offset:1024
  ds_read_b64_tr_b16 v[90:91], v109 offset:1536
  buffer_load_dwordx4 a[24:27], v111, s[16:19], s35 offen offset:2048 sc1
  s_add_u32 m0, s50, 12288
  s_add_u32 s40, s50, s39
  s_add_u32 s40, s40, 12288
  buffer_load_dwordx4 v111, s[12:15], s40 offen lds
  s_waitcnt vmcnt(6) lgkmcnt(4)
  v_mfma_f32_32x32x16_bf16 v[4:19], v[80:83], a[4:7], v[4:19]
  ds_read_b64_tr_b16 v[68:69], v105 offset:2048
  ds_read_b64_tr_b16 v[70:71], v105 offset:2560
  s_waitcnt lgkmcnt(4)
  v_mfma_f32_32x32x16_bf16 v[20:35], v[84:87], a[4:7], v[20:35]
  ds_read_b64_tr_b16 v[72:73], v107 offset:2048
  ds_read_b64_tr_b16 v[74:75], v107 offset:2560
  s_waitcnt lgkmcnt(4)
  v_mfma_f32_32x32x16_bf16 v[36:51], v[88:91], a[4:7], v[36:51]
  ds_read_b64_tr_b16 v[76:77], v109 offset:2048
  ds_read_b64_tr_b16 v[78:79], v109 offset:2560
  buffer_load_dwordx4 a[28:31], v111, s[16:19], s35 offen offset:3072 sc1
  s_add_u32 m0, s51, 12288
  s_add_u32 s40, s51, s39
  s_add_u32 s40, s40, 12288
  buffer_load_dwordx4 v111, s[12:15], s40 offen lds
  s_waitcnt vmcnt(7) lgkmcnt(4)
  v_mfma_f32_32x32x16_bf16 v[4:19], v[68:71], a[8:11], v[4:19]
  ds_read_b64_tr_b16 v[80:81], v105 offset:3072
  ds_read_b64_tr_b16 v[82:83], v105 offset:3584
  s_waitcnt lgkmcnt(4)
  v_mfma_f32_32x32x16_bf16 v[20:35], v[72:75], a[8:11], v[20:35]
  ds_read_b64_tr_b16 v[84:85], v107 offset:3072
  ds_read_b64_tr_b16 v[86:87], v107 offset:3584
  s_waitcnt lgkmcnt(4)
  v_mfma_f32_32x32x16_bf16 v[36:51], v[76:79], a[8:11], v[36:51]
  ds_read_b64_tr_b16 v[88:89], v109 offset:3072
  ds_read_b64_tr_b16 v[90:91], v109 offset:3584
  s_add_u32 s35, s35, 4096
  buffer_load_dwordx4 a[32:35], v111, s[16:19], s35 offen offset:0 sc1
  s_add_u32 m0, s52, 12288
  s_add_u32 s40, s52, s39
  s_add_u32 s40, s40, 12288
  buffer_load_dwordx4 v111, s[12:15], s40 offen lds
  s_waitcnt vmcnt(8) lgkmcnt(4)
  v_mfma_f32_32x32x16_bf16 v[4:19], v[80:83], a[12:15], v[4:19]
  ds_read_b64_tr_b16 v[68:69], v105 offset:4096
  ds_read_b64_tr_b16 v[70:71], v105 offset:4608
  s_waitcnt lgkmcnt(4)
  v_mfma_f32_32x32x16_bf16 v[20:35], v[84:87], a[12:15], v[20:35]
  ds_read_b64_tr_b16 v[72:73], v107 offset:4096
  ds_read_b64_tr_b16 v[74:75], v107 offset:4608
  s_waitcnt lgkmcnt(4)
  v_mfma_f32_32x32x16_bf16 v[36:51], v[88:91], a[12:15], v[36:51]
  ds_read_b64_tr_b16 v[76:77], v109 offset:4096
  ds_read_b64_tr_b16 v[78:79], v109 offset:4608
  buffer_load_dwordx4 a[36:39], v111, s[16:19], s35 offen offset:1024 sc1
  s_add_u32 m0, s53, 12288
  s_add_u32 s40, s53, s39
  s_add_u32 s40, s40, 12288
  buffer_load_dwordx4 v111, s[12:15], s40 offen lds
  s_waitcnt vmcnt(9) lgkmcnt(4)
  v_mfma_f32_32x32x16_bf16 v[4:19], v[68:71], a[16:19], v[4:19]
  ds_read_b64_tr_b16 v[80:81], v105 offset:5120
  ds_read_b64_tr_b16 v[82:83], v105 offset:5632
  s_waitcnt lgkmcnt(4)
  v_mfma_f32_32x32x16_bf16 v[20:35], v[72:75], a[16:19], v[20:35]
  ds_read_b64_tr_b16 v[84:85], v107 offset:5120
  ds_read_b64_tr_b16 v[86:87], v107 offset:5632
  s_waitcnt lgkmcnt(4)
  v_mfma_f32_32x32x16_bf16 v[36:51], v[76:79], a[16:19], v[36:51]
  ds_read_b64_tr_b16 v[88:89], v109 offset:5120
  ds_read_b64_tr_b16 v[90:91], v109 offset:5632
  buffer_load_dwordx4 a[40:43], v111, s[16:19], s35 offen offset:2048 sc1
  s_cmp_ge_u32 s24, 4
  s_cbranch_scc1 ffn1_kernel_sk2
  s_add_u32 m0, s54, 12288
  s_add_u32 s40, s54, s39
  s_add_u32 s40, s40, 12288
  buffer_load_dwordx4 v111, s[12:15], s40 offen lds
ffn1_kernel_sk2:
  s_waitcnt vmcnt(9) lgkmcnt(4)
  v_mfma_f32_32x32x16_bf16 v[4:19], v[80:83], a[20:23], v[4:19]
  ds_read_b64_tr_b16 v[68:69], v105 offset:6144
  ds_read_b64_tr_b16 v[70:71], v105 offset:6656
  s_waitcnt lgkmcnt(4)
  v_mfma_f32_32x32x16_bf16 v[20:35], v[84:87], a[20:23], v[20:35]
  ds_read_b64_tr_b16 v[72:73], v107 offset:6144
  ds_read_b64_tr_b16 v[74:75], v107 offset:6656
  s_waitcnt lgkmcnt(4)
  v_mfma_f32_32x32x16_bf16 v[36:51], v[88:91], a[20:23], v[36:51]
  ds_read_b64_tr_b16 v[76:77], v109 offset:6144
  ds_read_b64_tr_b16 v[78:79], v109 offset:6656
  buffer_load_dwordx4 a[44:47], v111, s[16:19], s35 offen offset:3072 sc1
  s_waitcnt vmcnt(9) lgkmcnt(4)
  v_mfma_f32_32x32x16_bf16 v[4:19], v[68:71], a[24:27], v[4:19]
  ds_read_b64_tr_b16 v[80:81], v105 offset:7168
  ds_read_b64_tr_b16 v[82:83], v105 offset:7680
  s_waitcnt lgkmcnt(4)
  v_mfma_f32_32x32x16_bf16 v[20:35], v[72:75], a[24:27], v[20:35]
  ds_read_b64_tr_b16 v[84:85], v107 offset:7168
  ds_read_b64_tr_b16 v[86:87], v107 offset:7680
  s_waitcnt lgkmcnt(4)
  v_mfma_f32_32x32x16_bf16 v[36:51], v[76:79], a[24:27], v[36:51]
  ds_read_b64_tr_b16 v[88:89], v109 offset:7168
  ds_read_b64_tr_b16 v[90:91], v109 offset:7680
  s_add_u32 s35, s35, 4096
  buffer_load_dwordx4 a[48:51], v111, s[16:19], s35 offen offset:0 sc1
  s_waitcnt vmcnt(8) lgkmcnt(4)
  v_mfma_f32_32x32x16_bf16 v[4:19], v[80:83], a[28:31], v[4:19]
  ds_read_b64_tr_b16 v[68:69], v105 offset:8192
  ds_read_b64_tr_b16 v[70:71], v105 offset:8704
  s_waitcnt lgkmcnt(4)
  v_mfma_f32_32x32x16_bf16 v[20:35], v[84:87], a[28:31], v[20:35]
  ds_read_b64_tr_b16 v[72:73], v107 offset:8192
  ds_read_b64_tr_b16 v[74:75], v107 offset:8704
  s_waitcnt lgkmcnt(4)
  v_mfma_f32_32x32x16_bf16 v[36:51], v[88:91], a[28:31], v[36:51]
  ds_read_b64_tr_b16 v[76:77], v109 offset:8192
  ds_read_b64_tr_b16 v[78:79], v109 offset:8704
  buffer_load_dwordx4 a[52:55], v111, s[16:19], s35 offen offset:1024 sc1
  s_waitcnt vmcnt(7) lgkmcnt(4)
  v_mfma_f32_32x32x16_bf16 v[4:19], v[68:71], a[32:35], v[4:19]
  ds_read_b64_tr_b16 v[80:81], v105 offset:9216
  ds_read_b64_tr_b16 v[82:83], v105 offset:9728
  s_waitcnt lgkmcnt(4)
  v_mfma_f32_32x32x16_bf16 v[20:35], v[72:75], a[32:35], v[20:35]
  ds_read_b64_tr_b16 v[84:85], v107 offset:9216
  ds_read_b64_tr_b16 v[86:87], v107 offset:9728
  s_waitcnt lgkmcnt(4)
  v_mfma_f32_32x32x16_bf16 v[36:51], v[76:79], a[32:35], v[36:51]
  ds_read_b64_tr_b16 v[88:89], v109 offset:9216
  ds_read_b64_tr_b16 v[90:91], v109 offset:9728
  buffer_load_dwordx4 a[56:59], v111, s[16:19], s35 offen offset:2048 sc1
  v_lshlrev_b32 v1, 6, v62
  v_lshl_add_u32 v1, v61, 5, v1
  s_lshl_b32 s36, s27, 11
  buffer_load_dwordx4 v[52:55], v1, s[28:31], s36 offen offset:0
  buffer_load_dwordx4 v[56:59], v1, s[28:31], s36 offen offset:16
  s_waitcnt vmcnt(8) lgkmcnt(4)
  v_mfma_f32_32x32x16_bf16 v[4:19], v[80:83], a[36:39], v[4:19]
  ds_read_b64_tr_b16 v[68:69], v105 offset:10240
  ds_read_b64_tr_b16 v[70:71], v105 offset:10752
  s_waitcnt lgkmcnt(4)
  v_mfma_f32_32x32x16_bf16 v[20:35], v[84:87], a[36:39], v[20:35]
  ds_read_b64_tr_b16 v[72:73], v107 offset:10240
  ds_read_b64_tr_b16 v[74:75], v107 offset:10752
  s_waitcnt lgkmcnt(4)
  v_mfma_f32_32x32x16_bf16 v[36:51], v[88:91], a[36:39], v[36:51]
  ds_read_b64_tr_b16 v[76:77], v109 offset:10240
  ds_read_b64_tr_b16 v[78:79], v109 offset:10752
  buffer_load_dwordx4 a[60:63], v111, s[16:19], s35 offen offset:3072 sc1
  s_waitcnt vmcnt(7) lgkmcnt(4)
  v_mfma_f32_32x32x16_bf16 v[4:19], v[68:71], a[40:43], v[4:19]
  ds_read_b64_tr_b16 v[80:81], v105 offset:11264
  ds_read_b64_tr_b16 v[82:83], v105 offset:11776
  s_waitcnt lgkmcnt(4)
  v_mfma_f32_32x32x16_bf16 v[20:35], v[72:75], a[40:43], v[20:35]
  ds_read_b64_tr_b16 v[84:85], v107 offset:11264
  ds_read_b64_tr_b16 v[86:87], v107 offset:11776
  s_waitcnt lgkmcnt(4)
  v_mfma_f32_32x32x16_bf16 v[36:51], v[76:79], a[40:43], v[36:51]
  ds_read_b64_tr_b16 v[88:89], v109 offset:11264
  ds_read_b64_tr_b16 v[90:91], v109 offset:11776
  s_add_u32 s35, s35, 4096
  buffer_load_dwordx4 a[64:67], v111, s[16:19], s35 offen offset:0 sc1
  s_waitcnt vmcnt(8)
  s_barrier
  s_waitcnt vmcnt(7) lgkmcnt(4)
  v_mfma_f32_32x32x16_bf16 v[4:19], v[80:83], a[44:47], v[4:19]
  ds_read_b64_tr_b16 v[68:69], v105 offset:12288
  ds_read_b64_tr_b16 v[70:71], v105 offset:12800
  s_waitcnt lgkmcnt(4)
  v_mfma_f32_32x32x16_bf16 v[20:35], v[84:87], a[44:47], v[20:35]
  ds_read_b64_tr_b16 v[72:73], v107 offset:12288
  ds_read_b64_tr_b16 v[74:75], v107 offset:12800
  s_waitcnt lgkmcnt(4)
  v_mfma_f32_32x32x16_bf16 v[36:51], v[88:91], a[44:47], v[36:51]
  ds_read_b64_tr_b16 v[76:77], v109 offset:12288
  ds_read_b64_tr_b16 v[78:79], v109 offset:12800
  buffer_load_dwordx4 a[68:71], v111, s[16:19], s35 offen offset:1024 sc1
  s_add_u32 m0, s50, 24576
  s_add_u32 s40, s50, s39
  s_add_u32 s40, s40, 24576
  buffer_load_dwordx4 v111, s[12:15], s40 offen lds
  s_waitcnt vmcnt(8) lgkmcnt(4)
  v_mfma_f32_32x32x16_bf16 v[4:19], v[68:71], a[48:51], v[4:19]
  ds_read_b64_tr_b16 v[80:81], v105 offset:13312
  ds_read_b64_tr_b16 v[82:83], v105 offset:13824
  s_waitcnt lgkmcnt(4)
  v_mfma_f32_32x32x16_bf16 v[20:35], v[72:75], a[48:51], v[20:35]
  ds_read_b64_tr_b16 v[84:85], v107 offset:13312
  ds_read_b64_tr_b16 v[86:87], v107 offset:13824
  s_waitcnt lgkmcnt(4)
  v_mfma_f32_32x32x16_bf16 v[36:51], v[76:79], a[48:51], v[36:51]
  ds_read_b64_tr_b16 v[88:89], v109 offset:13312
  ds_read_b64_tr_b16 v[90:91], v109 offset:13824
  buffer_load_dwordx4 a[72:75], v111, s[16:19], s35 offen offset:2048 sc1
  s_add_u32 m0, s51, 24576
  s_add_u32 s40, s51, s39
  s_add_u32 s40, s40, 24576
  buffer_load_dwordx4 v111, s[12:15], s40 offen lds
  s_waitcnt vmcnt(9) lgkmcnt(4)
  v_mfma_f32_32x32x16_bf16 v[4:19], v[80:83], a[52:55], v[4:19]
  ds_read_b64_tr_b16 v[68:69], v105 offset:14336
  ds_read_b64_tr_b16 v[70:71], v105 offset:14848
  s_waitcnt lgkmcnt(4)
  v_mfma_f32_32x32x16_bf16 v[20:35], v[84:87], a[52:55], v[20:35]
  ds_read_b64_tr_b16 v[72:73], v107 offset:14336
  ds_read_b64_tr_b16 v[74:75], v107 offset:14848
  s_waitcnt lgkmcnt(4)
  v_mfma_f32_32x32x16_bf16 v[36:51], v[88:91], a[52:55], v[36:51]
  ds_read_b64_tr_b16 v[76:77], v109 offset:14336
  ds_read_b64_tr_b16 v[78:79], v109 offset:14848
  buffer_load_dwordx4 a[76:79], v111, s[16:19], s35 offen offset:3072 sc1
  s_add_u32 m0, s52, 24576
  s_add_u32 s40, s52, s39
  s_add_u32 s40, s40, 24576
  buffer_load_dwordx4 v111, s[12:15], s40 offen lds
  s_waitcnt vmcnt(10) lgkmcnt(4)
  v_mfma_f32_32x32x16_bf16 v[4:19], v[68:71], a[56:59], v[4:19]
  ds_read_b64_tr_b16 v[80:81], v105 offset:15360
  ds_read_b64_tr_b16 v[82:83], v105 offset:15872
  s_waitcnt lgkmcnt(4)
  v_mfma_f32_32x32x16_bf16 v[20:35], v[72:75], a[56:59], v[20:35]
  ds_read_b64_tr_b16 v[84:85], v107 offset:15360
  ds_read_b64_tr_b16 v[86:87], v107 offset:15872
  s_waitcnt lgkmcnt(4)
  v_mfma_f32_32x32x16_bf16 v[36:51], v[76:79], a[56:59], v[36:51]
  ds_read_b64_tr_b16 v[88:89], v109 offset:15360
  ds_read_b64_tr_b16 v[90:91], v109 offset:15872
  s_add_u32 s35, s35, 4096
  buffer_load_dwordx4 a[80:83], v111, s[16:19], s35 offen offset:0 sc1
  s_add_u32 m0, s53, 24576
  s_add_u32 s40, s53, s39
  s_add_u32 s40, s40, 24576
  buffer_load_dwordx4 v111, s[12:15], s40 offen lds
  s_waitcnt vmcnt(9) lgkmcnt(4)
  v_mfma_f32_32x32x16_bf16 v[4:19], v[80:83], a[60:63], v[4:19]
  ds_read_b64_tr_b16 v[68:69], v105 offset:16384
  ds_read_b64_tr_b16 v[70:71], v105 offset:16896
  s_waitcnt lgkmcnt(4)
  v_mfma_f32_32x32x16_bf16 v[20:35], v[84:87], a[60:63], v[20:35]
  ds_read_b64_tr_b16 v[72:73], v107 offset:16384
  ds_read_b64_tr_b16 v[74:75], v107 offset:16896
  s_waitcnt lgkmcnt(4)
  v_mfma_f32_32x32x16_bf16 v[36:51], v[88:91], a[60:63], v[36:51]
  ds_read_b64_tr_b16 v[76:77], v109 offset:16384
  ds_read_b64_tr_b16 v[78:79], v109 offset:16896
  buffer_load_dwordx4 a[84:87], v111, s[16:19], s35 offen offset:1024 sc1
  s_cmp_ge_u32 s24, 4
  s_cbranch_scc1 ffn1_kernel_sk3
  s_add_u32 m0, s54, 24576
  s_add_u32 s40, s54, s39
  s_add_u32 s40, s40, 24576
  buffer_load_dwordx4 v111, s[12:15], s40 offen lds
ffn1_kernel_sk3:
  s_waitcnt vmcnt(9) lgkmcnt(4)
  v_mfma_f32_32x32x16_bf16 v[4:19], v[68:71], a[64:67], v[4:19]
  ds_read_b64_tr_b16 v[80:81], v105 offset:17408
  ds_read_b64_tr_b16 v[82:83], v105 offset:17920
  s_waitcnt lgkmcnt(4)
  v_mfma_f32_32x32x16_bf16 v[20:35], v[72:75], a[64:67], v[20:35]
  ds_read_b64_tr_b16 v[84:85], v107 offset:17408
  ds_read_b64_tr_b16 v[86:87], v107 offset:17920
  s_waitcnt lgkmcnt(4)
  v_mfma_f32_32x32x16_bf16 v[36:51], v[76:79], a[64:67], v[36:51]
  ds_read_b64_tr_b16 v[88:89], v109 offset:17408
  ds_read_b64_tr_b16 v[90:91], v109 offset:17920
  buffer_load_dwordx4 a[88:91], v111, s[16:19], s35 offen offset:2048 sc1
  s_waitcnt vmcnt(9) lgkmcnt(4)
  v_mfma_f32_32x32x16_bf16 v[4:19], v[80:83], a[68:71], v[4:19]
  ds_read_b64_tr_b16 v[68:69], v105 offset:18432
  ds_read_b64_tr_b16 v[70:71], v105 offset:18944
  s_waitcnt lgkmcnt(4)
  v_mfma_f32_32x32x16_bf16 v[20:35], v[84:87], a[68:71], v[20:35]
  ds_read_b64_tr_b16 v[72:73], v107 offset:18432
  ds_read_b64_tr_b16 v[74:75], v107 offset:18944
  s_waitcnt lgkmcnt(4)
  v_mfma_f32_32x32x16_bf16 v[36:51], v[88:91], a[68:71], v[36:51]
  ds_read_b64_tr_b16 v[76:77], v109 offset:18432
  ds_read_b64_tr_b16 v[78:79], v109 offset:18944
  buffer_load_dwordx4 a[92:95], v111, s[16:19], s35 offen offset:3072 sc1
  s_waitcnt vmcnt(8) lgkmcnt(4)
  v_mfma_f32_32x32x16_bf16 v[4:19], v[68:71], a[72:75], v[4:19]
  ds_read_b64_tr_b16 v[80:81], v105 offset:19456
  ds_read_b64_tr_b16 v[82:83], v105 offset:19968
  s_waitcnt lgkmcnt(4)
  v_mfma_f32_32x32x16_bf16 v[20:35], v[72:75], a[72:75], v[20:35]
  ds_read_b64_tr_b16 v[84:85], v107 offset:19456
  ds_read_b64_tr_b16 v[86:87], v107 offset:19968
  s_waitcnt lgkmcnt(4)
  v_mfma_f32_32x32x16_bf16 v[36:51], v[76:79], a[72:75], v[36:51]
  ds_read_b64_tr_b16 v[88:89], v109 offset:19456
  ds_read_b64_tr_b16 v[90:91], v109 offset:19968
  s_add_u32 s35, s35, 4096
  buffer_load_dwordx4 a[96:99], v111, s[16:19], s35 offen offset:0 sc1
  s_waitcnt vmcnt(7) lgkmcnt(4)
  v_mfma_f32_32x32x16_bf16 v[4:19], v[80:83], a[76:79], v[4:19]
  ds_read_b64_tr_b16 v[68:69], v105 offset:20480
  ds_read_b64_tr_b16 v[70:71], v105 offset:20992
  s_waitcnt lgkmcnt(4)
  v_mfma_f32_32x32x16_bf16 v[20:35], v[84:87], a[76:79], v[20:35]
  ds_read_b64_tr_b16 v[72:73], v107 offset:20480
  ds_read_b64_tr_b16 v[74:75], v107 offset:20992
  s_waitcnt lgkmcnt(4)
  v_mfma_f32_32x32x16_bf16 v[36:51], v[88:91], a[76:79], v[36:51]
  ds_read_b64_tr_b16 v[76:77], v109 offset:20480
  ds_read_b64_tr_b16 v[78:79], v109 offset:20992
  buffer_load_dwordx4 a[100:103], v111, s[16:19], s35 offen offset:1024 sc1
  s_waitcnt vmcnt(6) lgkmcnt(4)
  v_mfma_f32_32x32x16_bf16 v[4:19], v[68:71], a[80:83], v[4:19]
  ds_read_b64_tr_b16 v[80:81], v105 offset:21504
  ds_read_b64_tr_b16 v[82:83], v105 offset:22016
  s_waitcnt lgkmcnt(4)
  v_mfma_f32_32x32x16_bf16 v[20:35], v[72:75], a[80:83], v[20:35]
  ds_read_b64_tr_b16 v[84:85], v107 offset:21504
  ds_read_b64_tr_b16 v[86:87], v107 offset:22016
  s_waitcnt lgkmcnt(4)
  v_mfma_f32_32x32x16_bf16 v[36:51], v[76:79], a[80:83], v[36:51]
  ds_read_b64_tr_b16 v[88:89], v109 offset:21504
  ds_read_b64_tr_b16 v[90:91], v109 offset:22016
  buffer_load_dwordx4 a[104:107], v111, s[16:19], s35 offen offset:2048 sc1
  s_waitcnt vmcnt(5) lgkmcnt(4)
  v_mfma_f32_32x32x16_bf16 v[4:19], v[80:83], a[84:87], v[4:19]
  ds_read_b64_tr_b16 v[68:69], v105 offset:22528
  ds_read_b64_tr_b16 v[70:71], v105 offset:23040
  s_waitcnt lgkmcnt(4)
  v_mfma_f32_32x32x16_bf16 v[20:35], v[84:87], a[84:87], v[20:35]
  ds_read_b64_tr_b16 v[72:73], v107 offset:22528
  ds_read_b64_tr_b16 v[74:75], v107 offset:23040
  s_waitcnt lgkmcnt(4)
  v_mfma_f32_32x32x16_bf16 v[36:51], v[88:91], a[84:87], v[36:51]
  ds_read_b64_tr_b16 v[76:77], v109 offset:22528
  ds_read_b64_tr_b16 v[78:79], v109 offset:23040
  buffer_load_dwordx4 a[108:111], v111, s[16:19], s35 offen offset:3072 sc1
  s_waitcnt vmcnt(5) lgkmcnt(4)
  v_mfma_f32_32x32x16_bf16 v[4:19], v[68:71], a[88:91], v[4:19]
  ds_read_b64_tr_b16 v[80:81], v105 offset:23552
  ds_read_b64_tr_b16 v[82:83], v105 offset:24064
  s_waitcnt lgkmcnt(4)
  v_mfma_f32_32x32x16_bf16 v[20:35], v[72:75], a[88:91], v[20:35]
  ds_read_b64_tr_b16 v[84:85], v107 offset:23552
  ds_read_b64_tr_b16 v[86:87], v107 offset:24064
  s_waitcnt lgkmcnt(4)
  v_mfma_f32_32x32x16_bf16 v[36:51], v[76:79], a[88:91], v[36:51]
  ds_read_b64_tr_b16 v[88:89], v109 offset:23552
  ds_read_b64_tr_b16 v[90:91], v109 offset:24064
  s_add_u32 s35, s35, 4096
  buffer_load_dwordx4 a[112:115], v111, s[16:19], s35 offen offset:0 sc1
  s_waitcnt vmcnt(18)
  v_add_f32 v52, v52, v53
  v_add_f32 v52, v52, v54
  v_add_f32 v52, v52, v55
  v_add_f32 v52, v52, v56
  v_add_f32 v52, v52, v57
  v_add_f32 v52, v52, v58
  v_add_f32 v52, v52, v59
  v_mov_b32 v1, v52
  s_nop 1
  v_permlane32_swap_b32 v1, v52
  v_add_f32 v1, v1, v52
  v_mov_b32 v2, 0x3727c5ac
  v_fmac_f32 v2, 0x3ae38e39, v1
  v_mov_b32 v108, v2
  v_rsq_f32 v1, v2
  s_nop 0
  v_mul_f32 v104, 0xc0135761, v1
  v_mul_f32 v2, v1, v1
  v_mul_f32 v2, v2, v1
  v_mul_f32 v106, 0xbdd2d3e8, v2
  s_waitcnt vmcnt(7)
  s_barrier
  s_waitcnt vmcnt(5) lgkmcnt(4)
  v_mfma_f32_32x32x16_bf16 v[4:19], v[80:83], a[92:95], v[4:19]
  ds_read_b64_tr_b16 v[68:69], v105 offset:24576
  ds_read_b64_tr_b16 v[70:71], v105 offset:25088
  s_waitcnt lgkmcnt(4)
  v_mfma_f32_32x32x16_bf16 v[20:35], v[84:87], a[92:95], v[20:35]
  ds_read_b64_tr_b16 v[72:73], v107 offset:24576
  ds_read_b64_tr_b16 v[74:75], v107 offset:25088
  s_waitcnt lgkmcnt(4)
  v_mfma_f32_32x32x16_bf16 v[36:51], v[88:91], a[92:95], v[36:51]
  ds_read_b64_tr_b16 v[76:77], v109 offset:24576
  ds_read_b64_tr_b16 v[78:79], v109 offset:25088
  buffer_load_dwordx4 a[116:119], v111, s[16:19], s35 offen offset:1024 sc1
  s_add_u32 m0, s34, 110592
  s_add_u32 s40, s33, 110592
  buffer_load_dwordx4 v111, s[12:15], s40 offen lds
  s_waitcnt vmcnt(6) lgkmcnt(4)
  v_mfma_f32_32x32x16_bf16 v[4:19], v[68:71], a[96:99], v[4:19]
  ds_read_b64_tr_b16 v[80:81], v105 offset:25600
  ds_read_b64_tr_b16 v[82:83], v105 offset:26112
  s_waitcnt lgkmcnt(4)
  v_mfma_f32_32x32x16_bf16 v[20:35], v[72:75], a[96:99], v[20:35]
  ds_read_b64_tr_b16 v[84:85], v107 offset:25600
  ds_read_b64_tr_b16 v[86:87], v107 offset:26112
  s_waitcnt lgkmcnt(4)
  v_mfma_f32_32x32x16_bf16 v[36:51], v[76:79], a[96:99], v[36:51]
  ds_read_b64_tr_b16 v[88:89], v109 offset:25600
  ds_read_b64_tr_b16 v[90:91], v109 offset:26112
  buffer_load_dwordx4 a[120:123], v111, s[16:19], s35 offen offset:2048 sc1
  buffer_load_dwordx4 v111, s[12:15], s40 offen offset:1024 lds
  s_waitcnt vmcnt(7) lgkmcnt(4)
  v_mfma_f32_32x32x16_bf16 v[4:19], v[80:83], a[100:103], v[4:19]
  ds_read_b64_tr_b16 v[68:69], v105 offset:26624
  ds_read_b64_tr_b16 v[70:71], v105 offset:27136
  s_waitcnt lgkmcnt(4)
  v_mfma_f32_32x32x16_bf16 v[20:35], v[84:87], a[100:103], v[20:35]
  ds_read_b64_tr_b16 v[72:73], v107 offset:26624
  ds_read_b64_tr_b16 v[74:75], v107 offset:27136
  s_waitcnt lgkmcnt(4)
  v_mfma_f32_32x32x16_bf16 v[36:51], v[88:91], a[100:103], v[36:51]
  ds_read_b64_tr_b16 v[76:77], v109 offset:26624
  ds_read_b64_tr_b16 v[78:79], v109 offset:27136
  buffer_load_dwordx4 a[124:127], v111, s[16:19], s35 offen offset:3072 sc1
  buffer_load_dwordx4 v111, s[12:15], s40 offen offset:2048 lds
  s_waitcnt vmcnt(8) lgkmcnt(4)
  v_mfma_f32_32x32x16_bf16 v[4:19], v[68:71], a[104:107], v[4:19]
  ds_read_b64_tr_b16 v[80:81], v105 offset:27648
  ds_read_b64_tr_b16 v[82:83], v105 offset:28160
  s_waitcnt lgkmcnt(4)
  v_mfma_f32_32x32x16_bf16 v[20:35], v[72:75], a[104:107], v[20:35]
  ds_read_b64_tr_b16 v[84:85], v107 offset:27648
  ds_read_b64_tr_b16 v[86:87], v107 offset:28160
  s_waitcnt lgkmcnt(4)
  v_mfma_f32_32x32x16_bf16 v[36:51], v[76:79], a[104:107], v[36:51]
  ds_read_b64_tr_b16 v[88:89], v109 offset:27648
  ds_read_b64_tr_b16 v[90:91], v109 offset:28160
  s_add_u32 s35, s35, 4096
  buffer_load_dwordx4 a[128:131], v111, s[16:19], s35 offen offset:0 sc1
  buffer_load_dwordx4 v111, s[12:15], s40 offen offset:3072 lds
  s_waitcnt vmcnt(9) lgkmcnt(4)
  v_mfma_f32_32x32x16_bf16 v[4:19], v[80:83], a[108:111], v[4:19]
  ds_read_b64_tr_b16 v[68:69], v105 offset:28672
  ds_read_b64_tr_b16 v[70:71], v105 offset:29184
  s_waitcnt lgkmcnt(4)
  v_mfma_f32_32x32x16_bf16 v[20:35], v[84:87], a[108:111], v[20:35]
  ds_read_b64_tr_b16 v[72:73], v107 offset:28672
  ds_read_b64_tr_b16 v[74:75], v107 offset:29184
  s_waitcnt lgkmcnt(4)
  v_mfma_f32_32x32x16_bf16 v[36:51], v[88:91], a[108:111], v[36:51]
  ds_read_b64_tr_b16 v[76:77], v109 offset:28672
  ds_read_b64_tr_b16 v[78:79], v109 offset:29184
  buffer_load_dwordx4 a[132:135], v111, s[16:19], s35 offen offset:1024 sc1
  s_cmp_ge_u32 s24, 4
  s_cbranch_scc1 ffn1_kernel_sk4
  s_add_u32 m0, s34, 114688
  s_add_u32 s40, s33, 114688
  buffer_load_dwordx4 v111, s[12:15], s40 offen lds
ffn1_kernel_sk4:
  s_waitcnt vmcnt(9) lgkmcnt(4)
  v_mfma_f32_32x32x16_bf16 v[4:19], v[68:71], a[112:115], v[4:19]
  ds_read_b64_tr_b16 v[80:81], v105 offset:29696
  ds_read_b64_tr_b16 v[82:83], v105 offset:30208
  s_waitcnt lgkmcnt(4)
  v_mfma_f32_32x32x16_bf16 v[20:35], v[72:75], a[112:115], v[20:35]
  ds_read_b64_tr_b16 v[84:85], v107 offset:29696
  ds_read_b64_tr_b16 v[86:87], v107 offset:30208
  s_waitcnt lgkmcnt(4)
  v_mfma_f32_32x32x16_bf16 v[36:51], v[76:79], a[112:115], v[36:51]
  ds_read_b64_tr_b16 v[88:89], v109 offset:29696
  ds_read_b64_tr_b16 v[90:91], v109 offset:30208
  buffer_load_dwordx4 a[136:139], v111, s[16:19], s35 offen offset:2048 sc1
  s_waitcnt vmcnt(9) lgkmcnt(4)
  v_mfma_f32_32x32x16_bf16 v[4:19], v[80:83], a[116:119], v[4:19]
  ds_read_b64_tr_b16 v[68:69], v105 offset:30720
  ds_read_b64_tr_b16 v[70:71], v105 offset:31232
  s_waitcnt lgkmcnt(4)
  v_mfma_f32_32x32x16_bf16 v[20:35], v[84:87], a[116:119], v[20:35]
  ds_read_b64_tr_b16 v[72:73], v107 offset:30720
  ds_read_b64_tr_b16 v[74:75], v107 offset:31232
  s_waitcnt lgkmcnt(4)
  v_mfma_f32_32x32x16_bf16 v[36:51], v[88:91], a[116:119], v[36:51]
  ds_read_b64_tr_b16 v[76:77], v109 offset:30720
  ds_read_b64_tr_b16 v[78:79], v109 offset:31232
  buffer_load_dwordx4 a[140:143], v111, s[16:19], s35 offen offset:3072 sc1
  s_waitcnt vmcnt(8) lgkmcnt(4)
  v_mfma_f32_32x32x16_bf16 v[4:19], v[68:71], a[120:123], v[4:19]
  ds_read_b64_tr_b16 v[80:81], v105 offset:31744
  ds_read_b64_tr_b16 v[82:83], v105 offset:32256
  s_waitcnt lgkmcnt(4)
  v_mfma_f32_32x32x16_bf16 v[20:35], v[72:75], a[120:123], v[20:35]
  ds_read_b64_tr_b16 v[84:85], v107 offset:31744
  ds_read_b64_tr_b16 v[86:87], v107 offset:32256
  s_waitcnt lgkmcnt(4)
  v_mfma_f32_32x32x16_bf16 v[36:51], v[76:79], a[120:123], v[36:51]
  ds_read_b64_tr_b16 v[88:89], v109 offset:31744
  ds_read_b64_tr_b16 v[90:91], v109 offset:32256
  s_waitcnt vmcnt(6) lgkmcnt(4)
  v_mfma_f32_32x32x16_bf16 v[4:19], v[80:83], a[124:127], v[4:19]
  ds_read_b64_tr_b16 v[68:69], v105 offset:32768
  ds_read_b64_tr_b16 v[70:71], v105 offset:33280
  s_waitcnt lgkmcnt(4)
  v_mfma_f32_32x32x16_bf16 v[20:35], v[84:87], a[124:127], v[20:35]
  ds_read_b64_tr_b16 v[72:73], v107 offset:32768
  ds_read_b64_tr_b16 v[74:75], v107 offset:33280
  s_waitcnt lgkmcnt(4)
  v_mfma_f32_32x32x16_bf16 v[36:51], v[88:91], a[124:127], v[36:51]
  ds_read_b64_tr_b16 v[76:77], v109 offset:32768
  ds_read_b64_tr_b16 v[78:79], v109 offset:33280
  s_waitcnt vmcnt(4) lgkmcnt(4)
  v_mfma_f32_32x32x16_bf16 v[4:19], v[68:71], a[128:131], v[4:19]
  ds_read_b64_tr_b16 v[80:81], v105 offset:33792
  ds_read_b64_tr_b16 v[82:83], v105 offset:34304
  s_waitcnt lgkmcnt(4)
  v_mfma_f32_32x32x16_bf16 v[20:35], v[72:75], a[128:131], v[20:35]
  ds_read_b64_tr_b16 v[84:85], v107 offset:33792
  ds_read_b64_tr_b16 v[86:87], v107 offset:34304
  s_waitcnt lgkmcnt(4)
  v_mfma_f32_32x32x16_bf16 v[36:51], v[76:79], a[128:131], v[36:51]
  ds_read_b64_tr_b16 v[88:89], v109 offset:33792
  ds_read_b64_tr_b16 v[90:91], v109 offset:34304
  s_waitcnt vmcnt(2) lgkmcnt(4)
  v_mfma_f32_32x32x16_bf16 v[4:19], v[80:83], a[132:135], v[4:19]
  ds_read_b64_tr_b16 v[68:69], v105 offset:34816
  ds_read_b64_tr_b16 v[70:71], v105 offset:35328
  s_waitcnt lgkmcnt(4)
  v_mfma_f32_32x32x16_bf16 v[20:35], v[84:87], a[132:135], v[20:35]
  ds_read_b64_tr_b16 v[72:73], v107 offset:34816
  ds_read_b64_tr_b16 v[74:75], v107 offset:35328
  s_waitcnt lgkmcnt(4)
  v_mfma_f32_32x32x16_bf16 v[36:51], v[88:91], a[132:135], v[36:51]
  ds_read_b64_tr_b16 v[76:77], v109 offset:34816
  ds_read_b64_tr_b16 v[78:79], v109 offset:35328
  s_waitcnt vmcnt(1) lgkmcnt(4)
  v_mfma_f32_32x32x16_bf16 v[4:19], v[68:71], a[136:139], v[4:19]
  ds_read_b64_tr_b16 v[80:81], v105 offset:35840
  ds_read_b64_tr_b16 v[82:83], v105 offset:36352
  s_waitcnt lgkmcnt(4)
  v_mfma_f32_32x32x16_bf16 v[20:35], v[72:75], a[136:139], v[20:35]
  ds_read_b64_tr_b16 v[84:85], v107 offset:35840
  ds_read_b64_tr_b16 v[86:87], v107 offset:36352
  s_waitcnt lgkmcnt(4)
  v_mfma_f32_32x32x16_bf16 v[36:51], v[76:79], a[136:139], v[36:51]
  ds_read_b64_tr_b16 v[88:89], v109 offset:35840
  ds_read_b64_tr_b16 v[90:91], v109 offset:36352
  s_waitcnt vmcnt(2)
  s_barrier
  s_waitcnt vmcnt(0) lgkmcnt(4)
  v_mfma_f32_32x32x16_bf16 v[4:19], v[80:83], a[140:143], v[4:19]
  ds_read_b64_tr_b16 v[68:69], v110 offset:0
  ds_read_b64_tr_b16 v[70:71], v110 offset:512
  s_waitcnt lgkmcnt(4)
  v_mfma_f32_32x32x16_bf16 v[20:35], v[84:87], a[140:143], v[20:35]
  ds_read_b64_tr_b16 v[72:73], v110 offset:1024
  ds_read_b64_tr_b16 v[74:75], v110 offset:1536
  s_waitcnt lgkmcnt(4)
  v_mfma_f32_32x32x16_bf16 v[36:51], v[88:91], a[140:143], v[36:51]
  ds_read_b64_tr_b16 v[76:77], v110 offset:2048
  ds_read_b64_tr_b16 v[78:79], v110 offset:2560
  s_waitcnt lgkmcnt(4)
  v_mfma_f32_32x32x16_bf16 v[52:67], v[68:71], a[0:3], 0
  s_barrier
  ds_read_b64_tr_b16 v[80:81], v110 offset:3072
  ds_read_b64_tr_b16 v[82:83], v110 offset:3584
  s_waitcnt lgkmcnt(4)
  v_mfma_f32_32x32x16_bf16 v[52:67], v[72:75], a[4:7], v[52:67]
  s_add_u32 m0, s34, 0
  s_add_u32 s40, s33, 147456
  buffer_load_dwordx4 v111, s[12:15], s40 offen lds
  ds_read_b64_tr_b16 v[68:69], v110 offset:4096
  ds_read_b64_tr_b16 v[70:71], v110 offset:4608
  s_waitcnt lgkmcnt(4)
  v_mfma_f32_32x32x16_bf16 v[52:67], v[76:79], a[8:11], v[52:67]
  buffer_load_dwordx4 v111, s[12:15], s40 offen offset:1024 lds
  ds_read_b64_tr_b16 v[72:73], v110 offset:5120
  ds_read_b64_tr_b16 v[74:75], v110 offset:5632
  s_waitcnt lgkmcnt(4)
  v_mfma_f32_32x32x16_bf16 v[52:67], v[80:83], a[12:15], v[52:67]
  buffer_load_dwordx4 v111, s[12:15], s40 offen offset:2048 lds
  ds_read_b64_tr_b16 v[76:77], v110 offset:6144
  ds_read_b64_tr_b16 v[78:79], v110 offset:6656
  s_waitcnt lgkmcnt(4)
  v_mfma_f32_32x32x16_bf16 v[52:67], v[68:71], a[16:19], v[52:67]
  buffer_load_dwordx4 v111, s[12:15], s40 offen offset:3072 lds
  ds_read_b64_tr_b16 v[80:81], v110 offset:7168
  ds_read_b64_tr_b16 v[82:83], v110 offset:7680
  s_waitcnt lgkmcnt(4)
  v_mfma_f32_32x32x16_bf16 v[52:67], v[72:75], a[20:23], v[52:67]
  s_cmp_ge_u32 s24, 4
  s_cbranch_scc1 ffn1_kernel_sk5
  s_add_u32 m0, s34, 4096
  s_add_u32 s40, s33, 151552
  buffer_load_dwordx4 v111, s[12:15], s40 offen lds
ffn1_kernel_sk5:
  ds_read_b64_tr_b16 v[68:69], v110 offset:8192
  ds_read_b64_tr_b16 v[70:71], v110 offset:8704
  s_waitcnt lgkmcnt(4)
  v_mfma_f32_32x32x16_bf16 v[52:67], v[76:79], a[24:27], v[52:67]
  s_add_u32 m0, s34, 36864
  s_add_u32 s40, s33, 184320
  buffer_load_dwordx4 v111, s[12:15], s40 offen lds
  ds_read_b64_tr_b16 v[72:73], v110 offset:9216
  ds_read_b64_tr_b16 v[74:75], v110 offset:9728
  s_waitcnt lgkmcnt(4)
  v_mfma_f32_32x32x16_bf16 v[52:67], v[80:83], a[28:31], v[52:67]
  buffer_load_dwordx4 v111, s[12:15], s40 offen offset:1024 lds
  ds_read_b64_tr_b16 v[76:77], v110 offset:10240
  ds_read_b64_tr_b16 v[78:79], v110 offset:10752
  s_waitcnt lgkmcnt(4)
  v_mfma_f32_32x32x16_bf16 v[52:67], v[68:71], a[32:35], v[52:67]
  buffer_load_dwordx4 v111, s[12:15], s40 offen offset:2048 lds
  ds_read_b64_tr_b16 v[80:81], v110 offset:11264
  ds_read_b64_tr_b16 v[82:83], v110 offset:11776
  s_waitcnt lgkmcnt(4)
  v_mfma_f32_32x32x16_bf16 v[52:67], v[72:75], a[36:39], v[52:67]
  buffer_load_dwordx4 v111, s[12:15], s40 offen offset:3072 lds
  ds_read_b64_tr_b16 v[68:69], v110 offset:12288
  ds_read_b64_tr_b16 v[70:71], v110 offset:12800
  s_waitcnt lgkmcnt(4)
  v_mfma_f32_32x32x16_bf16 v[52:67], v[76:79], a[40:43], v[52:67]
  s_cmp_ge_u32 s24, 4
  s_cbranch_scc1 ffn1_kernel_sk6
  s_add_u32 m0, s34, 40960
  s_add_u32 s40, s33, 188416
  buffer_load_dwordx4 v111, s[12:15], s40 offen lds
ffn1_kernel_sk6:
  ds_read_b64_tr_b16 v[72:73], v110 offset:13312
  ds_read_b64_tr_b16 v[74:75], v110 offset:13824
  s_waitcnt lgkmcnt(4)
  v_mfma_f32_32x32x16_bf16 v[52:67], v[80:83], a[44:47], v[52:67]
  v_mul_f32 v96, v4, v4
  v_mul_f32 v97, v5, v5
  v_mul_f32 v98, v6, v6
  ds_read_b64_tr_b16 v[76:77], v110 offset:14336
  ds_read_b64_tr_b16 v[78:79], v110 offset:14848
  s_waitcnt lgkmcnt(4)
  v_mfma_f32_32x32x16_bf16 v[52:67], v[68:71], a[48:51], v[52:67]
  v_mul_f32 v99, v7, v7
  v_fma_f32 v96, v96, v106, v104
  v_fma_f32 v97, v97, v106, v104
  ds_read_b64_tr_b16 v[80:81], v110 offset:15360
  ds_read_b64_tr_b16 v[82:83], v110 offset:15872
  s_waitcnt lgkmcnt(4)
  v_mfma_f32_32x32x16_bf16 v[52:67], v[72:75], a[52:55], v[52:67]
  v_fma_f32 v98, v98, v106, v104
  v_fma_f32 v99, v99, v106, v104
  v_mul_f32 v96, v4, v96
  ds_read_b64_tr_b16 v[68:69], v110 offset:16384
  ds_read_b64_tr_b16 v[70:71], v110 offset:16896
  s_waitcnt lgkmcnt(4)
  v_mfma_f32_32x32x16_bf16 v[52:67], v[76:79], a[56:59], v[52:67]
  v_mul_f32 v97, v5, v97
  v_mul_f32 v98, v6, v98
  v_mul_f32 v99, v7, v99
  ds_read_b64_tr_b16 v[72:73], v110 offset:17408
  ds_read_b64_tr_b16 v[74:75], v110 offset:17920
  s_waitcnt lgkmcnt(4)
  v_mfma_f32_32x32x16_bf16 v[52:67], v[80:83], a[60:63], v[52:67]
  v_exp_f32 v100, v96
  v_exp_f32 v101, v97
  v_exp_f32 v102, v98
  ds_read_b64_tr_b16 v[76:77], v110 offset:18432
  ds_read_b64_tr_b16 v[78:79], v110 offset:18944
  s_waitcnt lgkmcnt(4)
  v_mfma_f32_32x32x16_bf16 v[52:67], v[68:71], a[64:67], v[52:67]
  v_exp_f32 v103, v99
  v_mul_f32 v96, v4, v12
  v_mul_f32 v97, v5, v13
  ds_read_b64_tr_b16 v[80:81], v110 offset:19456
  ds_read_b64_tr_b16 v[82:83], v110 offset:19968
  s_waitcnt lgkmcnt(4)
  v_mfma_f32_32x32x16_bf16 v[52:67], v[72:75], a[68:71], v[52:67]
  v_mul_f32 v98, v6, v14
  v_mul_f32 v99, v7, v15
  v_fma_f32 v100, v100, v108, v108
  ds_read_b64_tr_b16 v[68:69], v110 offset:20480
  ds_read_b64_tr_b16 v[70:71], v110 offset:20992
  s_waitcnt lgkmcnt(4)
  v_mfma_f32_32x32x16_bf16 v[52:67], v[76:79], a[72:75], v[52:67]
  v_fma_f32 v101, v101, v108, v108
  v_fma_f32 v102, v102, v108, v108
  v_fma_f32 v103, v103, v108, v108
  ds_read_b64_tr_b16 v[72:73], v110 offset:21504
  ds_read_b64_tr_b16 v[74:75], v110 offset:22016
  s_waitcnt lgkmcnt(4)
  v_mfma_f32_32x32x16_bf16 v[52:67], v[80:83], a[76:79], v[52:67]
  v_rcp_f32 v100, v100
  v_rcp_f32 v101, v101
  v_rcp_f32 v102, v102
  ds_read_b64_tr_b16 v[76:77], v110 offset:22528
  ds_read_b64_tr_b16 v[78:79], v110 offset:23040
  s_waitcnt lgkmcnt(4)
  v_mfma_f32_32x32x16_bf16 v[52:67], v[68:71], a[80:83], v[52:67]
  v_rcp_f32 v103, v103
  s_nop 0
  v_mul_f32 v96, v96, v100
  ds_read_b64_tr_b16 v[80:81], v110 offset:23552
  ds_read_b64_tr_b16 v[82:83], v110 offset:24064
  s_waitcnt lgkmcnt(4)
  v_mfma_f32_32x32x16_bf16 v[52:67], v[72:75], a[84:87], v[52:67]
  v_mul_f32 v97, v97, v101
  v_mul_f32 v98, v98, v102
  v_mul_f32 v99, v99, v103
  ds_read_b64_tr_b16 v[68:69], v110 offset:24576
  ds_read_b64_tr_b16 v[70:71], v110 offset:25088
  s_waitcnt lgkmcnt(4)
  v_mfma_f32_32x32x16_bf16 v[52:67], v[76:79], a[88:91], v[52:67]
  v_cvt_pk_bf16_f32 v92, v96, v97
  v_cvt_pk_bf16_f32 v93, v98, v99
  v_mul_f32 v96, v8, v8
  ds_read_b64_tr_b16 v[72:73], v110 offset:25600
  ds_read_b64_tr_b16 v[74:75], v110 offset:26112
  s_waitcnt lgkmcnt(4)
  v_mfma_f32_32x32x16_bf16 v[52:67], v[80:83], a[92:95], v[52:67]
  v_mul_f32 v97, v9, v9
  v_mul_f32 v98, v10, v10
  v_mul_f32 v99, v11, v11
  ds_read_b64_tr_b16 v[76:77], v110 offset:26624
  ds_read_b64_tr_b16 v[78:79], v110 offset:27136
  s_waitcnt lgkmcnt(4)
  v_mfma_f32_32x32x16_bf16 v[52:67], v[68:71], a[96:99], v[52:67]
  v_fma_f32 v96, v96, v106, v104
  v_fma_f32 v97, v97, v106, v104
  v_fma_f32 v98, v98, v106, v104
  ds_read_b64_tr_b16 v[80:81], v110 offset:27648
  ds_read_b64_tr_b16 v[82:83], v110 offset:28160
  s_waitcnt lgkmcnt(4)
  v_mfma_f32_32x32x16_bf16 v[52:67], v[72:75], a[100:103], v[52:67]
  v_fma_f32 v99, v99, v106, v104
  v_mul_f32 v96, v8, v96
  v_mul_f32 v97, v9, v97
  ds_read_b64_tr_b16 v[68:69], v110 offset:28672
  ds_read_b64_tr_b16 v[70:71], v110 offset:29184
  s_waitcnt lgkmcnt(4)
  v_mfma_f32_32x32x16_bf16 v[52:67], v[76:79], a[104:107], v[52:67]
  v_mul_f32 v98, v10, v98
  v_mul_f32 v99, v11, v99
  v_exp_f32 v100, v96
  ds_read_b64_tr_b16 v[72:73], v110 offset:29696
  ds_read_b64_tr_b16 v[74:75], v110 offset:30208
  s_waitcnt lgkmcnt(4)
  v_mfma_f32_32x32x16_bf16 v[52:67], v[80:83], a[108:111], v[52:67]
  v_exp_f32 v101, v97
  v_exp_f32 v102, v98
  v_exp_f32 v103, v99
  ds_read_b64_tr_b16 v[76:77], v110 offset:30720
  ds_read_b64_tr_b16 v[78:79], v110 offset:31232
  s_waitcnt lgkmcnt(4)
  v_mfma_f32_32x32x16_bf16 v[52:67], v[68:71], a[112:115], v[52:67]
  v_mul_f32 v96, v8, v16
  v_mul_f32 v97, v9, v17
  v_mul_f32 v98, v10, v18
  ds_read_b64_tr_b16 v[80:81], v110 offset:31744
  ds_read_b64_tr_b16 v[82:83], v110 offset:32256
  s_waitcnt lgkmcnt(4)
  v_mfma_f32_32x32x16_bf16 v[52:67], v[72:75], a[116:119], v[52:67]
  v_mul_f32 v99, v11, v19
  v_fma_f32 v100, v100, v108, v108
  v_fma_f32 v101, v101, v108, v108
  ds_read_b64_tr_b16 v[68:69], v110 offset:32768
  ds_read_b64_tr_b16 v[70:71], v110 offset:33280
  s_waitcnt lgkmcnt(4)
  v_mfma_f32_32x32x16_bf16 v[52:67], v[76:79], a[120:123], v[52:67]
  v_fma_f32 v102, v102, v108, v108
  v_fma_f32 v103, v103, v108, v108
  v_rcp_f32 v100, v100
  ds_read_b64_tr_b16 v[72:73], v110 offset:33792
  ds_read_b64_tr_b16 v[74:75], v110 offset:34304
  s_waitcnt lgkmcnt(4)
  v_mfma_f32_32x32x16_bf16 v[52:67], v[80:83], a[124:127], v[52:67]
  v_rcp_f32 v101, v101
  v_rcp_f32 v102, v102
  v_rcp_f32 v103, v103
  s_waitcnt vmcnt(4)
  s_barrier
  ds_read_b64_tr_b16 v[76:77], v110 offset:34816
  ds_read_b64_tr_b16 v[78:79], v110 offset:35328
  s_waitcnt lgkmcnt(4)
  v_mfma_f32_32x32x16_bf16 v[52:67], v[68:71], a[128:131], v[52:67]
  s_add_u32 m0, s34, 73728
  s_add_u32 s40, s33, 221184
  buffer_load_dwordx4 v111, s[12:15], s40 offen lds
  ds_read_b64_tr_b16 v[80:81], v110 offset:35840
  ds_read_b64_tr_b16 v[82:83], v110 offset:36352
  s_waitcnt lgkmcnt(4)
  v_mfma_f32_32x32x16_bf16 v[52:67], v[72:75], a[132:135], v[52:67]
  buffer_load_dwordx4 v111, s[12:15], s40 offen offset:1024 lds
  ds_read_b64_tr_b16 v[68:69], v105 offset:0
  ds_read_b64_tr_b16 v[70:71], v105 offset:512
  s_waitcnt lgkmcnt(4)
  v_mfma_f32_32x32x16_bf16 v[52:67], v[76:79], a[136:139], v[52:67]
  buffer_load_dwordx4 v111, s[12:15], s40 offen offset:2048 lds
  ds_read_b64_tr_b16 v[72:73], v105 offset:1024
  ds_read_b64_tr_b16 v[74:75], v105 offset:1536
  s_waitcnt lgkmcnt(4)
  v_mfma_f32_32x32x16_bf16 v[52:67], v[80:83], a[140:143], v[52:67]
  buffer_load_dwordx4 v111, s[12:15], s40 offen offset:3072 lds
  s_cmp_ge_u32 s24, 4
  s_cbranch_scc1 ffn1_kernel_sk7
  s_add_u32 m0, s34, 77824
  s_add_u32 s40, s33, 225280
  buffer_load_dwordx4 v111, s[12:15], s40 offen lds
ffn1_kernel_sk7:
  s_nop 0
  v_mul_f32 v96, v96, v100
  v_mul_f32 v97, v97, v101
  v_mul_f32 v98, v98, v102
  v_mul_f32 v99, v99, v103
  v_cvt_pk_bf16_f32 v94, v96, v97
  v_cvt_pk_bf16_f32 v95, v98, v99
  s_add_u32 s41, s37, 0
  buffer_store_dwordx4 v[92:95], v111, s[20:23], s41 offen sc1
  ds_read_b64_tr_b16 v[76:77], v105 offset:2048
  ds_read_b64_tr_b16 v[78:79], v105 offset:2560
  s_waitcnt lgkmcnt(4)
  v_mfma_f32_32x32x16_bf16 v[4:19], v[68:71], a[0:3], 0
  v_mul_f32 v96, v20, v20
  v_mul_f32 v97, v21, v21
  v_mul_f32 v98, v22, v22
  ds_read_b64_tr_b16 v[80:81], v105 offset:3072
  ds_read_b64_tr_b16 v[82:83], v105 offset:3584
  s_waitcnt lgkmcnt(4)
  v_mfma_f32_32x32x16_bf16 v[4:19], v[72:75], a[4:7], v[4:19]
  v_mul_f32 v99, v23, v23
  v_fma_f32 v96, v96, v106, v104
  v_fma_f32 v97, v97, v106, v104
  ds_read_b64_tr_b16 v[68:69], v105 offset:4096
  ds_read_b64_tr_b16 v[70:71], v105 offset:4608
  s_waitcnt lgkmcnt(4)
  v_mfma_f32_32x32x16_bf16 v[4:19], v[76:79], a[8:11], v[4:19]
  v_fma_f32 v98, v98, v106, v104
  v_fma_f32 v99, v99, v106, v104
  v_mul_f32 v96, v20, v96
  ds_read_b64_tr_b16 v[72:73], v105 offset:5120
  ds_read_b64_tr_b16 v[74:75], v105 offset:5632
  s_waitcnt lgkmcnt(4)
  v_mfma_f32_32x32x16_bf16 v[4:19], v[80:83], a[12:15], v[4:19]
  v_mul_f32 v97, v21, v97
  v_mul_f32 v98, v22, v98
  v_mul_f32 v99, v23, v99
  ds_read_b64_tr_b16 v[76:77], v105 offset:6144
  ds_read_b64_tr_b16 v[78:79], v105 offset:6656
  s_waitcnt lgkmcnt(4)
  v_mfma_f32_32x32x16_bf16 v[4:19], v[68:71], a[16:19], v[4:19]
  v_exp_f32 v100, v96
  v_exp_f32 v101, v97
  v_exp_f32 v102, v98
  ds_read_b64_tr_b16 v[80:81], v105 offset:7168
  ds_read_b64_tr_b16 v[82:83], v105 offset:7680
  s_waitcnt lgkmcnt(4)
  v_mfma_f32_32x32x16_bf16 v[4:19], v[72:75], a[20:23], v[4:19]
  v_exp_f32 v103, v99
  v_mul_f32 v96, v20, v28
  v_mul_f32 v97, v21, v29
  ds_read_b64_tr_b16 v[68:69], v105 offset:8192
  ds_read_b64_tr_b16 v[70:71], v105 offset:8704
  s_waitcnt lgkmcnt(4)
  v_mfma_f32_32x32x16_bf16 v[4:19], v[76:79], a[24:27], v[4:19]
  v_mul_f32 v98, v22, v30
  v_mul_f32 v99, v23, v31
  v_fma_f32 v100, v100, v108, v108
  ds_read_b64_tr_b16 v[72:73], v105 offset:9216
  ds_read_b64_tr_b16 v[74:75], v105 offset:9728
  s_waitcnt lgkmcnt(4)
  v_mfma_f32_32x32x16_bf16 v[4:19], v[80:83], a[28:31], v[4:19]
  v_fma_f32 v101, v101, v108, v108
  v_fma_f32 v102, v102, v108, v108
  v_fma_f32 v103, v103, v108, v108
  ds_read_b64_tr_b16 v[76:77], v105 offset:10240
  ds_read_b64_tr_b16 v[78:79], v105 offset:10752
  s_waitcnt lgkmcnt(4)
  v_mfma_f32_32x32x16_bf16 v[4:19], v[68:71], a[32:35], v[4:19]
  v_rcp_f32 v100, v100
  v_rcp_f32 v101, v101
  v_rcp_f32 v102, v102
  ds_read_b64_tr_b16 v[80:81], v105 offset:11264
  ds_read_b64_tr_b16 v[82:83], v105 offset:11776
  s_waitcnt lgkmcnt(4)
  v_mfma_f32_32x32x16_bf16 v[4:19], v[72:75], a[36:39], v[4:19]
  v_rcp_f32 v103, v103
  s_nop 0
  v_mul_f32 v96, v96, v100
  ds_read_b64_tr_b16 v[68:69], v105 offset:12288
  ds_read_b64_tr_b16 v[70:71], v105 offset:12800
  s_waitcnt lgkmcnt(4)
  v_mfma_f32_32x32x16_bf16 v[4:19], v[76:79], a[40:43], v[4:19]
  v_mul_f32 v97, v97, v101
  v_mul_f32 v98, v98, v102
  v_mul_f32 v99, v99, v103
  ds_read_b64_tr_b16 v[72:73], v105 offset:13312
  ds_read_b64_tr_b16 v[74:75], v105 offset:13824
  s_waitcnt lgkmcnt(4)
  v_mfma_f32_32x32x16_bf16 v[4:19], v[80:83], a[44:47], v[4:19]
  v_cvt_pk_bf16_f32 v92, v96, v97
  v_cvt_pk_bf16_f32 v93, v98, v99
  v_mul_f32 v96, v24, v24
  ds_read_b64_tr_b16 v[76:77], v105 offset:14336
  ds_read_b64_tr_b16 v[78:79], v105 offset:14848
  s_waitcnt lgkmcnt(4)
  v_mfma_f32_32x32x16_bf16 v[4:19], v[68:71], a[48:51], v[4:19]
  v_mul_f32 v97, v25, v25
  v_mul_f32 v98, v26, v26
  v_mul_f32 v99, v27, v27
  ds_read_b64_tr_b16 v[80:81], v105 offset:15360
  ds_read_b64_tr_b16 v[82:83], v105 offset:15872
  s_waitcnt lgkmcnt(4)
  v_mfma_f32_32x32x16_bf16 v[4:19], v[72:75], a[52:55], v[4:19]
  v_fma_f32 v96, v96, v106, v104
  v_fma_f32 v97, v97, v106, v104
  v_fma_f32 v98, v98, v106, v104
  ds_read_b64_tr_b16 v[68:69], v105 offset:16384
  ds_read_b64_tr_b16 v[70:71], v105 offset:16896
  s_waitcnt lgkmcnt(4)
  v_mfma_f32_32x32x16_bf16 v[4:19], v[76:79], a[56:59], v[4:19]
  v_fma_f32 v99, v99, v106, v104
  v_mul_f32 v96, v24, v96
  v_mul_f32 v97, v25, v97
  ds_read_b64_tr_b16 v[72:73], v105 offset:17408
  ds_read_b64_tr_b16 v[74:75], v105 offset:17920
  s_waitcnt lgkmcnt(4)
  v_mfma_f32_32x32x16_bf16 v[4:19], v[80:83], a[60:63], v[4:19]
  v_mul_f32 v98, v26, v98
  v_mul_f32 v99, v27, v99
  v_exp_f32 v100, v96
  ds_read_b64_tr_b16 v[76:77], v105 offset:18432
  ds_read_b64_tr_b16 v[78:79], v105 offset:18944
  s_waitcnt lgkmcnt(4)
  v_mfma_f32_32x32x16_bf16 v[4:19], v[68:71], a[64:67], v[4:19]
  v_exp_f32 v101, v97
  v_exp_f32 v102, v98
  v_exp_f32 v103, v99
  ds_read_b64_tr_b16 v[80:81], v105 offset:19456
  ds_read_b64_tr_b16 v[82:83], v105 offset:19968
  s_waitcnt lgkmcnt(4)
  v_mfma_f32_32x32x16_bf16 v[4:19], v[72:75], a[68:71], v[4:19]
  v_mul_f32 v96, v24, v32
  v_mul_f32 v97, v25, v33
  v_mul_f32 v98, v26, v34
  ds_read_b64_tr_b16 v[68:69], v105 offset:20480
  ds_read_b64_tr_b16 v[70:71], v105 offset:20992
  s_waitcnt lgkmcnt(4)
  v_mfma_f32_32x32x16_bf16 v[4:19], v[76:79], a[72:75], v[4:19]
  v_mul_f32 v99, v27, v35
  v_fma_f32 v100, v100, v108, v108
  v_fma_f32 v101, v101, v108, v108
  ds_read_b64_tr_b16 v[72:73], v105 offset:21504
  ds_read_b64_tr_b16 v[74:75], v105 offset:22016
  s_waitcnt lgkmcnt(4)
  v_mfma_f32_32x32x16_bf16 v[4:19], v[80:83], a[76:79], v[4:19]
  v_fma_f32 v102, v102, v108, v108
  v_fma_f32 v103, v103, v108, v108
  v_rcp_f32 v100, v100
  ds_read_b64_tr_b16 v[76:77], v105 offset:22528
  ds_read_b64_tr_b16 v[78:79], v105 offset:23040
  s_waitcnt lgkmcnt(4)
  v_mfma_f32_32x32x16_bf16 v[4:19], v[68:71], a[80:83], v[4:19]
  v_rcp_f32 v101, v101
  v_rcp_f32 v102, v102
  v_rcp_f32 v103, v103
  ds_read_b64_tr_b16 v[80:81], v105 offset:23552
  ds_read_b64_tr_b16 v[82:83], v105 offset:24064
  s_waitcnt lgkmcnt(4)
  v_mfma_f32_32x32x16_bf16 v[4:19], v[72:75], a[84:87], v[4:19]
  s_nop 0
  v_mul_f32 v96, v96, v100
  v_mul_f32 v97, v97, v101
  ds_read_b64_tr_b16 v[68:69], v105 offset:24576
  ds_read_b64_tr_b16 v[70:71], v105 offset:25088
  s_waitcnt lgkmcnt(4)
  v_mfma_f32_32x32x16_bf16 v[4:19], v[76:79], a[88:91], v[4:19]
  v_mul_f32 v98, v98, v102
  v_mul_f32 v99, v99, v103
  v_cvt_pk_bf16_f32 v94, v96, v97
  ds_read_b64_tr_b16 v[72:73], v105 offset:25600
  ds_read_b64_tr_b16 v[74:75], v105 offset:26112
  s_waitcnt lgkmcnt(4)
  v_mfma_f32_32x32x16_bf16 v[4:19], v[80:83], a[92:95], v[4:19]
  v_cvt_pk_bf16_f32 v95, v98, v99
  s_add_u32 s41, s37, 1024
  buffer_store_dwordx4 v[92:95], v111, s[20:23], s41 offen sc1
  ds_read_b64_tr_b16 v[76:77], v105 offset:26624
  ds_read_b64_tr_b16 v[78:79], v105 offset:27136
  s_waitcnt lgkmcnt(4)
  v_mfma_f32_32x32x16_bf16 v[4:19], v[68:71], a[96:99], v[4:19]
  v_mul_f32 v96, v36, v36
  v_mul_f32 v97, v37, v37
  v_mul_f32 v98, v38, v38
  ds_read_b64_tr_b16 v[80:81], v105 offset:27648
  ds_read_b64_tr_b16 v[82:83], v105 offset:28160
  s_waitcnt lgkmcnt(4)
  v_mfma_f32_32x32x16_bf16 v[4:19], v[72:75], a[100:103], v[4:19]
  v_mul_f32 v99, v39, v39
  v_fma_f32 v96, v96, v106, v104
  v_fma_f32 v97, v97, v106, v104
  ds_read_b64_tr_b16 v[68:69], v105 offset:28672
  ds_read_b64_tr_b16 v[70:71], v105 offset:29184
  s_waitcnt lgkmcnt(4)
  v_mfma_f32_32x32x16_bf16 v[4:19], v[76:79], a[104:107], v[4:19]
  v_fma_f32 v98, v98, v106, v104
  v_fma_f32 v99, v99, v106, v104
  v_mul_f32 v96, v36, v96
  ds_read_b64_tr_b16 v[72:73], v105 offset:29696
  ds_read_b64_tr_b16 v[74:75], v105 offset:30208
  s_waitcnt lgkmcnt(4)
  v_mfma_f32_32x32x16_bf16 v[4:19], v[80:83], a[108:111], v[4:19]
  v_mul_f32 v97, v37, v97
  v_mul_f32 v98, v38, v98
  v_mul_f32 v99, v39, v99
  ds_read_b64_tr_b16 v[76:77], v105 offset:30720
  ds_read_b64_tr_b16 v[78:79], v105 offset:31232
  s_waitcnt lgkmcnt(4)
  v_mfma_f32_32x32x16_bf16 v[4:19], v[68:71], a[112:115], v[4:19]
  v_exp_f32 v100, v96
  v_exp_f32 v101, v97
  v_exp_f32 v102, v98
  ds_read_b64_tr_b16 v[80:81], v105 offset:31744
  ds_read_b64_tr_b16 v[82:83], v105 offset:32256
  s_waitcnt lgkmcnt(4)
  v_mfma_f32_32x32x16_bf16 v[4:19], v[72:75], a[116:119], v[4:19]
  v_exp_f32 v103, v99
  v_mul_f32 v96, v36, v44
  v_mul_f32 v97, v37, v45
  ds_read_b64_tr_b16 v[68:69], v105 offset:32768
  ds_read_b64_tr_b16 v[70:71], v105 offset:33280
  s_waitcnt lgkmcnt(4)
  v_mfma_f32_32x32x16_bf16 v[4:19], v[76:79], a[120:123], v[4:19]
  v_mul_f32 v98, v38, v46
  v_mul_f32 v99, v39, v47
  v_fma_f32 v100, v100, v108, v108
  ds_read_b64_tr_b16 v[72:73], v105 offset:33792
  ds_read_b64_tr_b16 v[74:75], v105 offset:34304
  s_waitcnt lgkmcnt(4)
  v_mfma_f32_32x32x16_bf16 v[4:19], v[80:83], a[124:127], v[4:19]
  v_fma_f32 v101, v101, v108, v108
  v_fma_f32 v102, v102, v108, v108
  v_fma_f32 v103, v103, v108, v108
  s_waitcnt vmcnt(6)
  s_barrier
  ds_read_b64_tr_b16 v[76:77], v105 offset:34816
  ds_read_b64_tr_b16 v[78:79], v105 offset:35328
  s_waitcnt lgkmcnt(4)
  v_mfma_f32_32x32x16_bf16 v[4:19], v[68:71], a[128:131], v[4:19]
  s_add_u32 m0, s34, 110592
  s_add_u32 s40, s33, 258048
  buffer_load_dwordx4 v111, s[12:15], s40 offen lds
  ds_read_b64_tr_b16 v[80:81], v105 offset:35840
  ds_read_b64_tr_b16 v[82:83], v105 offset:36352
  s_waitcnt lgkmcnt(4)
  v_mfma_f32_32x32x16_bf16 v[4:19], v[72:75], a[132:135], v[4:19]
  buffer_load_dwordx4 v111, s[12:15], s40 offen offset:1024 lds
  ds_read_b64_tr_b16 v[68:69], v107 offset:0
  ds_read_b64_tr_b16 v[70:71], v107 offset:512
  s_waitcnt lgkmcnt(4)
  v_mfma_f32_32x32x16_bf16 v[4:19], v[76:79], a[136:139], v[4:19]
  buffer_load_dwordx4 v111, s[12:15], s40 offen offset:2048 lds
  ds_read_b64_tr_b16 v[72:73], v107 offset:1024
  ds_read_b64_tr_b16 v[74:75], v107 offset:1536
  s_waitcnt lgkmcnt(4)
  v_mfma_f32_32x32x16_bf16 v[4:19], v[80:83], a[140:143], v[4:19]
  buffer_load_dwordx4 v111, s[12:15], s40 offen offset:3072 lds
  s_cmp_ge_u32 s24, 4
  s_cbranch_scc1 ffn1_kernel_sk8
  s_add_u32 m0, s34, 114688
  s_add_u32 s40, s33, 262144
  buffer_load_dwordx4 v111, s[12:15], s40 offen lds
ffn1_kernel_sk8:
  ds_read_b64_tr_b16 v[76:77], v107 offset:2048
  ds_read_b64_tr_b16 v[78:79], v107 offset:2560
  s_waitcnt lgkmcnt(4)
  v_mfma_f32_32x32x16_bf16 v[20:35], v[68:71], a[0:3], 0
  v_rcp_f32 v100, v100
  v_rcp_f32 v101, v101
  v_rcp_f32 v102, v102
  ds_read_b64_tr_b16 v[80:81], v107 offset:3072
  ds_read_b64_tr_b16 v[82:83], v107 offset:3584
  s_waitcnt lgkmcnt(4)
  v_mfma_f32_32x32x16_bf16 v[20:35], v[72:75], a[4:7], v[20:35]
  v_rcp_f32 v103, v103
  s_nop 0
  v_mul_f32 v96, v96, v100
  ds_read_b64_tr_b16 v[68:69], v107 offset:4096
  ds_read_b64_tr_b16 v[70:71], v107 offset:4608
  s_waitcnt lgkmcnt(4)
  v_mfma_f32_32x32x16_bf16 v[20:35], v[76:79], a[8:11], v[20:35]
  v_mul_f32 v97, v97, v101
  v_mul_f32 v98, v98, v102
  v_mul_f32 v99, v99, v103
  ds_read_b64_tr_b16 v[72:73], v107 offset:5120
  ds_read_b64_tr_b16 v[74:75], v107 offset:5632
  s_waitcnt lgkmcnt(4)
  v_mfma_f32_32x32x16_bf16 v[20:35], v[80:83], a[12:15], v[20:35]
  v_cvt_pk_bf16_f32 v92, v96, v97
  v_cvt_pk_bf16_f32 v93, v98, v99
  v_mul_f32 v96, v40, v40
  ds_read_b64_tr_b16 v[76:77], v107 offset:6144
  ds_read_b64_tr_b16 v[78:79], v107 offset:6656
  s_waitcnt lgkmcnt(4)
  v_mfma_f32_32x32x16_bf16 v[20:35], v[68:71], a[16:19], v[20:35]
  v_mul_f32 v97, v41, v41
  v_mul_f32 v98, v42, v42
  v_mul_f32 v99, v43, v43
  ds_read_b64_tr_b16 v[80:81], v107 offset:7168
  ds_read_b64_tr_b16 v[82:83], v107 offset:7680
  s_waitcnt lgkmcnt(4)
  v_mfma_f32_32x32x16_bf16 v[20:35], v[72:75], a[20:23], v[20:35]
  v_fma_f32 v96, v96, v106, v104
  v_fma_f32 v97, v97, v106, v104
  v_fma_f32 v98, v98, v106, v104
  ds_read_b64_tr_b16 v[68:69], v107 offset:8192
  ds_read_b64_tr_b16 v[70:71], v107 offset:8704
  s_waitcnt lgkmcnt(4)
  v_mfma_f32_32x32x16_bf16 v[20:35], v[76:79], a[24:27], v[20:35]
  v_fma_f32 v99, v99, v106, v104
  v_mul_f32 v96, v40, v96
  v_mul_f32 v97, v41, v97
  ds_read_b64_tr_b16 v[72:73], v107 offset:9216
  ds_read_b64_tr_b16 v[74:75], v107 offset:9728
  s_waitcnt lgkmcnt(4)
  v_mfma_f32_32x32x16_bf16 v[20:35], v[80:83], a[28:31], v[20:35]
  v_mul_f32 v98, v42, v98
  v_mul_f32 v99, v43, v99
  v_exp_f32 v100, v96
  ds_read_b64_tr_b16 v[76:77], v107 offset:10240
  ds_read_b64_tr_b16 v[78:79], v107 offset:10752
  s_waitcnt lgkmcnt(4)
  v_mfma_f32_32x32x16_bf16 v[20:35], v[68:71], a[32:35], v[20:35]
  v_exp_f32 v101, v97
  v_exp_f32 v102, v98
  v_exp_f32 v103, v99
  ds_read_b64_tr_b16 v[80:81], v107 offset:11264
  ds_read_b64_tr_b16 v[82:83], v107 offset:11776
  s_waitcnt lgkmcnt(4)
  v_mfma_f32_32x32x16_bf16 v[20:35], v[72:75], a[36:39], v[20:35]
  v_mul_f32 v96, v40, v48
  v_mul_f32 v97, v41, v49
  v_mul_f32 v98, v42, v50
  ds_read_b64_tr_b16 v[68:69], v107 offset:12288
  ds_read_b64_tr_b16 v[70:71], v107 offset:12800
  s_waitcnt lgkmcnt(4)
  v_mfma_f32_32x32x16_bf16 v[20:35], v[76:79], a[40:43], v[20:35]
  v_mul_f32 v99, v43, v51
  v_fma_f32 v100, v100, v108, v108
  v_fma_f32 v101, v101, v108, v108
  ds_read_b64_tr_b16 v[72:73], v107 offset:13312
  ds_read_b64_tr_b16 v[74:75], v107 offset:13824
  s_waitcnt lgkmcnt(4)
  v_mfma_f32_32x32x16_bf16 v[20:35], v[80:83], a[44:47], v[20:35]
  v_fma_f32 v102, v102, v108, v108
  v_fma_f32 v103, v103, v108, v108
  v_rcp_f32 v100, v100
  ds_read_b64_tr_b16 v[76:77], v107 offset:14336
  ds_read_b64_tr_b16 v[78:79], v107 offset:14848
  s_waitcnt lgkmcnt(4)
  v_mfma_f32_32x32x16_bf16 v[20:35], v[68:71], a[48:51], v[20:35]
  v_rcp_f32 v101, v101
  v_rcp_f32 v102, v102
  v_rcp_f32 v103, v103
  ds_read_b64_tr_b16 v[80:81], v107 offset:15360
  ds_read_b64_tr_b16 v[82:83], v107 offset:15872
  s_waitcnt lgkmcnt(4)
  v_mfma_f32_32x32x16_bf16 v[20:35], v[72:75], a[52:55], v[20:35]
  s_nop 0
  v_mul_f32 v96, v96, v100
  v_mul_f32 v97, v97, v101
  ds_read_b64_tr_b16 v[68:69], v107 offset:16384
  ds_read_b64_tr_b16 v[70:71], v107 offset:16896
  s_waitcnt lgkmcnt(4)
  v_mfma_f32_32x32x16_bf16 v[20:35], v[76:79], a[56:59], v[20:35]
  v_mul_f32 v98, v98, v102
  v_mul_f32 v99, v99, v103
  v_cvt_pk_bf16_f32 v94, v96, v97
  ds_read_b64_tr_b16 v[72:73], v107 offset:17408
  ds_read_b64_tr_b16 v[74:75], v107 offset:17920
  s_waitcnt lgkmcnt(4)
  v_mfma_f32_32x32x16_bf16 v[20:35], v[80:83], a[60:63], v[20:35]
  v_cvt_pk_bf16_f32 v95, v98, v99
  s_add_u32 s41, s37, 2048
  buffer_store_dwordx4 v[92:95], v111, s[20:23], s41 offen sc1
  ds_read_b64_tr_b16 v[76:77], v107 offset:18432
  ds_read_b64_tr_b16 v[78:79], v107 offset:18944
  s_waitcnt lgkmcnt(4)
  v_mfma_f32_32x32x16_bf16 v[20:35], v[68:71], a[64:67], v[20:35]
  v_mul_f32 v96, v52, v52
  v_mul_f32 v97, v53, v53
  v_mul_f32 v98, v54, v54
  ds_read_b64_tr_b16 v[80:81], v107 offset:19456
  ds_read_b64_tr_b16 v[82:83], v107 offset:19968
  s_waitcnt lgkmcnt(4)
  v_mfma_f32_32x32x16_bf16 v[20:35], v[72:75], a[68:71], v[20:35]
  v_mul_f32 v99, v55, v55
  v_fma_f32 v96, v96, v106, v104
  v_fma_f32 v97, v97, v106, v104
  ds_read_b64_tr_b16 v[68:69], v107 offset:20480
  ds_read_b64_tr_b16 v[70:71], v107 offset:20992
  s_waitcnt lgkmcnt(4)
  v_mfma_f32_32x32x16_bf16 v[20:35], v[76:79], a[72:75], v[20:35]
  v_fma_f32 v98, v98, v106, v104
  v_fma_f32 v99, v99, v106, v104
  v_mul_f32 v96, v52, v96
  ds_read_b64_tr_b16 v[72:73], v107 offset:21504
  ds_read_b64_tr_b16 v[74:75], v107 offset:22016
  s_waitcnt lgkmcnt(4)
  v_mfma_f32_32x32x16_bf16 v[20:35], v[80:83], a[76:79], v[20:35]
  v_mul_f32 v97, v53, v97
  v_mul_f32 v98, v54, v98
  v_mul_f32 v99, v55, v99
  ds_read_b64_tr_b16 v[76:77], v107 offset:22528
  ds_read_b64_tr_b16 v[78:79], v107 offset:23040
  s_waitcnt lgkmcnt(4)
  v_mfma_f32_32x32x16_bf16 v[20:35], v[68:71], a[80:83], v[20:35]
  v_exp_f32 v100, v96
  v_exp_f32 v101, v97
  v_exp_f32 v102, v98
  ds_read_b64_tr_b16 v[80:81], v107 offset:23552
  ds_read_b64_tr_b16 v[82:83], v107 offset:24064
  s_waitcnt lgkmcnt(4)
  v_mfma_f32_32x32x16_bf16 v[20:35], v[72:75], a[84:87], v[20:35]
  v_exp_f32 v103, v99
  v_mul_f32 v96, v52, v60
  v_mul_f32 v97, v53, v61
  ds_read_b64_tr_b16 v[68:69], v107 offset:24576
  ds_read_b64_tr_b16 v[70:71], v107 offset:25088
  s_waitcnt lgkmcnt(4)
  v_mfma_f32_32x32x16_bf16 v[20:35], v[76:79], a[88:91], v[20:35]
  v_mul_f32 v98, v54, v62
  v_mul_f32 v99, v55, v63
  v_fma_f32 v100, v100, v108, v108
  ds_read_b64_tr_b16 v[72:73], v107 offset:25600
  ds_read_b64_tr_b16 v[74:75], v107 offset:26112
  s_waitcnt lgkmcnt(4)
  v_mfma_f32_32x32x16_bf16 v[20:35], v[80:83], a[92:95], v[20:35]
  v_fma_f32 v101, v101, v108, v108
  v_fma_f32 v102, v102, v108, v108
  v_fma_f32 v103, v103, v108, v108
  ds_read_b64_tr_b16 v[76:77], v107 offset:26624
  ds_read_b64_tr_b16 v[78:79], v107 offset:27136
  s_waitcnt lgkmcnt(4)
  v_mfma_f32_32x32x16_bf16 v[20:35], v[68:71], a[96:99], v[20:35]
  v_rcp_f32 v100, v100
  v_rcp_f32 v101, v101
  v_rcp_f32 v102, v102
  ds_read_b64_tr_b16 v[80:81], v107 offset:27648
  ds_read_b64_tr_b16 v[82:83], v107 offset:28160
  s_waitcnt lgkmcnt(4)
  v_mfma_f32_32x32x16_bf16 v[20:35], v[72:75], a[100:103], v[20:35]
  v_rcp_f32 v103, v103
  s_nop 0
  v_mul_f32 v96, v96, v100
  ds_read_b64_tr_b16 v[68:69], v107 offset:28672
  ds_read_b64_tr_b16 v[70:71], v107 offset:29184
  s_waitcnt lgkmcnt(4)
  v_mfma_f32_32x32x16_bf16 v[20:35], v[76:79], a[104:107], v[20:35]
  v_mul_f32 v97, v97, v101
  v_mul_f32 v98, v98, v102
  v_mul_f32 v99, v99, v103
  ds_read_b64_tr_b16 v[72:73], v107 offset:29696
  ds_read_b64_tr_b16 v[74:75], v107 offset:30208
  s_waitcnt lgkmcnt(4)
  v_mfma_f32_32x32x16_bf16 v[20:35], v[80:83], a[108:111], v[20:35]
  v_cvt_pk_bf16_f32 v92, v96, v97
  v_cvt_pk_bf16_f32 v93, v98, v99
  v_mul_f32 v96, v56, v56
  ds_read_b64_tr_b16 v[76:77], v107 offset:30720
  ds_read_b64_tr_b16 v[78:79], v107 offset:31232
  s_waitcnt lgkmcnt(4)
  v_mfma_f32_32x32x16_bf16 v[20:35], v[68:71], a[112:115], v[20:35]
  v_mul_f32 v97, v57, v57
  v_mul_f32 v98, v58, v58
  v_mul_f32 v99, v59, v59
  ds_read_b64_tr_b16 v[80:81], v107 offset:31744
  ds_read_b64_tr_b16 v[82:83], v107 offset:32256
  s_waitcnt lgkmcnt(4)
  v_mfma_f32_32x32x16_bf16 v[20:35], v[72:75], a[116:119], v[20:35]
  v_fma_f32 v96, v96, v106, v104
  v_fma_f32 v97, v97, v106, v104
  v_fma_f32 v98, v98, v106, v104
  ds_read_b64_tr_b16 v[68:69], v107 offset:32768
  ds_read_b64_tr_b16 v[70:71], v107 offset:33280
  s_waitcnt lgkmcnt(4)
  v_mfma_f32_32x32x16_bf16 v[20:35], v[76:79], a[120:123], v[20:35]
  v_fma_f32 v99, v99, v106, v104
  v_mul_f32 v96, v56, v96
  v_mul_f32 v97, v57, v97
  ds_read_b64_tr_b16 v[72:73], v107 offset:33792
  ds_read_b64_tr_b16 v[74:75], v107 offset:34304
  s_waitcnt lgkmcnt(4)
  v_mfma_f32_32x32x16_bf16 v[20:35], v[80:83], a[124:127], v[20:35]
  v_mul_f32 v98, v58, v98
  v_mul_f32 v99, v59, v99
  v_exp_f32 v100, v96
  s_waitcnt vmcnt(7)
  s_barrier
  ds_read_b64_tr_b16 v[76:77], v107 offset:34816
  ds_read_b64_tr_b16 v[78:79], v107 offset:35328
  s_waitcnt lgkmcnt(4)
  v_mfma_f32_32x32x16_bf16 v[20:35], v[68:71], a[128:131], v[20:35]
  s_add_u32 m0, s34, 0
  s_add_u32 s40, s33, 294912
  buffer_load_dwordx4 v111, s[12:15], s40 offen lds
  ds_read_b64_tr_b16 v[80:81], v107 offset:35840
  ds_read_b64_tr_b16 v[82:83], v107 offset:36352
  s_waitcnt lgkmcnt(4)
  v_mfma_f32_32x32x16_bf16 v[20:35], v[72:75], a[132:135], v[20:35]
  buffer_load_dwordx4 v111, s[12:15], s40 offen offset:1024 lds
  ds_read_b64_tr_b16 v[68:69], v109 offset:0
  ds_read_b64_tr_b16 v[70:71], v109 offset:512
  s_waitcnt lgkmcnt(4)
  v_mfma_f32_32x32x16_bf16 v[20:35], v[76:79], a[136:139], v[20:35]
  buffer_load_dwordx4 v111, s[12:15], s40 offen offset:2048 lds
  ds_read_b64_tr_b16 v[72:73], v109 offset:1024
  ds_read_b64_tr_b16 v[74:75], v109 offset:1536
  s_waitcnt lgkmcnt(4)
  v_mfma_f32_32x32x16_bf16 v[20:35], v[80:83], a[140:143], v[20:35]
  buffer_load_dwordx4 v111, s[12:15], s40 offen offset:3072 lds
  s_cmp_ge_u32 s24, 4
  s_cbranch_scc1 ffn1_kernel_sk9
  s_add_u32 m0, s34, 4096
  s_add_u32 s40, s33, 299008
  buffer_load_dwordx4 v111, s[12:15], s40 offen lds
ffn1_kernel_sk9:
  ds_read_b64_tr_b16 v[76:77], v109 offset:2048
  ds_read_b64_tr_b16 v[78:79], v109 offset:2560
  s_waitcnt lgkmcnt(4)
  v_mfma_f32_32x32x16_bf16 v[36:51], v[68:71], a[0:3], 0
  v_exp_f32 v101, v97
  v_exp_f32 v102, v98
  v_exp_f32 v103, v99
  ds_read_b64_tr_b16 v[80:81], v109 offset:3072
  ds_read_b64_tr_b16 v[82:83], v109 offset:3584
  s_waitcnt lgkmcnt(4)
  v_mfma_f32_32x32x16_bf16 v[36:51], v[72:75], a[4:7], v[36:51]
  v_mul_f32 v96, v56, v64
  v_mul_f32 v97, v57, v65
  v_mul_f32 v98, v58, v66
  ds_read_b64_tr_b16 v[68:69], v109 offset:4096
  ds_read_b64_tr_b16 v[70:71], v109 offset:4608
  s_waitcnt lgkmcnt(4)
  v_mfma_f32_32x32x16_bf16 v[36:51], v[76:79], a[8:11], v[36:51]
  v_mul_f32 v99, v59, v67
  v_fma_f32 v100, v100, v108, v108
  v_fma_f32 v101, v101, v108, v108
  ds_read_b64_tr_b16 v[72:73], v109 offset:5120
  ds_read_b64_tr_b16 v[74:75], v109 offset:5632
  s_waitcnt lgkmcnt(4)
  v_mfma_f32_32x32x16_bf16 v[36:51], v[80:83], a[12:15], v[36:51]
  v_fma_f32 v102, v102, v108, v108
  v_fma_f32 v103, v103, v108, v108
  v_rcp_f32 v100, v100
  ds_read_b64_tr_b16 v[76:77], v109 offset:6144
  ds_read_b64_tr_b16 v[78:79], v109 offset:6656
  s_waitcnt lgkmcnt(4)
  v_mfma_f32_32x32x16_bf16 v[36:51], v[68:71], a[16:19], v[36:51]
  v_rcp_f32 v101, v101
  v_rcp_f32 v102, v102
  v_rcp_f32 v103, v103
  ds_read_b64_tr_b16 v[80:81], v109 offset:7168
  ds_read_b64_tr_b16 v[82:83], v109 offset:7680
  s_waitcnt lgkmcnt(4)
  v_mfma_f32_32x32x16_bf16 v[36:51], v[72:75], a[20:23], v[36:51]
  s_nop 0
  v_mul_f32 v96, v96, v100
  v_mul_f32 v97, v97, v101
  ds_read_b64_tr_b16 v[68:69], v109 offset:8192
  ds_read_b64_tr_b16 v[70:71], v109 offset:8704
  s_waitcnt lgkmcnt(4)
  v_mfma_f32_32x32x16_bf16 v[36:51], v[76:79], a[24:27], v[36:51]
  v_mul_f32 v98, v98, v102
  v_mul_f32 v99, v99, v103
  v_cvt_pk_bf16_f32 v94, v96, v97
  ds_read_b64_tr_b16 v[72:73], v109 offset:9216
  ds_read_b64_tr_b16 v[74:75], v109 offset:9728
  s_waitcnt lgkmcnt(4)
  v_mfma_f32_32x32x16_bf16 v[36:51], v[80:83], a[28:31], v[36:51]
  v_cvt_pk_bf16_f32 v95, v98, v99
  s_add_u32 s41, s37, 3072
  buffer_store_dwordx4 v[92:95], v111, s[20:23], s41 offen sc1
  ds_read_b64_tr_b16 v[76:77], v109 offset:10240
  ds_read_b64_tr_b16 v[78:79], v109 offset:10752
  s_waitcnt lgkmcnt(4)
  v_mfma_f32_32x32x16_bf16 v[36:51], v[68:71], a[32:35], v[36:51]
  v_mul_f32 v96, v4, v4
  v_mul_f32 v97, v5, v5
  v_mul_f32 v98, v6, v6
  ds_read_b64_tr_b16 v[80:81], v109 offset:11264
  ds_read_b64_tr_b16 v[82:83], v109 offset:11776
  s_waitcnt lgkmcnt(4)
  v_mfma_f32_32x32x16_bf16 v[36:51], v[72:75], a[36:39], v[36:51]
  v_mul_f32 v99, v7, v7
  v_fma_f32 v96, v96, v106, v104
  v_fma_f32 v97, v97, v106, v104
  ds_read_b64_tr_b16 v[68:69], v109 offset:12288
  ds_read_b64_tr_b16 v[70:71], v109 offset:12800
  s_waitcnt lgkmcnt(4)
  v_mfma_f32_32x32x16_bf16 v[36:51], v[76:79], a[40:43], v[36:51]
  v_fma_f32 v98, v98, v106, v104
  v_fma_f32 v99, v99, v106, v104
  v_mul_f32 v96, v4, v96
  ds_read_b64_tr_b16 v[72:73], v109 offset:13312
  ds_read_b64_tr_b16 v[74:75], v109 offset:13824
  s_waitcnt lgkmcnt(4)
  v_mfma_f32_32x32x16_bf16 v[36:51], v[80:83], a[44:47], v[36:51]
  v_mul_f32 v97, v5, v97
  v_mul_f32 v98, v6, v98
  v_mul_f32 v99, v7, v99
  ds_read_b64_tr_b16 v[76:77], v109 offset:14336
  ds_read_b64_tr_b16 v[78:79], v109 offset:14848
  s_waitcnt lgkmcnt(4)
  v_mfma_f32_32x32x16_bf16 v[36:51], v[68:71], a[48:51], v[36:51]
  v_exp_f32 v100, v96
  v_exp_f32 v101, v97
  v_exp_f32 v102, v98
  ds_read_b64_tr_b16 v[80:81], v109 offset:15360
  ds_read_b64_tr_b16 v[82:83], v109 offset:15872
  s_waitcnt lgkmcnt(4)
  v_mfma_f32_32x32x16_bf16 v[36:51], v[72:75], a[52:55], v[36:51]
  v_exp_f32 v103, v99
  v_mul_f32 v96, v4, v12
  v_mul_f32 v97, v5, v13
  ds_read_b64_tr_b16 v[68:69], v109 offset:16384
  ds_read_b64_tr_b16 v[70:71], v109 offset:16896
  s_waitcnt lgkmcnt(4)
  v_mfma_f32_32x32x16_bf16 v[36:51], v[76:79], a[56:59], v[36:51]
  v_mul_f32 v98, v6, v14
  v_mul_f32 v99, v7, v15
  v_fma_f32 v100, v100, v108, v108
  ds_read_b64_tr_b16 v[72:73], v109 offset:17408
  ds_read_b64_tr_b16 v[74:75], v109 offset:17920
  s_waitcnt lgkmcnt(4)
  v_mfma_f32_32x32x16_bf16 v[36:51], v[80:83], a[60:63], v[36:51]
  v_fma_f32 v101, v101, v108, v108
  v_fma_f32 v102, v102, v108, v108
  v_fma_f32 v103, v103, v108, v108
  ds_read_b64_tr_b16 v[76:77], v109 offset:18432
  ds_read_b64_tr_b16 v[78:79], v109 offset:18944
  s_waitcnt lgkmcnt(4)
  v_mfma_f32_32x32x16_bf16 v[36:51], v[68:71], a[64:67], v[36:51]
  v_rcp_f32 v100, v100
  v_rcp_f32 v101, v101
  v_rcp_f32 v102, v102
  ds_read_b64_tr_b16 v[80:81], v109 offset:19456
  ds_read_b64_tr_b16 v[82:83], v109 offset:19968
  s_waitcnt lgkmcnt(4)
  v_mfma_f32_32x32x16_bf16 v[36:51], v[72:75], a[68:71], v[36:51]
  v_rcp_f32 v103, v103
  s_nop 0
  v_mul_f32 v96, v96, v100
  ds_read_b64_tr_b16 v[68:69], v109 offset:20480
  ds_read_b64_tr_b16 v[70:71], v109 offset:20992
  s_waitcnt lgkmcnt(4)
  v_mfma_f32_32x32x16_bf16 v[36:51], v[76:79], a[72:75], v[36:51]
  v_mul_f32 v97, v97, v101
  v_mul_f32 v98, v98, v102
  v_mul_f32 v99, v99, v103
  ds_read_b64_tr_b16 v[72:73], v109 offset:21504
  ds_read_b64_tr_b16 v[74:75], v109 offset:22016
  s_waitcnt lgkmcnt(4)
  v_mfma_f32_32x32x16_bf16 v[36:51], v[80:83], a[76:79], v[36:51]
  v_cvt_pk_bf16_f32 v92, v96, v97
  v_cvt_pk_bf16_f32 v93, v98, v99
  v_mul_f32 v96, v8, v8
  ds_read_b64_tr_b16 v[76:77], v109 offset:22528
  ds_read_b64_tr_b16 v[78:79], v109 offset:23040
  s_waitcnt lgkmcnt(4)
  v_mfma_f32_32x32x16_bf16 v[36:51], v[68:71], a[80:83], v[36:51]
  v_mul_f32 v97, v9, v9
  v_mul_f32 v98, v10, v10
  v_mul_f32 v99, v11, v11
  ds_read_b64_tr_b16 v[80:81], v109 offset:23552
  ds_read_b64_tr_b16 v[82:83], v109 offset:24064
  s_waitcnt lgkmcnt(4)
  v_mfma_f32_32x32x16_bf16 v[36:51], v[72:75], a[84:87], v[36:51]
  v_fma_f32 v96, v96, v106, v104
  v_fma_f32 v97, v97, v106, v104
  v_fma_f32 v98, v98, v106, v104
  ds_read_b64_tr_b16 v[68:69], v109 offset:24576
  ds_read_b64_tr_b16 v[70:71], v109 offset:25088
  s_waitcnt lgkmcnt(4)
  v_mfma_f32_32x32x16_bf16 v[36:51], v[76:79], a[88:91], v[36:51]
  v_fma_f32 v99, v99, v106, v104
  v_mul_f32 v96, v8, v96
  v_mul_f32 v97, v9, v97
  ds_read_b64_tr_b16 v[72:73], v109 offset:25600
  ds_read_b64_tr_b16 v[74:75], v109 offset:26112
  s_waitcnt lgkmcnt(4)
  v_mfma_f32_32x32x16_bf16 v[36:51], v[80:83], a[92:95], v[36:51]
  v_mul_f32 v98, v10, v98
  v_mul_f32 v99, v11, v99
  v_exp_f32 v100, v96
  ds_read_b64_tr_b16 v[76:77], v109 offset:26624
  ds_read_b64_tr_b16 v[78:79], v109 offset:27136
  s_waitcnt lgkmcnt(4)
  v_mfma_f32_32x32x16_bf16 v[36:51], v[68:71], a[96:99], v[36:51]
  v_exp_f32 v101, v97
  v_exp_f32 v102, v98
  v_exp_f32 v103, v99
  ds_read_b64_tr_b16 v[80:81], v109 offset:27648
  ds_read_b64_tr_b16 v[82:83], v109 offset:28160
  s_waitcnt lgkmcnt(4)
  v_mfma_f32_32x32x16_bf16 v[36:51], v[72:75], a[100:103], v[36:51]
  v_mul_f32 v96, v8, v16
  v_mul_f32 v97, v9, v17
  v_mul_f32 v98, v10, v18
  ds_read_b64_tr_b16 v[68:69], v109 offset:28672
  ds_read_b64_tr_b16 v[70:71], v109 offset:29184
  s_waitcnt lgkmcnt(4)
  v_mfma_f32_32x32x16_bf16 v[36:51], v[76:79], a[104:107], v[36:51]
  v_mul_f32 v99, v11, v19
  v_fma_f32 v100, v100, v108, v108
  v_fma_f32 v101, v101, v108, v108
  ds_read_b64_tr_b16 v[72:73], v109 offset:29696
  ds_read_b64_tr_b16 v[74:75], v109 offset:30208
  s_waitcnt lgkmcnt(4)
  v_mfma_f32_32x32x16_bf16 v[36:51], v[80:83], a[108:111], v[36:51]
  v_fma_f32 v102, v102, v108, v108
  v_fma_f32 v103, v103, v108, v108
  v_rcp_f32 v100, v100
  ds_read_b64_tr_b16 v[76:77], v109 offset:30720
  ds_read_b64_tr_b16 v[78:79], v109 offset:31232
  s_waitcnt lgkmcnt(4)
  v_mfma_f32_32x32x16_bf16 v[36:51], v[68:71], a[112:115], v[36:51]
  v_rcp_f32 v101, v101
  v_rcp_f32 v102, v102
  v_rcp_f32 v103, v103
  ds_read_b64_tr_b16 v[80:81], v109 offset:31744
  ds_read_b64_tr_b16 v[82:83], v109 offset:32256
  s_waitcnt lgkmcnt(4)
  v_mfma_f32_32x32x16_bf16 v[36:51], v[72:75], a[116:119], v[36:51]
  s_nop 0
  v_mul_f32 v96, v96, v100
  v_mul_f32 v97, v97, v101
  ds_read_b64_tr_b16 v[68:69], v109 offset:32768
  ds_read_b64_tr_b16 v[70:71], v109 offset:33280
  s_waitcnt lgkmcnt(4)
  v_mfma_f32_32x32x16_bf16 v[36:51], v[76:79], a[120:123], v[36:51]
  v_mul_f32 v98, v98, v102
  v_mul_f32 v99, v99, v103
  v_cvt_pk_bf16_f32 v94, v96, v97
  ds_read_b64_tr_b16 v[72:73], v109 offset:33792
  ds_read_b64_tr_b16 v[74:75], v109 offset:34304
  s_waitcnt lgkmcnt(4)
  v_mfma_f32_32x32x16_bf16 v[36:51], v[80:83], a[124:127], v[36:51]
  v_cvt_pk_bf16_f32 v95, v98, v99
  s_add_u32 s41, s37, 4096
  buffer_store_dwordx4 v[92:95], v111, s[20:23], s41 offen sc1
  s_waitcnt vmcnt(7)
  s_barrier
  ds_read_b64_tr_b16 v[76:77], v109 offset:34816
  ds_read_b64_tr_b16 v[78:79], v109 offset:35328
  s_waitcnt lgkmcnt(4)
  v_mfma_f32_32x32x16_bf16 v[36:51], v[68:71], a[128:131], v[36:51]
  v_mul_f32 v96, v20, v20
  v_mul_f32 v97, v21, v21
  v_mul_f32 v98, v22, v22
  ds_read_b64_tr_b16 v[80:81], v109 offset:35840
  ds_read_b64_tr_b16 v[82:83], v109 offset:36352
  s_waitcnt lgkmcnt(4)
  v_mfma_f32_32x32x16_bf16 v[36:51], v[72:75], a[132:135], v[36:51]
  v_mul_f32 v99, v23, v23
  v_fma_f32 v96, v96, v106, v104
  v_fma_f32 v97, v97, v106, v104
  ds_read_b64_tr_b16 v[68:69], v110 offset:0
  ds_read_b64_tr_b16 v[70:71], v110 offset:512
  s_waitcnt lgkmcnt(4)
  v_mfma_f32_32x32x16_bf16 v[36:51], v[76:79], a[136:139], v[36:51]
  v_fma_f32 v98, v98, v106, v104
  v_fma_f32 v99, v99, v106, v104
  v_mul_f32 v96, v20, v96
  ds_read_b64_tr_b16 v[72:73], v110 offset:1024
  ds_read_b64_tr_b16 v[74:75], v110 offset:1536
  s_waitcnt lgkmcnt(4)
  v_mfma_f32_32x32x16_bf16 v[36:51], v[80:83], a[140:143], v[36:51]
  v_mul_f32 v97, v21, v97
  v_mul_f32 v98, v22, v98
  v_mul_f32 v99, v23, v99
  ds_read_b64_tr_b16 v[76:77], v110 offset:2048
  ds_read_b64_tr_b16 v[78:79], v110 offset:2560
  s_waitcnt lgkmcnt(4)
  v_mfma_f32_32x32x16_bf16 v[52:67], v[68:71], a[0:3], 0
  v_exp_f32 v100, v96
  v_exp_f32 v101, v97
  v_exp_f32 v102, v98
  ds_read_b64_tr_b16 v[80:81], v110 offset:3072
  ds_read_b64_tr_b16 v[82:83], v110 offset:3584
  s_waitcnt lgkmcnt(4)
  v_mfma_f32_32x32x16_bf16 v[52:67], v[72:75], a[4:7], v[52:67]
  v_exp_f32 v103, v99
  v_mul_f32 v96, v20, v28
  v_mul_f32 v97, v21, v29
  ds_read_b64_tr_b16 v[68:69], v110 offset:4096
  ds_read_b64_tr_b16 v[70:71], v110 offset:4608
  s_waitcnt lgkmcnt(4)
  v_mfma_f32_32x32x16_bf16 v[52:67], v[76:79], a[8:11], v[52:67]
  v_mul_f32 v98, v22, v30
  v_mul_f32 v99, v23, v31
  v_fma_f32 v100, v100, v108, v108
  ds_read_b64_tr_b16 v[72:73], v110 offset:5120
  ds_read_b64_tr_b16 v[74:75], v110 offset:5632
  s_waitcnt lgkmcnt(4)
  v_mfma_f32_32x32x16_bf16 v[52:67], v[80:83], a[12:15], v[52:67]
  v_fma_f32 v101, v101, v108, v108
  v_fma_f32 v102, v102, v108, v108
  v_fma_f32 v103, v103, v108, v108
  ds_read_b64_tr_b16 v[76:77], v110 offset:6144
  ds_read_b64_tr_b16 v[78:79], v110 offset:6656
  s_waitcnt lgkmcnt(4)
  v_mfma_f32_32x32x16_bf16 v[52:67], v[68:71], a[16:19], v[52:67]
  v_rcp_f32 v100, v100
  v_rcp_f32 v101, v101
  v_rcp_f32 v102, v102
  ds_read_b64_tr_b16 v[80:81], v110 offset:7168
  ds_read_b64_tr_b16 v[82:83], v110 offset:7680
  s_waitcnt lgkmcnt(4)
  v_mfma_f32_32x32x16_bf16 v[52:67], v[72:75], a[20:23], v[52:67]
  v_rcp_f32 v103, v103
  s_nop 0
  v_mul_f32 v96, v96, v100
  ds_read_b64_tr_b16 v[68:69], v110 offset:8192
  ds_read_b64_tr_b16 v[70:71], v110 offset:8704
  s_waitcnt lgkmcnt(4)
  v_mfma_f32_32x32x16_bf16 v[52:67], v[76:79], a[24:27], v[52:67]
  v_mul_f32 v97, v97, v101
  v_mul_f32 v98, v98, v102
  v_mul_f32 v99, v99, v103
  ds_read_b64_tr_b16 v[72:73], v110 offset:9216
  ds_read_b64_tr_b16 v[74:75], v110 offset:9728
  s_waitcnt lgkmcnt(4)
  v_mfma_f32_32x32x16_bf16 v[52:67], v[80:83], a[28:31], v[52:67]
  v_cvt_pk_bf16_f32 v92, v96, v97
  v_cvt_pk_bf16_f32 v93, v98, v99
  v_mul_f32 v96, v24, v24
  ds_read_b64_tr_b16 v[76:77], v110 offset:10240
  ds_read_b64_tr_b16 v[78:79], v110 offset:10752
  s_waitcnt lgkmcnt(4)
  v_mfma_f32_32x32x16_bf16 v[52:67], v[68:71], a[32:35], v[52:67]
  v_mul_f32 v97, v25, v25
  v_mul_f32 v98, v26, v26
  v_mul_f32 v99, v27, v27
  ds_read_b64_tr_b16 v[80:81], v110 offset:11264
  ds_read_b64_tr_b16 v[82:83], v110 offset:11776
  s_waitcnt lgkmcnt(4)
  v_mfma_f32_32x32x16_bf16 v[52:67], v[72:75], a[36:39], v[52:67]
  v_fma_f32 v96, v96, v106, v104
  v_fma_f32 v97, v97, v106, v104
  v_fma_f32 v98, v98, v106, v104
  ds_read_b64_tr_b16 v[68:69], v110 offset:12288
  ds_read_b64_tr_b16 v[70:71], v110 offset:12800
  s_waitcnt lgkmcnt(4)
  v_mfma_f32_32x32x16_bf16 v[52:67], v[76:79], a[40:43], v[52:67]
  v_fma_f32 v99, v99, v106, v104
  v_mul_f32 v96, v24, v96
  v_mul_f32 v97, v25, v97
  ds_read_b64_tr_b16 v[72:73], v110 offset:13312
  ds_read_b64_tr_b16 v[74:75], v110 offset:13824
  s_waitcnt lgkmcnt(4)
  v_mfma_f32_32x32x16_bf16 v[52:67], v[80:83], a[44:47], v[52:67]
  v_mul_f32 v98, v26, v98
  v_mul_f32 v99, v27, v99
  v_exp_f32 v100, v96
  ds_read_b64_tr_b16 v[76:77], v110 offset:14336
  ds_read_b64_tr_b16 v[78:79], v110 offset:14848
  s_waitcnt lgkmcnt(4)
  v_mfma_f32_32x32x16_bf16 v[52:67], v[68:71], a[48:51], v[52:67]
  v_exp_f32 v101, v97
  v_exp_f32 v102, v98
  v_exp_f32 v103, v99
  ds_read_b64_tr_b16 v[80:81], v110 offset:15360
  ds_read_b64_tr_b16 v[82:83], v110 offset:15872
  s_waitcnt lgkmcnt(4)
  v_mfma_f32_32x32x16_bf16 v[52:67], v[72:75], a[52:55], v[52:67]
  v_mul_f32 v96, v24, v32
  v_mul_f32 v97, v25, v33
  v_mul_f32 v98, v26, v34
  ds_read_b64_tr_b16 v[68:69], v110 offset:16384
  ds_read_b64_tr_b16 v[70:71], v110 offset:16896
  s_waitcnt lgkmcnt(4)
  v_mfma_f32_32x32x16_bf16 v[52:67], v[76:79], a[56:59], v[52:67]
  v_mul_f32 v99, v27, v35
  v_fma_f32 v100, v100, v108, v108
  v_fma_f32 v101, v101, v108, v108
  ds_read_b64_tr_b16 v[72:73], v110 offset:17408
  ds_read_b64_tr_b16 v[74:75], v110 offset:17920
  s_waitcnt lgkmcnt(4)
  v_mfma_f32_32x32x16_bf16 v[52:67], v[80:83], a[60:63], v[52:67]
  v_fma_f32 v102, v102, v108, v108
  v_fma_f32 v103, v103, v108, v108
  v_rcp_f32 v100, v100
  ds_read_b64_tr_b16 v[76:77], v110 offset:18432
  ds_read_b64_tr_b16 v[78:79], v110 offset:18944
  s_waitcnt lgkmcnt(4)
  v_mfma_f32_32x32x16_bf16 v[52:67], v[68:71], a[64:67], v[52:67]
  v_rcp_f32 v101, v101
  v_rcp_f32 v102, v102
  v_rcp_f32 v103, v103
  ds_read_b64_tr_b16 v[80:81], v110 offset:19456
  ds_read_b64_tr_b16 v[82:83], v110 offset:19968
  s_waitcnt lgkmcnt(4)
  v_mfma_f32_32x32x16_bf16 v[52:67], v[72:75], a[68:71], v[52:67]
  s_nop 0
  v_mul_f32 v96, v96, v100
  v_mul_f32 v97, v97, v101
  ds_read_b64_tr_b16 v[68:69], v110 offset:20480
  ds_read_b64_tr_b16 v[70:71], v110 offset:20992
  s_waitcnt lgkmcnt(4)
  v_mfma_f32_32x32x16_bf16 v[52:67], v[76:79], a[72:75], v[52:67]
  v_mul_f32 v98, v98, v102
  v_mul_f32 v99, v99, v103
  v_cvt_pk_bf16_f32 v94, v96, v97
  ds_read_b64_tr_b16 v[72:73], v110 offset:21504
  ds_read_b64_tr_b16 v[74:75], v110 offset:22016
  s_waitcnt lgkmcnt(4)
  v_mfma_f32_32x32x16_bf16 v[52:67], v[80:83], a[76:79], v[52:67]
  v_cvt_pk_bf16_f32 v95, v98, v99
  s_add_u32 s41, s37, 5120
  buffer_store_dwordx4 v[92:95], v111, s[20:23], s41 offen sc1
  ds_read_b64_tr_b16 v[76:77], v110 offset:22528
  ds_read_b64_tr_b16 v[78:79], v110 offset:23040
  s_waitcnt lgkmcnt(4)
  v_mfma_f32_32x32x16_bf16 v[52:67], v[68:71], a[80:83], v[52:67]
  v_mul_f32 v96, v36, v36
  v_mul_f32 v97, v37, v37
  v_mul_f32 v98, v38, v38
  ds_read_b64_tr_b16 v[80:81], v110 offset:23552
  ds_read_b64_tr_b16 v[82:83], v110 offset:24064
  s_waitcnt lgkmcnt(4)
  v_mfma_f32_32x32x16_bf16 v[52:67], v[72:75], a[84:87], v[52:67]
  v_mul_f32 v99, v39, v39
  v_fma_f32 v96, v96, v106, v104
  v_fma_f32 v97, v97, v106, v104
  ds_read_b64_tr_b16 v[68:69], v110 offset:24576
  ds_read_b64_tr_b16 v[70:71], v110 offset:25088
  s_waitcnt lgkmcnt(4)
  v_mfma_f32_32x32x16_bf16 v[52:67], v[76:79], a[88:91], v[52:67]
  v_fma_f32 v98, v98, v106, v104
  v_fma_f32 v99, v99, v106, v104
  v_mul_f32 v96, v36, v96
  ds_read_b64_tr_b16 v[72:73], v110 offset:25600
  ds_read_b64_tr_b16 v[74:75], v110 offset:26112
  s_waitcnt lgkmcnt(4)
  v_mfma_f32_32x32x16_bf16 v[52:67], v[80:83], a[92:95], v[52:67]
  v_mul_f32 v97, v37, v97
  v_mul_f32 v98, v38, v98
  v_mul_f32 v99, v39, v99
  ds_read_b64_tr_b16 v[76:77], v110 offset:26624
  ds_read_b64_tr_b16 v[78:79], v110 offset:27136
  s_waitcnt lgkmcnt(4)
  v_mfma_f32_32x32x16_bf16 v[52:67], v[68:71], a[96:99], v[52:67]
  v_exp_f32 v100, v96
  v_exp_f32 v101, v97
  v_exp_f32 v102, v98
  ds_read_b64_tr_b16 v[80:81], v110 offset:27648
  ds_read_b64_tr_b16 v[82:83], v110 offset:28160
  s_waitcnt lgkmcnt(4)
  v_mfma_f32_32x32x16_bf16 v[52:67], v[72:75], a[100:103], v[52:67]
  v_exp_f32 v103, v99
  v_mul_f32 v96, v36, v44
  v_mul_f32 v97, v37, v45
  ds_read_b64_tr_b16 v[68:69], v110 offset:28672
  ds_read_b64_tr_b16 v[70:71], v110 offset:29184
  s_waitcnt lgkmcnt(4)
  v_mfma_f32_32x32x16_bf16 v[52:67], v[76:79], a[104:107], v[52:67]
  v_mul_f32 v98, v38, v46
  v_mul_f32 v99, v39, v47
  v_fma_f32 v100, v100, v108, v108
  ds_read_b64_tr_b16 v[72:73], v110 offset:29696
  ds_read_b64_tr_b16 v[74:75], v110 offset:30208
  s_waitcnt lgkmcnt(4)
  v_mfma_f32_32x32x16_bf16 v[52:67], v[80:83], a[108:111], v[52:67]
  v_fma_f32 v101, v101, v108, v108
  v_fma_f32 v102, v102, v108, v108
  v_fma_f32 v103, v103, v108, v108
  ds_read_b64_tr_b16 v[76:77], v110 offset:30720
  ds_read_b64_tr_b16 v[78:79], v110 offset:31232
  s_waitcnt lgkmcnt(4)
  v_mfma_f32_32x32x16_bf16 v[52:67], v[68:71], a[112:115], v[52:67]
  v_rcp_f32 v100, v100
  v_rcp_f32 v101, v101
  v_rcp_f32 v102, v102
  ds_read_b64_tr_b16 v[80:81], v110 offset:31744
  ds_read_b64_tr_b16 v[82:83], v110 offset:32256
  s_waitcnt lgkmcnt(4)
  v_mfma_f32_32x32x16_bf16 v[52:67], v[72:75], a[116:119], v[52:67]
  v_rcp_f32 v103, v103
  s_nop 0
  v_mul_f32 v96, v96, v100
  ds_read_b64_tr_b16 v[68:69], v110 offset:32768
  ds_read_b64_tr_b16 v[70:71], v110 offset:33280
  s_waitcnt lgkmcnt(4)
  v_mfma_f32_32x32x16_bf16 v[52:67], v[76:79], a[120:123], v[52:67]
  v_mul_f32 v97, v97, v101
  v_mul_f32 v98, v98, v102
  v_mul_f32 v99, v99, v103
  ds_read_b64_tr_b16 v[72:73], v110 offset:33792
  ds_read_b64_tr_b16 v[74:75], v110 offset:34304
  s_waitcnt lgkmcnt(4)
  v_mfma_f32_32x32x16_bf16 v[52:67], v[80:83], a[124:127], v[52:67]
  v_cvt_pk_bf16_f32 v92, v96, v97
  v_cvt_pk_bf16_f32 v93, v98, v99
  v_mul_f32 v96, v40, v40
  s_waitcnt vmcnt(3)
  s_barrier
  ds_read_b64_tr_b16 v[76:77], v110 offset:34816
  ds_read_b64_tr_b16 v[78:79], v110 offset:35328
  s_waitcnt lgkmcnt(4)
  v_mfma_f32_32x32x16_bf16 v[52:67], v[68:71], a[128:131], v[52:67]
  v_mul_f32 v97, v41, v41
  v_mul_f32 v98, v42, v42
  v_mul_f32 v99, v43, v43
  ds_read_b64_tr_b16 v[80:81], v110 offset:35840
  ds_read_b64_tr_b16 v[82:83], v110 offset:36352
  s_waitcnt lgkmcnt(4)
  v_mfma_f32_32x32x16_bf16 v[52:67], v[72:75], a[132:135], v[52:67]
  v_fma_f32 v96, v96, v106, v104
  v_fma_f32 v97, v97, v106, v104
  v_fma_f32 v98, v98, v106, v104
  ds_read_b64_tr_b16 v[68:69], v105 offset:0
  ds_read_b64_tr_b16 v[70:71], v105 offset:512
  s_waitcnt lgkmcnt(4)
  v_mfma_f32_32x32x16_bf16 v[52:67], v[76:79], a[136:139], v[52:67]
  v_fma_f32 v99, v99, v106, v104
  v_mul_f32 v96, v40, v96
  v_mul_f32 v97, v41, v97
  ds_read_b64_tr_b16 v[72:73], v105 offset:1024
  ds_read_b64_tr_b16 v[74:75], v105 offset:1536
  s_waitcnt lgkmcnt(4)
  v_mfma_f32_32x32x16_bf16 v[52:67], v[80:83], a[140:143], v[52:67]
  v_mul_f32 v98, v42, v98
  v_mul_f32 v99, v43, v99
  v_exp_f32 v100, v96
  ds_read_b64_tr_b16 v[76:77], v105 offset:2048
  ds_read_b64_tr_b16 v[78:79], v105 offset:2560
  s_waitcnt lgkmcnt(4)
  v_mfma_f32_32x32x16_bf16 v[4:19], v[68:71], a[0:3], 0
  v_exp_f32 v101, v97
  v_exp_f32 v102, v98
  v_exp_f32 v103, v99
  ds_read_b64_tr_b16 v[80:81], v105 offset:3072
  ds_read_b64_tr_b16 v[82:83], v105 offset:3584
  s_waitcnt lgkmcnt(4)
  v_mfma_f32_32x32x16_bf16 v[4:19], v[72:75], a[4:7], v[4:19]
  v_mul_f32 v96, v40, v48
  v_mul_f32 v97, v41, v49
  v_mul_f32 v98, v42, v50
  ds_read_b64_tr_b16 v[68:69], v105 offset:4096
  ds_read_b64_tr_b16 v[70:71], v105 offset:4608
  s_waitcnt lgkmcnt(4)
  v_mfma_f32_32x32x16_bf16 v[4:19], v[76:79], a[8:11], v[4:19]
  v_mul_f32 v99, v43, v51
  v_fma_f32 v100, v100, v108, v108
  v_fma_f32 v101, v101, v108, v108
  ds_read_b64_tr_b16 v[72:73], v105 offset:5120
  ds_read_b64_tr_b16 v[74:75], v105 offset:5632
  s_waitcnt lgkmcnt(4)
  v_mfma_f32_32x32x16_bf16 v[4:19], v[80:83], a[12:15], v[4:19]
  v_fma_f32 v102, v102, v108, v108
  v_fma_f32 v103, v103, v108, v108
  v_rcp_f32 v100, v100
  ds_read_b64_tr_b16 v[76:77], v105 offset:6144
  ds_read_b64_tr_b16 v[78:79], v105 offset:6656
  s_waitcnt lgkmcnt(4)
  v_mfma_f32_32x32x16_bf16 v[4:19], v[68:71], a[16:19], v[4:19]
  v_rcp_f32 v101, v101
  v_rcp_f32 v102, v102
  v_rcp_f32 v103, v103
  ds_read_b64_tr_b16 v[80:81], v105 offset:7168
  ds_read_b64_tr_b16 v[82:83], v105 offset:7680
  s_waitcnt lgkmcnt(4)
  v_mfma_f32_32x32x16_bf16 v[4:19], v[72:75], a[20:23], v[4:19]
  s_nop 0
  v_mul_f32 v96, v96, v100
  v_mul_f32 v97, v97, v101
  ds_read_b64_tr_b16 v[68:69], v105 offset:8192
  ds_read_b64_tr_b16 v[70:71], v105 offset:8704
  s_waitcnt lgkmcnt(4)
  v_mfma_f32_32x32x16_bf16 v[4:19], v[76:79], a[24:27], v[4:19]
  v_mul_f32 v98, v98, v102
  v_mul_f32 v99, v99, v103
  v_cvt_pk_bf16_f32 v94, v96, v97
  ds_read_b64_tr_b16 v[72:73], v105 offset:9216
  ds_read_b64_tr_b16 v[74:75], v105 offset:9728
  s_waitcnt lgkmcnt(4)
  v_mfma_f32_32x32x16_bf16 v[4:19], v[80:83], a[28:31], v[4:19]
  v_cvt_pk_bf16_f32 v95, v98, v99
  s_add_u32 s41, s37, 6144
  buffer_store_dwordx4 v[92:95], v111, s[20:23], s41 offen sc1
  ds_read_b64_tr_b16 v[76:77], v105 offset:10240
  ds_read_b64_tr_b16 v[78:79], v105 offset:10752
  s_waitcnt lgkmcnt(4)
  v_mfma_f32_32x32x16_bf16 v[4:19], v[68:71], a[32:35], v[4:19]
  v_mul_f32 v96, v52, v52
  v_mul_f32 v97, v53, v53
  v_mul_f32 v98, v54, v54
  ds_read_b64_tr_b16 v[80:81], v105 offset:11264
  ds_read_b64_tr_b16 v[82:83], v105 offset:11776
  s_waitcnt lgkmcnt(4)
  v_mfma_f32_32x32x16_bf16 v[4:19], v[72:75], a[36:39], v[4:19]
  v_mul_f32 v99, v55, v55
  v_fma_f32 v96, v96, v106, v104
  v_fma_f32 v97, v97, v106, v104
  ds_read_b64_tr_b16 v[68:69], v105 offset:12288
  ds_read_b64_tr_b16 v[70:71], v105 offset:12800
  s_waitcnt lgkmcnt(4)
  v_mfma_f32_32x32x16_bf16 v[4:19], v[76:79], a[40:43], v[4:19]
  v_fma_f32 v98, v98, v106, v104
  v_fma_f32 v99, v99, v106, v104
  v_mul_f32 v96, v52, v96
  ds_read_b64_tr_b16 v[72:73], v105 offset:13312
  ds_read_b64_tr_b16 v[74:75], v105 offset:13824
  s_waitcnt lgkmcnt(4)
  v_mfma_f32_32x32x16_bf16 v[4:19], v[80:83], a[44:47], v[4:19]
  v_mul_f32 v97, v53, v97
  v_mul_f32 v98, v54, v98
  v_mul_f32 v99, v55, v99
  ds_read_b64_tr_b16 v[76:77], v105 offset:14336
  ds_read_b64_tr_b16 v[78:79], v105 offset:14848
  s_waitcnt lgkmcnt(4)
  v_mfma_f32_32x32x16_bf16 v[4:19], v[68:71], a[48:51], v[4:19]
  v_exp_f32 v100, v96
  v_exp_f32 v101, v97
  v_exp_f32 v102, v98
  ds_read_b64_tr_b16 v[80:81], v105 offset:15360
  ds_read_b64_tr_b16 v[82:83], v105 offset:15872
  s_waitcnt lgkmcnt(4)
  v_mfma_f32_32x32x16_bf16 v[4:19], v[72:75], a[52:55], v[4:19]
  v_exp_f32 v103, v99
  v_mul_f32 v96, v52, v60
  v_mul_f32 v97, v53, v61
  ds_read_b64_tr_b16 v[68:69], v105 offset:16384
  ds_read_b64_tr_b16 v[70:71], v105 offset:16896
  s_waitcnt lgkmcnt(4)
  v_mfma_f32_32x32x16_bf16 v[4:19], v[76:79], a[56:59], v[4:19]
  v_mul_f32 v98, v54, v62
  v_mul_f32 v99, v55, v63
  v_fma_f32 v100, v100, v108, v108
  ds_read_b64_tr_b16 v[72:73], v105 offset:17408
  ds_read_b64_tr_b16 v[74:75], v105 offset:17920
  s_waitcnt lgkmcnt(4)
  v_mfma_f32_32x32x16_bf16 v[4:19], v[80:83], a[60:63], v[4:19]
  v_fma_f32 v101, v101, v108, v108
  v_fma_f32 v102, v102, v108, v108
  v_fma_f32 v103, v103, v108, v108
  ds_read_b64_tr_b16 v[76:77], v105 offset:18432
  ds_read_b64_tr_b16 v[78:79], v105 offset:18944
  s_waitcnt lgkmcnt(4)
  v_mfma_f32_32x32x16_bf16 v[4:19], v[68:71], a[64:67], v[4:19]
  v_rcp_f32 v100, v100
  v_rcp_f32 v101, v101
  v_rcp_f32 v102, v102
  ds_read_b64_tr_b16 v[80:81], v105 offset:19456
  ds_read_b64_tr_b16 v[82:83], v105 offset:19968
  s_waitcnt lgkmcnt(4)
  v_mfma_f32_32x32x16_bf16 v[4:19], v[72:75], a[68:71], v[4:19]
  v_rcp_f32 v103, v103
  s_nop 0
  v_mul_f32 v96, v96, v100
  ds_read_b64_tr_b16 v[68:69], v105 offset:20480
  ds_read_b64_tr_b16 v[70:71], v105 offset:20992
  s_waitcnt lgkmcnt(4)
  v_mfma_f32_32x32x16_bf16 v[4:19], v[76:79], a[72:75], v[4:19]
  v_mul_f32 v97, v97, v101
  v_mul_f32 v98, v98, v102
  v_mul_f32 v99, v99, v103
  ds_read_b64_tr_b16 v[72:73], v105 offset:21504
  ds_read_b64_tr_b16 v[74:75], v105 offset:22016
  s_waitcnt lgkmcnt(4)
  v_mfma_f32_32x32x16_bf16 v[4:19], v[80:83], a[76:79], v[4:19]
  v_cvt_pk_bf16_f32 v92, v96, v97
  v_cvt_pk_bf16_f32 v93, v98, v99
  v_mul_f32 v96, v56, v56
  ds_read_b64_tr_b16 v[76:77], v105 offset:22528
  ds_read_b64_tr_b16 v[78:79], v105 offset:23040
  s_waitcnt lgkmcnt(4)
  v_mfma_f32_32x32x16_bf16 v[4:19], v[68:71], a[80:83], v[4:19]
  v_mul_f32 v97, v57, v57
  v_mul_f32 v98, v58, v58
  v_mul_f32 v99, v59, v59
  ds_read_b64_tr_b16 v[80:81], v105 offset:23552
  ds_read_b64_tr_b16 v[82:83], v105 offset:24064
  s_waitcnt lgkmcnt(4)
  v_mfma_f32_32x32x16_bf16 v[4:19], v[72:75], a[84:87], v[4:19]
  v_fma_f32 v96, v96, v106, v104
  v_fma_f32 v97, v97, v106, v104
  v_fma_f32 v98, v98, v106, v104
  ds_read_b64_tr_b16 v[68:69], v105 offset:24576
  ds_read_b64_tr_b16 v[70:71], v105 offset:25088
  s_waitcnt lgkmcnt(4)
  v_mfma_f32_32x32x16_bf16 v[4:19], v[76:79], a[88:91], v[4:19]
  v_fma_f32 v99, v99, v106, v104
  v_mul_f32 v96, v56, v96
  v_mul_f32 v97, v57, v97
  ds_read_b64_tr_b16 v[72:73], v105 offset:25600
  ds_read_b64_tr_b16 v[74:75], v105 offset:26112
  s_waitcnt lgkmcnt(4)
  v_mfma_f32_32x32x16_bf16 v[4:19], v[80:83], a[92:95], v[4:19]
  v_mul_f32 v98, v58, v98
  v_mul_f32 v99, v59, v99
  v_exp_f32 v100, v96
  ds_read_b64_tr_b16 v[76:77], v105 offset:26624
  ds_read_b64_tr_b16 v[78:79], v105 offset:27136
  s_waitcnt lgkmcnt(4)
  v_mfma_f32_32x32x16_bf16 v[4:19], v[68:71], a[96:99], v[4:19]
  v_exp_f32 v101, v97
  v_exp_f32 v102, v98
  v_exp_f32 v103, v99
  ds_read_b64_tr_b16 v[80:81], v105 offset:27648
  ds_read_b64_tr_b16 v[82:83], v105 offset:28160
  s_waitcnt lgkmcnt(4)
  v_mfma_f32_32x32x16_bf16 v[4:19], v[72:75], a[100:103], v[4:19]
  v_mul_f32 v96, v56, v64
  v_mul_f32 v97, v57, v65
  v_mul_f32 v98, v58, v66
  ds_read_b64_tr_b16 v[68:69], v105 offset:28672
  ds_read_b64_tr_b16 v[70:71], v105 offset:29184
  s_waitcnt lgkmcnt(4)
  v_mfma_f32_32x32x16_bf16 v[4:19], v[76:79], a[104:107], v[4:19]
  v_mul_f32 v99, v59, v67
  v_fma_f32 v100, v100, v108, v108
  v_fma_f32 v101, v101, v108, v108
  ds_read_b64_tr_b16 v[72:73], v105 offset:29696
  ds_read_b64_tr_b16 v[74:75], v105 offset:30208
  s_waitcnt lgkmcnt(4)
  v_mfma_f32_32x32x16_bf16 v[4:19], v[80:83], a[108:111], v[4:19]
  v_fma_f32 v102, v102, v108, v108
  v_fma_f32 v103, v103, v108, v108
  v_rcp_f32 v100, v100
  ds_read_b64_tr_b16 v[76:77], v105 offset:30720
  ds_read_b64_tr_b16 v[78:79], v105 offset:31232
  s_waitcnt lgkmcnt(4)
  v_mfma_f32_32x32x16_bf16 v[4:19], v[68:71], a[112:115], v[4:19]
  v_rcp_f32 v101, v101
  v_rcp_f32 v102, v102
  v_rcp_f32 v103, v103
  ds_read_b64_tr_b16 v[80:81], v105 offset:31744
  ds_read_b64_tr_b16 v[82:83], v105 offset:32256
  s_waitcnt lgkmcnt(4)
  v_mfma_f32_32x32x16_bf16 v[4:19], v[72:75], a[116:119], v[4:19]
  s_nop 0
  v_mul_f32 v96, v96, v100
  v_mul_f32 v97, v97, v101
  ds_read_b64_tr_b16 v[68:69], v105 offset:32768
  ds_read_b64_tr_b16 v[70:71], v105 offset:33280
  s_waitcnt lgkmcnt(4)
  v_mfma_f32_32x32x16_bf16 v[4:19], v[76:79], a[120:123], v[4:19]
  v_mul_f32 v98, v98, v102
  v_mul_f32 v99, v99, v103
  v_cvt_pk_bf16_f32 v94, v96, v97
  ds_read_b64_tr_b16 v[72:73], v105 offset:33792
  ds_read_b64_tr_b16 v[74:75], v105 offset:34304
  s_waitcnt lgkmcnt(4)
  v_mfma_f32_32x32x16_bf16 v[4:19], v[80:83], a[124:127], v[4:19]
  v_cvt_pk_bf16_f32 v95, v98, v99
  s_add_u32 s41, s37, 7168
  buffer_store_dwordx4 v[92:95], v111, s[20:23], s41 offen sc1
  ds_read_b64_tr_b16 v[76:77], v105 offset:34816
  ds_read_b64_tr_b16 v[78:79], v105 offset:35328
  s_waitcnt lgkmcnt(4)
  v_mfma_f32_32x32x16_bf16 v[4:19], v[68:71], a[128:131], v[4:19]
  ds_read_b64_tr_b16 v[80:81], v105 offset:35840
  ds_read_b64_tr_b16 v[82:83], v105 offset:36352
  s_waitcnt lgkmcnt(4)
  v_mfma_f32_32x32x16_bf16 v[4:19], v[72:75], a[132:135], v[4:19]
  s_waitcnt lgkmcnt(2)
  v_mfma_f32_32x32x16_bf16 v[4:19], v[76:79], a[136:139], v[4:19]
  s_waitcnt lgkmcnt(0)
  v_mfma_f32_32x32x16_bf16 v[4:19], v[80:83], a[140:143], v[4:19]
  s_nop 7
  s_nop 7
  v_mul_f32 v96, v4, v4
  v_mul_f32 v97, v5, v5
  v_mul_f32 v98, v6, v6
  v_mul_f32 v99, v7, v7
  v_fma_f32 v96, v96, v106, v104
  v_fma_f32 v97, v97, v106, v104
  v_fma_f32 v98, v98, v106, v104
  v_fma_f32 v99, v99, v106, v104
  v_mul_f32 v96, v4, v96
  v_mul_f32 v97, v5, v97
  v_mul_f32 v98, v6, v98
  v_mul_f32 v99, v7, v99
  v_exp_f32 v100, v96
  v_exp_f32 v101, v97
  v_exp_f32 v102, v98
  v_exp_f32 v103, v99
  v_mul_f32 v96, v4, v12
  v_mul_f32 v97, v5, v13
  v_mul_f32 v98, v6, v14
  v_mul_f32 v99, v7, v15
  v_fma_f32 v100, v100, v108, v108
  v_fma_f32 v101, v101, v108, v108
  v_fma_f32 v102, v102, v108, v108
  v_fma_f32 v103, v103, v108, v108
  v_rcp_f32 v100, v100
  v_rcp_f32 v101, v101
  v_rcp_f32 v102, v102
  v_rcp_f32 v103, v103
  s_nop 0
  v_mul_f32 v96, v96, v100
  v_mul_f32 v97, v97, v101
  v_mul_f32 v98, v98, v102
  v_mul_f32 v99, v99, v103
  v_cvt_pk_bf16_f32 v92, v96, v97
  v_cvt_pk_bf16_f32 v93, v98, v99
  v_mul_f32 v96, v8, v8
  v_mul_f32 v97, v9, v9
  v_mul_f32 v98, v10, v10
  v_mul_f32 v99, v11, v11
  v_fma_f32 v96, v96, v106, v104
  v_fma_f32 v97, v97, v106, v104
  v_fma_f32 v98, v98, v106, v104
  v_fma_f32 v99, v99, v106, v104
  v_mul_f32 v96, v8, v96
  v_mul_f32 v97, v9, v97
  v_mul_f32 v98, v10, v98
  v_mul_f32 v99, v11, v99
  v_exp_f32 v100, v96
  v_exp_f32 v101, v97
  v_exp_f32 v102, v98
  v_exp_f32 v103, v99
  v_mul_f32 v96, v8, v16
  v_mul_f32 v97, v9, v17
  v_mul_f32 v98, v10, v18
  v_mul_f32 v99, v11, v19
  v_fma_f32 v100, v100, v108, v108
  v_fma_f32 v101, v101, v108, v108
  v_fma_f32 v102, v102, v108, v108
  v_fma_f32 v103, v103, v108, v108
  v_rcp_f32 v100, v100
  v_rcp_f32 v101, v101
  v_rcp_f32 v102, v102
  v_rcp_f32 v103, v103
  s_nop 0
  v_mul_f32 v96, v96, v100
  v_mul_f32 v97, v97, v101
  v_mul_f32 v98, v98, v102
  v_mul_f32 v99, v99, v103
  v_cvt_pk_bf16_f32 v94, v96, v97
  v_cvt_pk_bf16_f32 v95, v98, v99
  s_add_u32 s41, s37, 8192
  buffer_store_dwordx4 v[92:95], v111, s[20:23], s41 offen sc1
ffn1_kernel_end:
  s_endpgm
.section .rodata,"a"
.p2align 6
.amdhsa_kernel ffn1_kernel
.amdhsa_next_free_vgpr 256
.amdhsa_next_free_sgpr 100
.amdhsa_accum_offset 112
.amdhsa_group_segment_fixed_size 0
.amdhsa_kernarg_size 80
.amdhsa_user_sgpr_count 2
.amdhsa_user_sgpr_kernarg_segment_ptr 1
.amdhsa_system_sgpr_workgroup_id_x 1
.amdhsa_float_denorm_mode_32 3
.amdhsa_ieee_mode 0
.end_amdhsa_kernel
.text
.globl ffn2_kernel
.p2align 8
.type ffn2_kernel,@function
ffn2_kernel:
  s_cmp_ge_u32 s2, 256
  s_cbranch_scc1 ffn2_kernel_end
  s_getpc_b64 s[94:95]
ffn2_kernel_pc:
  s_sub_u32 s94, s94, ffn2_kernel_pc-code_begin
  s_subb_u32 s95, s95, 0
  v_lshlrev_b32 v180, 7, v0
  v_min_u32 v180, code_end-code_begin-4, v180
  global_load_dword v236, v180, s[94:95]
  s_load_dwordx2 s[8:9], s[0:1], 72
  s_load_dwordx2 s[4:5], s[0:1], 56
  v_lshrrev_b32 v180, 6, v0
  v_and_b32 v172, 63, v0
  v_readfirstlane_b32 s24, v180
  s_and_b32 s25, s2, 7
  s_lshr_b32 s26, s25, 1
  s_and_b32 s25, s25, 1
  s_lshl_b32 s25, s25, 3
  s_bfe_u32 s27, s2, 0x30003
  s_add_u32 s25, s25, s27
  s_lshr_b32 s27, s2, 6
  s_and_b32 s29, s24, 3
  s_lshr_b32 s30, s24, 2
  s_lshl_b32 s28, s25, 2
  s_add_u32 s28, s28, s29
  v_lshlrev_b32 v175, 4, v172
  s_mul_i32 s32, s27, 72
  s_mul_i32 s33, s26, 18
  s_add_u32 s32, s32, s33
  s_mul_i32 s32, s32, 18432
  s_mul_i32 s34, s24, 5120
  s_lshl_b32 s99, s24, 12
  s_add_u32 s99, s99, 4096
  s_cmp_lt_u32 s24, 4
  s_cselect_b32 s34, s34, s99
  s_add_u32 s32, s32, s34
  s_mul_i32 s35, s28, 288
  s_mul_i32 s36, s26, 72
  s_add_u32 s35, s35, s36
  s_add_u32 s35, s35, s30
  s_lshl_b32 s35, s35, 10
  s_waitcnt lgkmcnt(0)
  s_add_u32 s12, s8, 33554432
  s_addc_u32 s13, s9, 0
  s_mov_b32 s14, 5308416
  s_mov_b32 s15, 0x00020000
  s_add_u32 s16, s8, 39845888
  s_addc_u32 s17, s9, 0
  s_mov_b32 s18, 18874368
  s_mov_b32 s19, 0x00020000
  s_add_u32 m0, s34, 0
  s_add_u32 s40, s32, 0
  buffer_load_dwordx4 v175, s[12:15], s40 offen lds
  buffer_load_dwordx4 v175, s[12:15], s40 offen offset:1024 lds
  buffer_load_dwordx4 v175, s[12:15], s40 offen offset:2048 lds
  buffer_load_dwordx4 v175, s[12:15], s40 offen offset:3072 lds
  s_cmp_ge_u32 s24, 4
  s_cbranch_scc1 ffn2_kernel_sk1
  s_add_u32 m0, s34, 4096
  s_add_u32 s40, s32, 4096
  buffer_load_dwordx4 v175, s[12:15], s40 offen lds
ffn2_kernel_sk1:
  s_add_u32 s41, s35, 0
  buffer_load_dwordx4 v[84:87], v175, s[16:19], s41 offen offset:0 sc1
  buffer_load_dwordx4 v[88:91], v175, s[16:19], s41 offen offset:2048 sc1
  s_add_u32 s41, s35, 4096
  buffer_load_dwordx4 v[92:95], v175, s[16:19], s41 offen offset:0 sc1
  buffer_load_dwordx4 v[96:99], v175, s[16:19], s41 offen offset:2048 sc1
  v_lshrrev_b32 v173, 5, v172
  v_and_b32 v174, 31, v172
  v_bfe_u32 v180, v172, 2, 2
  v_lshl_add_u32 v180, v173, 2, v180
  v_and_b32 v181, 3, v172
  v_lshlrev_b32 v177, 5, v180
  s_lshl_b32 s37, s30, 1
  v_xor_b32 v182, s37, v181
  v_lshl_add_u32 v177, v182, 3, v177
  s_lshl_b32 s37, s30, 9
  s_add_u32 s37, s37, 16384
  v_add_u32 v177, s37, v177
  v_lshlrev_b32 v176, 6, v180
  v_lshl_add_u32 v176, v181, 3, v176
  v_bfe_u32 v181, v172, 4, 1
  v_xor_b32 v181, s30, v181
  v_lshl_add_u32 v176, v181, 5, v176
  s_lshl_b32 s37, s30, 10
  v_add_u32 v176, s37, v176
  v_mov_b32 v178, v176
  v_mov_b32 v179, v177
  v_mov_b32 v4, 0
  v_mov_b32 v5, 0
  v_mov_b32 v6, 0
  v_mov_b32 v7, 0
  v_mov_b32 v8, 0
  v_mov_b32 v9, 0
  v_mov_b32 v10, 0
  v_mov_b32 v11, 0
  v_mov_b32 v12, 0
  v_mov_b32 v13, 0
  v_mov_b32 v14, 0
  v_mov_b32 v15, 0
  v_mov_b32 v16, 0
  v_mov_b32 v17, 0
  v_mov_b32 v18, 0
  v_mov_b32 v19, 0
  v_mov_b32 v20, 0
  v_mov_b32 v21, 0
  v_mov_b32 v22, 0
  v_mov_b32 v23, 0
  v_mov_b32 v24, 0
  v_mov_b32 v25, 0
  v_mov_b32 v26, 0
  v_mov_b32 v27, 0
  v_mov_b32 v28, 0
  v_mov_b32 v29, 0
  v_mov_b32 v30, 0
  v_mov_b32 v31, 0
  v_mov_b32 v32, 0
  v_mov_b32 v33, 0
  v_mov_b32 v34, 0
  v_mov_b32 v35, 0
  v_mov_b32 v36, 0
  v_mov_b32 v37, 0
  v_mov_b32 v38, 0
  v_mov_b32 v39, 0
  v_mov_b32 v40, 0
  v_mov_b32 v41, 0
  v_mov_b32 v42, 0
  v_mov_b32 v43, 0
  v_mov_b32 v44, 0
  v_mov_b32 v45, 0
  v_mov_b32 v46, 0
  v_mov_b32 v47, 0
  v_mov_b32 v48, 0
  v_mov_b32 v49, 0
  v_mov_b32 v50, 0
  v_mov_b32 v51, 0
  v_mov_b32 v52, 0
  v_mov_b32 v53, 0
  v_mov_b32 v54, 0
  v_mov_b32 v55, 0
  v_mov_b32 v56, 0
  v_mov_b32 v57, 0
  v_mov_b32 v58, 0
  v_mov_b32 v59, 0
  v_mov_b32 v60, 0
  v_mov_b32 v61, 0
  v_mov_b32 v62, 0
  v_mov_b32 v63, 0
  v_mov_b32 v64, 0
  v_mov_b32 v65, 0
  v_mov_b32 v66, 0
  v_mov_b32 v67, 0
  v_mov_b32 v68, 0
  v_mov_b32 v69, 0
  v_mov_b32 v70, 0
  v_mov_b32 v71, 0
  v_mov_b32 v72, 0
  v_mov_b32 v73, 0
  v_mov_b32 v74, 0
  v_mov_b32 v75, 0
  v_mov_b32 v76, 0
  v_mov_b32 v77, 0
  v_mov_b32 v78, 0
  v_mov_b32 v79, 0
  v_mov_b32 v80, 0
  v_mov_b32 v81, 0
  v_mov_b32 v82, 0
  v_mov_b32 v83, 0
  s_waitcnt vmcnt(4)
  s_barrier
  ds_read_b64_tr_b16 v[132:133], v178 offset:0
  ds_read_b64_tr_b16 v[134:135], v178 offset:512
  ds_read_b64_tr_b16 v[136:137], v178 offset:4096
  ds_read_b64_tr_b16 v[138:139], v178 offset:4608
  ds_read_b64_tr_b16 v[140:141], v178 offset:8192
  ds_read_b64_tr_b16 v[142:143], v178 offset:8704
  ds_read_b64_tr_b16 v[144:145], v178 offset:12288
  ds_read_b64_tr_b16 v[146:147], v178 offset:12800
  ds_read_b64_tr_b16 v[148:149], v179 offset:0
  ds_read_b64_tr_b16 v[150:151], v179 offset:256
  s_add_u32 m0, s34, 36864
  s_add_u32 s40, s32, 36864
  buffer_load_dwordx4 v175, s[12:15], s40 offen lds
  buffer_load_dwordx4 v175, s[12:15], s40 offen offset:1024 lds
  buffer_load_dwordx4 v175, s[12:15], s40 offen offset:2048 lds
  buffer_load_dwordx4 v175, s[12:15], s40 offen offset:3072 lds
  s_cmp_ge_u32 s24, 4
  s_cbranch_scc1 ffn2_kernel_sk2
  s_add_u32 m0, s34, 40960
  s_add_u32 s40, s32, 40960
  buffer_load_dwordx4 v175, s[12:15], s40 offen lds
ffn2_kernel_sk2:
  s_add_u32 s41, s35, 8192
  buffer_load_dwordx4 v[100:103], v175, s[16:19], s41 offen offset:0 sc1
  buffer_load_dwordx4 v[104:107], v175, s[16:19], s41 offen offset:2048 sc1
  s_add_u32 s41, s35, 12288
  buffer_load_dwordx4 v[108:111], v175, s[16:19], s41 offen offset:0 sc1
  buffer_load_dwordx4 v[112:115], v175, s[16:19], s41 offen offset:2048 sc1
  s_waitcnt vmcnt(11) lgkmcnt(4)
  v_mfma_f32_32x32x16_bf16 v[4:19], v[132:135], v[84:87], v[4:19]
  ds_read_b64_tr_b16 v[152:153], v178 offset:2048
  ds_read_b64_tr_b16 v[154:155], v178 offset:2560
  v_mfma_f32_32x32x16_bf16 v[20:35], v[136:139], v[84:87], v[20:35]
  ds_read_b64_tr_b16 v[156:157], v178 offset:6144
  ds_read_b64_tr_b16 v[158:159], v178 offset:6656
  v_mfma_f32_32x32x16_bf16 v[36:51], v[140:143], v[84:87], v[36:51]
  ds_read_b64_tr_b16 v[160:161], v178 offset:10240
  ds_read_b64_tr_b16 v[162:163], v178 offset:10752
  s_waitcnt lgkmcnt(6)
  v_mfma_f32_32x32x16_bf16 v[52:67], v[144:147], v[84:87], v[52:67]
  ds_read_b64_tr_b16 v[164:165], v178 offset:14336
  ds_read_b64_tr_b16 v[166:167], v178 offset:14848
  v_mfma_f32_32x32x16_bf16 v[68:83], v[148:151], v[84:87], v[68:83]
  ds_read_b64_tr_b16 v[168:169], v179 offset:1024
  ds_read_b64_tr_b16 v[170:171], v179 offset:1280
  s_add_u32 m0, s34, 73728
  s_add_u32 s40, s32, 73728
  buffer_load_dwordx4 v175, s[12:15], s40 offen lds
  buffer_load_dwordx4 v175, s[12:15], s40 offen offset:1024 lds
  buffer_load_dwordx4 v175, s[12:15], s40 offen offset:2048 lds
  buffer_load_dwordx4 v175, s[12:15], s40 offen offset:3072 lds
  s_cmp_ge_u32 s24, 4
  s_cbranch_scc1 ffn2_kernel_sk3
  s_add_u32 m0, s34, 77824
  s_add_u32 s40, s32, 77824
  buffer_load_dwordx4 v175, s[12:15], s40 offen lds
ffn2_kernel_sk3:
  s_add_u32 s41, s35, 16384
  buffer_load_dwordx4 v[116:119], v175, s[16:19], s41 offen offset:0 sc1
  buffer_load_dwordx4 v[120:123], v175, s[16:19], s41 offen offset:2048 sc1
  s_waitcnt vmcnt(16) lgkmcnt(4)
  v_mfma_f32_32x32x16_bf16 v[4:19], v[152:155], v[88:91], v[4:19]
  ds_read_b64_tr_b16 v[132:133], v178 offset:18432
  ds_read_b64_tr_b16 v[134:135], v178 offset:18944
  v_mfma_f32_32x32x16_bf16 v[20:35], v[156:159], v[88:91], v[20:35]
  ds_read_b64_tr_b16 v[136:137], v178 offset:22528
  ds_read_b64_tr_b16 v[138:139], v178 offset:23040
  v_mfma_f32_32x32x16_bf16 v[36:51], v[160:163], v[88:91], v[36:51]
  ds_read_b64_tr_b16 v[140:141], v178 offset:26624
  ds_read_b64_tr_b16 v[142:143], v178 offset:27136
  s_waitcnt lgkmcnt(6)
  v_mfma_f32_32x32x16_bf16 v[52:67], v[164:167], v[88:91], v[52:67]
  ds_read_b64_tr_b16 v[144:145], v178 offset:30720
  ds_read_b64_tr_b16 v[146:147], v178 offset:31232
  v_mfma_f32_32x32x16_bf16 v[68:83], v[168:171], v[88:91], v[68:83]
  ds_read_b64_tr_b16 v[148:149], v179 offset:18432
  ds_read_b64_tr_b16 v[150:151], v179 offset:18688
  s_add_u32 s41, s35, 20480
  buffer_load_dwordx4 v[124:127], v175, s[16:19], s41 offen offset:0 sc1
  buffer_load_dwordx4 v[128:131], v175, s[16:19], s41 offen offset:2048 sc1
  s_waitcnt vmcnt(12)
  s_barrier
  s_waitcnt vmcnt(17) lgkmcnt(4)
  v_mfma_f32_32x32x16_bf16 v[4:19], v[132:135], v[92:95], v[4:19]
  ds_read_b64_tr_b16 v[152:153], v178 offset:20480
  ds_read_b64_tr_b16 v[154:155], v178 offset:20992
  s_add_u32 m0, s34, 110592
  s_add_u32 s40, s32, 110592
  buffer_load_dwordx4 v175, s[12:15], s40 offen lds
  v_mfma_f32_32x32x16_bf16 v[20:35], v[136:139], v[92:95], v[20:35]
  ds_read_b64_tr_b16 v[156:157], v178 offset:24576
  ds_read_b64_tr_b16 v[158:159], v178 offset:25088
  buffer_load_dwordx4 v175, s[12:15], s40 offen offset:1024 lds
  v_mfma_f32_32x32x16_bf16 v[36:51], v[140:143], v[92:95], v[36:51]
  ds_read_b64_tr_b16 v[160:161], v178 offset:28672
  ds_read_b64_tr_b16 v[162:163], v178 offset:29184
  buffer_load_dwordx4 v175, s[12:15], s40 offen offset:2048 lds
  s_waitcnt lgkmcnt(6)
  v_mfma_f32_32x32x16_bf16 v[52:67], v[144:147], v[92:95], v[52:67]
  ds_read_b64_tr_b16 v[164:165], v178 offset:32768
  ds_read_b64_tr_b16 v[166:167], v178 offset:33280
  buffer_load_dwordx4 v175, s[12:15], s40 offen offset:3072 lds
  v_mfma_f32_32x32x16_bf16 v[68:83], v[148:151], v[92:95], v[68:83]
  ds_read_b64_tr_b16 v[168:169], v179 offset:19456
  ds_read_b64_tr_b16 v[170:171], v179 offset:19712
  s_cmp_ge_u32 s24, 4
  s_cbranch_scc1 ffn2_kernel_sk4
  s_add_u32 m0, s34, 114688
  s_add_u32 s40, s32, 114688
  buffer_load_dwordx4 v175, s[12:15], s40 offen lds
ffn2_kernel_sk4:
  s_add_u32 s41, s35, 24576
  buffer_load_dwordx4 v[84:87], v175, s[16:19], s41 offen offset:0 sc1
  buffer_load_dwordx4 v[88:91], v175, s[16:19], s41 offen offset:2048 sc1
  v_add_u32 v178, 36864, v176
  v_add_u32 v179, 36864, v177
  s_waitcnt vmcnt(22) lgkmcnt(4)
  v_mfma_f32_32x32x16_bf16 v[4:19], v[152:155], v[96:99], v[4:19]
  ds_read_b64_tr_b16 v[132:133], v178 offset:0
  ds_read_b64_tr_b16 v[134:135], v178 offset:512
  v_mfma_f32_32x32x16_bf16 v[20:35], v[156:159], v[96:99], v[20:35]
  ds_read_b64_tr_b16 v[136:137], v178 offset:4096
  ds_read_b64_tr_b16 v[138:139], v178 offset:4608
  v_mfma_f32_32x32x16_bf16 v[36:51], v[160:163], v[96:99], v[36:51]
  ds_read_b64_tr_b16 v[140:141], v178 offset:8192
  ds_read_b64_tr_b16 v[142:143], v178 offset:8704
  s_waitcnt lgkmcnt(6)
  v_mfma_f32_32x32x16_bf16 v[52:67], v[164:167], v[96:99], v[52:67]
  ds_read_b64_tr_b16 v[144:145], v178 offset:12288
  ds_read_b64_tr_b16 v[146:147], v178 offset:12800
  v_mfma_f32_32x32x16_bf16 v[68:83], v[168:171], v[96:99], v[68:83]
  ds_read_b64_tr_b16 v[148:149], v179 offset:0
  ds_read_b64_tr_b16 v[150:151], v179 offset:256
  s_add_u32 s41, s35, 28672
  buffer_load_dwordx4 v[92:95], v175, s[16:19], s41 offen offset:0 sc1
  buffer_load_dwordx4 v[96:99], v175, s[16:19], s41 offen offset:2048 sc1
  s_waitcnt vmcnt(19) lgkmcnt(4)
  v_mfma_f32_32x32x16_bf16 v[4:19], v[132:135], v[100:103], v[4:19]
  ds_read_b64_tr_b16 v[152:153], v178 offset:2048
  ds_read_b64_tr_b16 v[154:155], v178 offset:2560
  v_mfma_f32_32x32x16_bf16 v[20:35], v[136:139], v[100:103], v[20:35]
  ds_read_b64_tr_b16 v[156:157], v178 offset:6144
  ds_read_b64_tr_b16 v[158:159], v178 offset:6656
  v_mfma_f32_32x32x16_bf16 v[36:51], v[140:143], v[100:103], v[36:51]
  ds_read_b64_tr_b16 v[160:161], v178 offset:10240
  ds_read_b64_tr_b16 v[162:163], v178 offset:10752
  s_waitcnt lgkmcnt(6)
  v_mfma_f32_32x32x16_bf16 v[52:67], v[144:147], v[100:103], v[52:67]
  ds_read_b64_tr_b16 v[164:165], v178 offset:14336
  ds_read_b64_tr_b16 v[166:167], v178 offset:14848
  v_mfma_f32_32x32x16_bf16 v[68:83], v[148:151], v[100:103], v[68:83]
  ds_read_b64_tr_b16 v[168:169], v179 offset:1024
  ds_read_b64_tr_b16 v[170:171], v179 offset:1280
  s_add_u32 s41, s35, 32768
  buffer_load_dwordx4 v[100:103], v175, s[16:19], s41 offen offset:0 sc1
  s_waitcnt vmcnt(19) lgkmcnt(4)
  v_mfma_f32_32x32x16_bf16 v[4:19], v[152:155], v[104:107], v[4:19]
  ds_read_b64_tr_b16 v[132:133], v178 offset:18432
  ds_read_b64_tr_b16 v[134:135], v178 offset:18944
  v_mfma_f32_32x32x16_bf16 v[20:35], v[156:159], v[104:107], v[20:35]
  ds_read_b64_tr_b16 v[136:137], v178 offset:22528
  ds_read_b64_tr_b16 v[138:139], v178 offset:23040
  v_mfma_f32_32x32x16_bf16 v[36:51], v[160:163], v[104:107], v[36:51]
  ds_read_b64_tr_b16 v[140:141], v178 offset:26624
  ds_read_b64_tr_b16 v[142:143], v178 offset:27136
  s_waitcnt lgkmcnt(6)
  v_mfma_f32_32x32x16_bf16 v[52:67], v[164:167], v[104:107], v[52:67]
  ds_read_b64_tr_b16 v[144:145], v178 offset:30720
  ds_read_b64_tr_b16 v[146:147], v178 offset:31232
  v_mfma_f32_32x32x16_bf16 v[68:83], v[168:171], v[104:107], v[68:83]
  ds_read_b64_tr_b16 v[148:149], v179 offset:18432
  ds_read_b64_tr_b16 v[150:151], v179 offset:18688
  buffer_load_dwordx4 v[104:107], v175, s[16:19], s41 offen offset:2048 sc1
  s_waitcnt vmcnt(14)
  s_barrier
  s_waitcnt vmcnt(19) lgkmcnt(4)
  v_mfma_f32_32x32x16_bf16 v[4:19], v[132:135], v[108:111], v[4:19]
  ds_read_b64_tr_b16 v[152:153], v178 offset:20480
  ds_read_b64_tr_b16 v[154:155], v178 offset:20992
  s_add_u32 m0, s34, 0
  s_add_u32 s40, s32, 147456
  buffer_load_dwordx4 v175, s[12:15], s40 offen lds
  v_mfma_f32_32x32x16_bf16 v[20:35], v[136:139], v[108:111], v[20:35]
  ds_read_b64_tr_b16 v[156:157], v178 offset:24576
  ds_read_b64_tr_b16 v[158:159], v178 offset:25088
  buffer_load_dwordx4 v175, s[12:15], s40 offen offset:1024 lds
  v_mfma_f32_32x32x16_bf16 v[36:51], v[140:143], v[108:111], v[36:51]
  ds_read_b64_tr_b16 v[160:161], v178 offset:28672
  ds_read_b64_tr_b16 v[162:163], v178 offset:29184
  buffer_load_dwordx4 v175, s[12:15], s40 offen offset:2048 lds
  s_waitcnt lgkmcnt(6)
  v_mfma_f32_32x32x16_bf16 v[52:67], v[144:147], v[108:111], v[52:67]
  ds_read_b64_tr_b16 v[164:165], v178 offset:32768
  ds_read_b64_tr_b16 v[166:167], v178 offset:33280
  buffer_load_dwordx4 v175, s[12:15], s40 offen offset:3072 lds
  v_mfma_f32_32x32x16_bf16 v[68:83], v[148:151], v[108:111], v[68:83]
  ds_read_b64_tr_b16 v[168:169], v179 offset:19456
  ds_read_b64_tr_b16 v[170:171], v179 offset:19712
  s_cmp_ge_u32 s24, 4
  s_cbranch_scc1 ffn2_kernel_sk5
  s_add_u32 m0, s34, 4096
  s_add_u32 s40, s32, 151552
  buffer_load_dwordx4 v175, s[12:15], s40 offen lds
ffn2_kernel_sk5:
  s_add_u32 s41, s35, 36864
  buffer_load_dwordx4 v[108:111], v175, s[16:19], s41 offen offset:0 sc1
  v_add_u32 v178, 73728, v176
  v_add_u32 v179, 73728, v177
  s_waitcnt vmcnt(23) lgkmcnt(4)
  v_mfma_f32_32x32x16_bf16 v[4:19], v[152:155], v[112:115], v[4:19]
  ds_read_b64_tr_b16 v[132:133], v178 offset:0
  ds_read_b64_tr_b16 v[134:135], v178 offset:512
  v_mfma_f32_32x32x16_bf16 v[20:35], v[156:159], v[112:115], v[20:35]
  ds_read_b64_tr_b16 v[136:137], v178 offset:4096
  ds_read_b64_tr_b16 v[138:139], v178 offset:4608
  v_mfma_f32_32x32x16_bf16 v[36:51], v[160:163], v[112:115], v[36:51]
  ds_read_b64_tr_b16 v[140:141], v178 offset:8192
  ds_read_b64_tr_b16 v[142:143], v178 offset:8704
  s_waitcnt lgkmcnt(6)
  v_mfma_f32_32x32x16_bf16 v[52:67], v[164:167], v[112:115], v[52:67]
  ds_read_b64_tr_b16 v[144:145], v178 offset:12288
  ds_read_b64_tr_b16 v[146:147], v178 offset:12800
  v_mfma_f32_32x32x16_bf16 v[68:83], v[168:171], v[112:115], v[68:83]
  ds_read_b64_tr_b16 v[148:149], v179 offset:0
  ds_read_b64_tr_b16 v[150:151], v179 offset:256
  buffer_load_dwordx4 v[112:115], v175, s[16:19], s41 offen offset:2048 sc1
  s_waitcnt vmcnt(19) lgkmcnt(4)
  v_mfma_f32_32x32x16_bf16 v[4:19], v[132:135], v[116:119], v[4:19]
  ds_read_b64_tr_b16 v[152:153], v178 offset:2048
  ds_read_b64_tr_b16 v[154:155], v178 offset:2560
  v_mfma_f32_32x32x16_bf16 v[20:35], v[136:139], v[116:119], v[20:35]
  ds_read_b64_tr_b16 v[156:157], v178 offset:6144
  ds_read_b64_tr_b16 v[158:159], v178 offset:6656
  v_mfma_f32_32x32x16_bf16 v[36:51], v[140:143], v[116:119], v[36:51]
  ds_read_b64_tr_b16 v[160:161], v178 offset:10240
  ds_read_b64_tr_b16 v[162:163], v178 offset:10752
  s_waitcnt lgkmcnt(6)
  v_mfma_f32_32x32x16_bf16 v[52:67], v[144:147], v[116:119], v[52:67]
  ds_read_b64_tr_b16 v[164:165], v178 offset:14336
  ds_read_b64_tr_b16 v[166:167], v178 offset:14848
  v_mfma_f32_32x32x16_bf16 v[68:83], v[148:151], v[116:119], v[68:83]
  ds_read_b64_tr_b16 v[168:169], v179 offset:1024
  ds_read_b64_tr_b16 v[170:171], v179 offset:1280
  s_add_u32 s41, s35, 40960
  buffer_load_dwordx4 v[116:119], v175, s[16:19], s41 offen offset:0 sc1
  s_waitcnt vmcnt(19) lgkmcnt(4)
  v_mfma_f32_32x32x16_bf16 v[4:19], v[152:155], v[120:123], v[4:19]
  ds_read_b64_tr_b16 v[132:133], v178 offset:18432
  ds_read_b64_tr_b16 v[134:135], v178 offset:18944
  v_mfma_f32_32x32x16_bf16 v[20:35], v[156:159], v[120:123], v[20:35]
  ds_read_b64_tr_b16 v[136:137], v178 offset:22528
  ds_read_b64_tr_b16 v[138:139], v178 offset:23040
  v_mfma_f32_32x32x16_bf16 v[36:51], v[160:163], v[120:123], v[36:51]
  ds_read_b64_tr_b16 v[140:141], v178 offset:26624
  ds_read_b64_tr_b16 v[142:143], v178 offset:27136
  s_waitcnt lgkmcnt(6)
  v_mfma_f32_32x32x16_bf16 v[52:67], v[164:167], v[120:123], v[52:67]
  ds_read_b64_tr_b16 v[144:145], v178 offset:30720
  ds_read_b64_tr_b16 v[146:147], v178 offset:31232
  v_mfma_f32_32x32x16_bf16 v[68:83], v[168:171], v[120:123], v[68:83]
  ds_read_b64_tr_b16 v[148:149], v179 offset:18432
  ds_read_b64_tr_b16 v[150:151], v179 offset:18688
  buffer_load_dwordx4 v[120:123], v175, s[16:19], s41 offen offset:2048 sc1
  s_waitcnt vmcnt(14)
  s_barrier
  s_waitcnt vmcnt(19) lgkmcnt(4)
  v_mfma_f32_32x32x16_bf16 v[4:19], v[132:135], v[124:127], v[4:19]
  ds_read_b64_tr_b16 v[152:153], v178 offset:20480
  ds_read_b64_tr_b16 v[154:155], v178 offset:20992
  s_add_u32 m0, s34, 36864
  s_add_u32 s40, s32, 184320
  buffer_load_dwordx4 v175, s[12:15], s40 offen lds
  v_mfma_f32_32x32x16_bf16 v[20:35], v[136:139], v[124:127], v[20:35]
  ds_read_b64_tr_b16 v[156:157], v178 offset:24576
  ds_read_b64_tr_b16 v[158:159], v178 offset:25088
  buffer_load_dwordx4 v175, s[12:15], s40 offen offset:1024 lds
  v_mfma_f32_32x32x16_bf16 v[36:51], v[140:143], v[124:127], v[36:51]
  ds_read_b64_tr_b16 v[160:161], v178 offset:28672
  ds_read_b64_tr_b16 v[162:163], v178 offset:29184
  buffer_load_dwordx4 v175, s[12:15], s40 offen offset:2048 lds
  s_waitcnt lgkmcnt(6)
  v_mfma_f32_32x32x16_bf16 v[52:67], v[144:147], v[124:127], v[52:67]
  ds_read_b64_tr_b16 v[164:165], v178 offset:32768
  ds_read_b64_tr_b16 v[166:167], v178 offset:33280
  buffer_load_dwordx4 v175, s[12:15], s40 offen offset:3072 lds
  v_mfma_f32_32x32x16_bf16 v[68:83], v[148:151], v[124:127], v[68:83]
  ds_read_b64_tr_b16 v[168:169], v179 offset:19456
  ds_read_b64_tr_b16 v[170:171], v179 offset:19712
  s_cmp_ge_u32 s24, 4
  s_cbranch_scc1 ffn2_kernel_sk6
  s_add_u32 m0, s34, 40960
  s_add_u32 s40, s32, 188416
  buffer_load_dwordx4 v175, s[12:15], s40 offen lds
ffn2_kernel_sk6:
  s_add_u32 s41, s35, 45056
  buffer_load_dwordx4 v[124:127], v175, s[16:19], s41 offen offset:0 sc1
  v_add_u32 v178, 110592, v176
  v_add_u32 v179, 110592, v177
  s_waitcnt vmcnt(23) lgkmcnt(4)
  v_mfma_f32_32x32x16_bf16 v[4:19], v[152:155], v[128:131], v[4:19]
  ds_read_b64_tr_b16 v[132:133], v178 offset:0
  ds_read_b64_tr_b16 v[134:135], v178 offset:512
  v_mfma_f32_32x32x16_bf16 v[20:35], v[156:159], v[128:131], v[20:35]
  ds_read_b64_tr_b16 v[136:137], v178 offset:4096
  ds_read_b64_tr_b16 v[138:139], v178 offset:4608
  v_mfma_f32_32x32x16_bf16 v[36:51], v[160:163], v[128:131], v[36:51]
  ds_read_b64_tr_b16 v[140:141], v178 offset:8192
  ds_read_b64_tr_b16 v[142:143], v178 offset:8704
  s_waitcnt lgkmcnt(6)
  v_mfma_f32_32x32x16_bf16 v[52:67], v[164:167], v[128:131], v[52:67]
  ds_read_b64_tr_b16 v[144:145], v178 offset:12288
  ds_read_b64_tr_b16 v[146:147], v178 offset:12800
  v_mfma_f32_32x32x16_bf16 v[68:83], v[168:171], v[128:131], v[68:83]
  ds_read_b64_tr_b16 v[148:149], v179 offset:0
  ds_read_b64_tr_b16 v[150:151], v179 offset:256
  buffer_load_dwordx4 v[128:131], v175, s[16:19], s41 offen offset:2048 sc1
  s_waitcnt vmcnt(19) lgkmcnt(4)
  v_mfma_f32_32x32x16_bf16 v[4:19], v[132:135], v[84:87], v[4:19]
  ds_read_b64_tr_b16 v[152:153], v178 offset:2048
  ds_read_b64_tr_b16 v[154:155], v178 offset:2560
  v_mfma_f32_32x32x16_bf16 v[20:35], v[136:139], v[84:87], v[20:35]
  ds_read_b64_tr_b16 v[156:157], v178 offset:6144
  ds_read_b64_tr_b16 v[158:159], v178 offset:6656
  v_mfma_f32_32x32x16_bf16 v[36:51], v[140:143], v[84:87], v[36:51]
  ds_read_b64_tr_b16 v[160:161], v178 offset:10240
  ds_read_b64_tr_b16 v[162:163], v178 offset:10752
  s_waitcnt lgkmcnt(6)
  v_mfma_f32_32x32x16_bf16 v[52:67], v[144:147], v[84:87], v[52:67]
  ds_read_b64_tr_b16 v[164:165], v178 offset:14336
  ds_read_b64_tr_b16 v[166:167], v178 offset:14848
  v_mfma_f32_32x32x16_bf16 v[68:83], v[148:151], v[84:87], v[68:83]
  ds_read_b64_tr_b16 v[168:169], v179 offset:1024
  ds_read_b64_tr_b16 v[170:171], v179 offset:1280
  s_add_u32 s41, s35, 49152
  buffer_load_dwordx4 v[84:87], v175, s[16:19], s41 offen offset:0 sc1
  s_waitcnt vmcnt(19) lgkmcnt(4)
  v_mfma_f32_32x32x16_bf16 v[4:19], v[152:155], v[88:91], v[4:19]
  ds_read_b64_tr_b16 v[132:133], v178 offset:18432
  ds_read_b64_tr_b16 v[134:135], v178 offset:18944
  v_mfma_f32_32x32x16_bf16 v[20:35], v[156:159], v[88:91], v[20:35]
  ds_read_b64_tr_b16 v[136:137], v178 offset:22528
  ds_read_b64_tr_b16 v[138:139], v178 offset:23040
  v_mfma_f32_32x32x16_bf16 v[36:51], v[160:163], v[88:91], v[36:51]
  ds_read_b64_tr_b16 v[140:141], v178 offset:26624
  ds_read_b64_tr_b16 v[142:143], v178 offset:27136
  s_waitcnt lgkmcnt(6)
  v_mfma_f32_32x32x16_bf16 v[52:67], v[164:167], v[88:91], v[52:67]
  ds_read_b64_tr_b16 v[144:145], v178 offset:30720
  ds_read_b64_tr_b16 v[146:147], v178 offset:31232
  v_mfma_f32_32x32x16_bf16 v[68:83], v[168:171], v[88:91], v[68:83]
  ds_read_b64_tr_b16 v[148:149], v179 offset:18432
  ds_read_b64_tr_b16 v[150:151], v179 offset:18688
  buffer_load_dwordx4 v[88:91], v175, s[16:19], s41 offen offset:2048 sc1
  s_waitcnt vmcnt(12)
  s_barrier
  s_waitcnt vmcnt(19) lgkmcnt(4)
  v_mfma_f32_32x32x16_bf16 v[4:19], v[132:135], v[92:95], v[4:19]
  ds_read_b64_tr_b16 v[152:153], v178 offset:20480
  ds_read_b64_tr_b16 v[154:155], v178 offset:20992
  s_add_u32 m0, s34, 73728
  s_add_u32 s40, s32, 221184
  buffer_load_dwordx4 v175, s[12:15], s40 offen lds
  v_mfma_f32_32x32x16_bf16 v[20:35], v[136:139], v[92:95], v[20:35]
  ds_read_b64_tr_b16 v[156:157], v178 offset:24576
  ds_read_b64_tr_b16 v[158:159], v178 offset:25088
  buffer_load_dwordx4 v175, s[12:15], s40 offen offset:1024 lds
  v_mfma_f32_32x32x16_bf16 v[36:51], v[140:143], v[92:95], v[36:51]
  ds_read_b64_tr_b16 v[160:161], v178 offset:28672
  ds_read_b64_tr_b16 v[162:163], v178 offset:29184
  buffer_load_dwordx4 v175, s[12:15], s40 offen offset:2048 lds
  s_waitcnt lgkmcnt(6)
  v_mfma_f32_32x32x16_bf16 v[52:67], v[144:147], v[92:95], v[52:67]
  ds_read_b64_tr_b16 v[164:165], v178 offset:32768
  ds_read_b64_tr_b16 v[166:167], v178 offset:33280
  buffer_load_dwordx4 v175, s[12:15], s40 offen offset:3072 lds
  v_mfma_f32_32x32x16_bf16 v[68:83], v[148:151], v[92:95], v[68:83]
  ds_read_b64_tr_b16 v[168:169], v179 offset:19456
  ds_read_b64_tr_b16 v[170:171], v179 offset:19712
  s_cmp_ge_u32 s24, 4
  s_cbranch_scc1 ffn2_kernel_sk7
  s_add_u32 m0, s34, 77824
  s_add_u32 s40, s32, 225280
  buffer_load_dwordx4 v175, s[12:15], s40 offen lds
ffn2_kernel_sk7:
  s_add_u32 s41, s35, 53248
  buffer_load_dwordx4 v[92:95], v175, s[16:19], s41 offen offset:0 sc1
  v_add_u32 v178, 0, v176
  v_add_u32 v179, 0, v177
  s_waitcnt vmcnt(23) lgkmcnt(4)
  v_mfma_f32_32x32x16_bf16 v[4:19], v[152:155], v[96:99], v[4:19]
  ds_read_b64_tr_b16 v[132:133], v178 offset:0
  ds_read_b64_tr_b16 v[134:135], v178 offset:512
  v_mfma_f32_32x32x16_bf16 v[20:35], v[156:159], v[96:99], v[20:35]
  ds_read_b64_tr_b16 v[136:137], v178 offset:4096
  ds_read_b64_tr_b16 v[138:139], v178 offset:4608
  v_mfma_f32_32x32x16_bf16 v[36:51], v[160:163], v[96:99], v[36:51]
  ds_read_b64_tr_b16 v[140:141], v178 offset:8192
  ds_read_b64_tr_b16 v[142:143], v178 offset:8704
  s_waitcnt lgkmcnt(6)
  v_mfma_f32_32x32x16_bf16 v[52:67], v[164:167], v[96:99], v[52:67]
  ds_read_b64_tr_b16 v[144:145], v178 offset:12288
  ds_read_b64_tr_b16 v[146:147], v178 offset:12800
  v_mfma_f32_32x32x16_bf16 v[68:83], v[168:171], v[96:99], v[68:83]
  ds_read_b64_tr_b16 v[148:149], v179 offset:0
  ds_read_b64_tr_b16 v[150:151], v179 offset:256
  buffer_load_dwordx4 v[96:99], v175, s[16:19], s41 offen offset:2048 sc1
  s_waitcnt vmcnt(23) lgkmcnt(4)
  v_mfma_f32_32x32x16_bf16 v[4:19], v[132:135], v[100:103], v[4:19]
  ds_read_b64_tr_b16 v[152:153], v178 offset:2048
  ds_read_b64_tr_b16 v[154:155], v178 offset:2560
  v_mfma_f32_32x32x16_bf16 v[20:35], v[136:139], v[100:103], v[20:35]
  ds_read_b64_tr_b16 v[156:157], v178 offset:6144
  ds_read_b64_tr_b16 v[158:159], v178 offset:6656
  v_mfma_f32_32x32x16_bf16 v[36:51], v[140:143], v[100:103], v[36:51]
  ds_read_b64_tr_b16 v[160:161], v178 offset:10240
  ds_read_b64_tr_b16 v[162:163], v178 offset:10752
  s_waitcnt lgkmcnt(6)
  v_mfma_f32_32x32x16_bf16 v[52:67], v[144:147], v[100:103], v[52:67]
  ds_read_b64_tr_b16 v[164:165], v178 offset:14336
  ds_read_b64_tr_b16 v[166:167], v178 offset:14848
  v_mfma_f32_32x32x16_bf16 v[68:83], v[148:151], v[100:103], v[68:83]
  ds_read_b64_tr_b16 v[168:169], v179 offset:1024
  ds_read_b64_tr_b16 v[170:171], v179 offset:1280
  s_add_u32 s41, s35, 57344
  buffer_load_dwordx4 v[100:103], v175, s[16:19], s41 offen offset:0 sc1
  s_waitcnt vmcnt(23) lgkmcnt(4)
  v_mfma_f32_32x32x16_bf16 v[4:19], v[152:155], v[104:107], v[4:19]
  ds_read_b64_tr_b16 v[132:133], v178 offset:18432
  ds_read_b64_tr_b16 v[134:135], v178 offset:18944
  v_mfma_f32_32x32x16_bf16 v[20:35], v[156:159], v[104:107], v[20:35]
  ds_read_b64_tr_b16 v[136:137], v178 offset:22528
  ds_read_b64_tr_b16 v[138:139], v178 offset:23040
  v_mfma_f32_32x32x16_bf16 v[36:51], v[160:163], v[104:107], v[36:51]
  ds_read_b64_tr_b16 v[140:141], v178 offset:26624
  ds_read_b64_tr_b16 v[142:143], v178 offset:27136
  s_waitcnt lgkmcnt(6)
  v_mfma_f32_32x32x16_bf16 v[52:67], v[164:167], v[104:107], v[52:67]
  ds_read_b64_tr_b16 v[144:145], v178 offset:30720
  ds_read_b64_tr_b16 v[146:147], v178 offset:31232
  v_mfma_f32_32x32x16_bf16 v[68:83], v[168:171], v[104:107], v[68:83]
  ds_read_b64_tr_b16 v[148:149], v179 offset:18432
  ds_read_b64_tr_b16 v[150:151], v179 offset:18688
  buffer_load_dwordx4 v[104:107], v175, s[16:19], s41 offen offset:2048 sc1
  s_waitcnt vmcnt(12)
  s_barrier
  s_waitcnt vmcnt(19) lgkmcnt(4)
  v_mfma_f32_32x32x16_bf16 v[4:19], v[132:135], v[108:111], v[4:19]
  ds_read_b64_tr_b16 v[152:153], v178 offset:20480
  ds_read_b64_tr_b16 v[154:155], v178 offset:20992
  s_add_u32 m0, s34, 110592
  s_add_u32 s40, s32, 258048
  buffer_load_dwordx4 v175, s[12:15], s40 offen lds
  v_mfma_f32_32x32x16_bf16 v[20:35], v[136:139], v[108:111], v[20:35]
  ds_read_b64_tr_b16 v[156:157], v178 offset:24576
  ds_read_b64_tr_b16 v[158:159], v178 offset:25088
  buffer_load_dwordx4 v175, s[12:15], s40 offen offset:1024 lds
  v_mfma_f32_32x32x16_bf16 v[36:51], v[140:143], v[108:111], v[36:51]
  ds_read_b64_tr_b16 v[160:161], v178 offset:28672
  ds_read_b64_tr_b16 v[162:163], v178 offset:29184
  buffer_load_dwordx4 v175, s[12:15], s40 offen offset:2048 lds
  s_waitcnt lgkmcnt(6)
  v_mfma_f32_32x32x16_bf16 v[52:67], v[144:147], v[108:111], v[52:67]
  ds_read_b64_tr_b16 v[164:165], v178 offset:32768
  ds_read_b64_tr_b16 v[166:167], v178 offset:33280
  buffer_load_dwordx4 v175, s[12:15], s40 offen offset:3072 lds
  v_mfma_f32_32x32x16_bf16 v[68:83], v[148:151], v[108:111], v[68:83]
  ds_read_b64_tr_b16 v[168:169], v179 offset:19456
  ds_read_b64_tr_b16 v[170:171], v179 offset:19712
  s_cmp_ge_u32 s24, 4
  s_cbranch_scc1 ffn2_kernel_sk8
  s_add_u32 m0, s34, 114688
  s_add_u32 s40, s32, 262144
  buffer_load_dwordx4 v175, s[12:15], s40 offen lds
ffn2_kernel_sk8:
  s_add_u32 s41, s35, 61440
  buffer_load_dwordx4 v[108:111], v175, s[16:19], s41 offen offset:0 sc1
  v_add_u32 v178, 36864, v176
  v_add_u32 v179, 36864, v177
  s_waitcnt vmcnt(23) lgkmcnt(4)
  v_mfma_f32_32x32x16_bf16 v[4:19], v[152:155], v[112:115], v[4:19]
  ds_read_b64_tr_b16 v[132:133], v178 offset:0
  ds_read_b64_tr_b16 v[134:135], v178 offset:512
  v_mfma_f32_32x32x16_bf16 v[20:35], v[156:159], v[112:115], v[20:35]
  ds_read_b64_tr_b16 v[136:137], v178 offset:4096
  ds_read_b64_tr_b16 v[138:139], v178 offset:4608
  v_mfma_f32_32x32x16_bf16 v[36:51], v[160:163], v[112:115], v[36:51]
  ds_read_b64_tr_b16 v[140:141], v178 offset:8192
  ds_read_b64_tr_b16 v[142:143], v178 offset:8704
  s_waitcnt lgkmcnt(6)
  v_mfma_f32_32x32x16_bf16 v[52:67], v[164:167], v[112:115], v[52:67]
  ds_read_b64_tr_b16 v[144:145], v178 offset:12288
  ds_read_b64_tr_b16 v[146:147], v178 offset:12800
  v_mfma_f32_32x32x16_bf16 v[68:83], v[168:171], v[112:115], v[68:83]
  ds_read_b64_tr_b16 v[148:149], v179 offset:0
  ds_read_b64_tr_b16 v[150:151], v179 offset:256
  buffer_load_dwordx4 v[112:115], v175, s[16:19], s41 offen offset:2048 sc1
  s_waitcnt vmcnt(23) lgkmcnt(4)
  v_mfma_f32_32x32x16_bf16 v[4:19], v[132:135], v[116:119], v[4:19]
  ds_read_b64_tr_b16 v[152:153], v178 offset:2048
  ds_read_b64_tr_b16 v[154:155], v178 offset:2560
  v_mfma_f32_32x32x16_bf16 v[20:35], v[136:139], v[116:119], v[20:35]
  ds_read_b64_tr_b16 v[156:157], v178 offset:6144
  ds_read_b64_tr_b16 v[158:159], v178 offset:6656
  v_mfma_f32_32x32x16_bf16 v[36:51], v[140:143], v[116:119], v[36:51]
  ds_read_b64_tr_b16 v[160:161], v178 offset:10240
  ds_read_b64_tr_b16 v[162:163], v178 offset:10752
  s_waitcnt lgkmcnt(6)
  v_mfma_f32_32x32x16_bf16 v[52:67], v[144:147], v[116:119], v[52:67]
  ds_read_b64_tr_b16 v[164:165], v178 offset:14336
  ds_read_b64_tr_b16 v[166:167], v178 offset:14848
  v_mfma_f32_32x32x16_bf16 v[68:83], v[148:151], v[116:119], v[68:83]
  ds_read_b64_tr_b16 v[168:169], v179 offset:1024
  ds_read_b64_tr_b16 v[170:171], v179 offset:1280
  s_add_u32 s41, s35, 65536
  buffer_load_dwordx4 v[116:119], v175, s[16:19], s41 offen offset:0 sc1
  s_waitcnt vmcnt(23) lgkmcnt(4)
  v_mfma_f32_32x32x16_bf16 v[4:19], v[152:155], v[120:123], v[4:19]
  ds_read_b64_tr_b16 v[132:133], v178 offset:18432
  ds_read_b64_tr_b16 v[134:135], v178 offset:18944
  v_mfma_f32_32x32x16_bf16 v[20:35], v[156:159], v[120:123], v[20:35]
  ds_read_b64_tr_b16 v[136:137], v178 offset:22528
  ds_read_b64_tr_b16 v[138:139], v178 offset:23040
  v_mfma_f32_32x32x16_bf16 v[36:51], v[160:163], v[120:123], v[36:51]
  ds_read_b64_tr_b16 v[140:141], v178 offset:26624
  ds_read_b64_tr_b16 v[142:143], v178 offset:27136
  s_waitcnt lgkmcnt(6)
  v_mfma_f32_32x32x16_bf16 v[52:67], v[164:167], v[120:123], v[52:67]
  ds_read_b64_tr_b16 v[144:145], v178 offset:30720
  ds_read_b64_tr_b16 v[146:147], v178 offset:31232
  v_mfma_f32_32x32x16_bf16 v[68:83], v[168:171], v[120:123], v[68:83]
  ds_read_b64_tr_b16 v[148:149], v179 offset:18432
  ds_read_b64_tr_b16 v[150:151], v179 offset:18688
  buffer_load_dwordx4 v[120:123], v175, s[16:19], s41 offen offset:2048 sc1
  s_waitcnt vmcnt(12)
  s_barrier
  s_waitcnt vmcnt(19) lgkmcnt(4)
  v_mfma_f32_32x32x16_bf16 v[4:19], v[132:135], v[124:127], v[4:19]
  ds_read_b64_tr_b16 v[152:153], v178 offset:20480
  ds_read_b64_tr_b16 v[154:155], v178 offset:20992
  s_add_u32 m0, s34, 0
  s_add_u32 s40, s32, 294912
  buffer_load_dwordx4 v175, s[12:15], s40 offen lds
  v_mfma_f32_32x32x16_bf16 v[20:35], v[136:139], v[124:127], v[20:35]
  ds_read_b64_tr_b16 v[156:157], v178 offset:24576
  ds_read_b64_tr_b16 v[158:159], v178 offset:25088
  buffer_load_dwordx4 v175, s[12:15], s40 offen offset:1024 lds
  v_mfma_f32_32x32x16_bf16 v[36:51], v[140:143], v[124:127], v[36:51]
  ds_read_b64_tr_b16 v[160:161], v178 offset:28672
  ds_read_b64_tr_b16 v[162:163], v178 offset:29184
  buffer_load_dwordx4 v175, s[12:15], s40 offen offset:2048 lds
  s_waitcnt lgkmcnt(6)
  v_mfma_f32_32x32x16_bf16 v[52:67], v[144:147], v[124:127], v[52:67]
  ds_read_b64_tr_b16 v[164:165], v178 offset:32768
  ds_read_b64_tr_b16 v[166:167], v178 offset:33280
  buffer_load_dwordx4 v175, s[12:15], s40 offen offset:3072 lds
  v_mfma_f32_32x32x16_bf16 v[68:83], v[148:151], v[124:127], v[68:83]
  ds_read_b64_tr_b16 v[168:169], v179 offset:19456
  ds_read_b64_tr_b16 v[170:171], v179 offset:19712
  s_cmp_ge_u32 s24, 4
  s_cbranch_scc1 ffn2_kernel_sk9
  s_add_u32 m0, s34, 4096
  s_add_u32 s40, s32, 299008
  buffer_load_dwordx4 v175, s[12:15], s40 offen lds
ffn2_kernel_sk9:
  s_add_u32 s41, s35, 69632
  buffer_load_dwordx4 v[124:127], v175, s[16:19], s41 offen offset:0 sc1
  s_waitcnt vmcnt(23) lgkmcnt(4)
  v_mfma_f32_32x32x16_bf16 v[4:19], v[152:155], v[128:131], v[4:19]
  v_mfma_f32_32x32x16_bf16 v[20:35], v[156:159], v[128:131], v[20:35]
  v_mfma_f32_32x32x16_bf16 v[36:51], v[160:163], v[128:131], v[36:51]
  s_waitcnt lgkmcnt(0)
  v_mfma_f32_32x32x16_bf16 v[52:67], v[164:167], v[128:131], v[52:67]
  v_mfma_f32_32x32x16_bf16 v[68:83], v[168:171], v[128:131], v[68:83]
  buffer_load_dwordx4 v[128:131], v175, s[16:19], s41 offen offset:2048 sc1
  v_add_u32 v237, 73728, v176
  v_add_u32 v240, 73728, v177
  v_add_u32 v238, 110592, v176
  v_add_u32 v241, 110592, v177
  v_add_u32 v239, 0, v176
  v_add_u32 v242, 0, v177
  s_lshl_b32 s37, s24, 11
  s_add_u32 s37, s37, 36864
  v_add_u32 v243, s37, v175
  s_xor_b32 s38, s24, 4
  s_lshl_b32 s38, s38, 11
  s_add_u32 s38, s38, 36864
  v_add_u32 v244, s38, v175
  s_add_u32 s48, s8, 58720256
  s_addc_u32 s49, s9, 0
  s_mov_b32 s50, 9437184
  s_mov_b32 s51, 0x00020000
  s_lshl_b32 s37, s25, 2
  s_add_u32 s37, s37, s27
  s_lshl_b32 s38, s37, 2
  s_add_u32 s52, s38, s29
  s_lshl_b32 s52, s52, 2
  s_add_u32 s52, s52, s26
  s_mul_i32 s52, s52, 9216
  s_lshl_b32 s53, s30, 10
  s_add_u32 s53, s53, s52
  s_cmp_eq_u32 s29, s26
  s_cselect_b32 s53, 0x7f000000, s53
  ds_read_b64_tr_b16 v[132:133], v237 offset:0
  ds_read_b64_tr_b16 v[134:135], v237 offset:512
  ds_read_b64_tr_b16 v[136:137], v237 offset:2048
  ds_read_b64_tr_b16 v[138:139], v237 offset:2560
  ds_read_b64_tr_b16 v[140:141], v237 offset:18432
  ds_read_b64_tr_b16 v[142:143], v237 offset:18944
  s_waitcnt vmcnt(23) lgkmcnt(4)
  v_mfma_f32_32x32x16_bf16 v[4:19], v[132:135], v[84:87], v[4:19]
  ds_read_b64_tr_b16 v[144:145], v237 offset:20480
  ds_read_b64_tr_b16 v[146:147], v237 offset:20992
  s_waitcnt vmcnt(22) lgkmcnt(4)
  v_mfma_f32_32x32x16_bf16 v[4:19], v[136:139], v[88:91], v[4:19]
  s_waitcnt vmcnt(10)
  s_barrier
  ds_read_b64_tr_b16 v[132:133], v238 offset:0
  ds_read_b64_tr_b16 v[134:135], v238 offset:512
  s_waitcnt vmcnt(17) lgkmcnt(4)
  v_mfma_f32_32x32x16_bf16 v[4:19], v[140:143], v[92:95], v[4:19]
  ds_read_b64_tr_b16 v[136:137], v238 offset:2048
  ds_read_b64_tr_b16 v[138:139], v238 offset:2560
  s_waitcnt vmcnt(16) lgkmcnt(4)
  v_mfma_f32_32x32x16_bf16 v[4:19], v[144:147], v[96:99], v[4:19]
  ds_read_b64_tr_b16 v[140:141], v238 offset:18432
  ds_read_b64_tr_b16 v[142:143], v238 offset:18944
  s_waitcnt vmcnt(15) lgkmcnt(4)
  v_mfma_f32_32x32x16_bf16 v[4:19], v[132:135], v[100:103], v[4:19]
  ds_read_b64_tr_b16 v[144:145], v238 offset:20480
  ds_read_b64_tr_b16 v[146:147], v238 offset:20992
  s_waitcnt vmcnt(14) lgkmcnt(4)
  v_mfma_f32_32x32x16_bf16 v[4:19], v[136:139], v[104:107], v[4:19]
  s_waitcnt vmcnt(2)
  s_barrier
  ds_read_b64_tr_b16 v[132:133], v239 offset:0
  ds_read_b64_tr_b16 v[134:135], v239 offset:512
  s_waitcnt vmcnt(9) lgkmcnt(4)
  v_mfma_f32_32x32x16_bf16 v[4:19], v[140:143], v[108:111], v[4:19]
  ds_read_b64_tr_b16 v[136:137], v239 offset:2048
  ds_read_b64_tr_b16 v[138:139], v239 offset:2560
  s_waitcnt vmcnt(8) lgkmcnt(4)
  v_mfma_f32_32x32x16_bf16 v[4:19], v[144:147], v[112:115], v[4:19]
  ds_read_b64_tr_b16 v[140:141], v239 offset:18432
  ds_read_b64_tr_b16 v[142:143], v239 offset:18944
  s_waitcnt vmcnt(7) lgkmcnt(4)
  v_mfma_f32_32x32x16_bf16 v[4:19], v[132:135], v[116:119], v[4:19]
  ds_read_b64_tr_b16 v[144:145], v239 offset:20480
  ds_read_b64_tr_b16 v[146:147], v239 offset:20992
  s_waitcnt vmcnt(6) lgkmcnt(4)
  v_mfma_f32_32x32x16_bf16 v[4:19], v[136:139], v[120:123], v[4:19]
  ds_read_b64_tr_b16 v[132:133], v237 offset:4096
  ds_read_b64_tr_b16 v[134:135], v237 offset:4608
  s_waitcnt vmcnt(1) lgkmcnt(4)
  v_mfma_f32_32x32x16_bf16 v[4:19], v[140:143], v[124:127], v[4:19]
  ds_read_b64_tr_b16 v[136:137], v237 offset:6144
  ds_read_b64_tr_b16 v[138:139], v237 offset:6656
  s_waitcnt vmcnt(0) lgkmcnt(4)
  v_mfma_f32_32x32x16_bf16 v[4:19], v[144:147], v[128:131], v[4:19]
  ds_read_b64_tr_b16 v[140:141], v237 offset:22528
  ds_read_b64_tr_b16 v[142:143], v237 offset:23040
  s_waitcnt lgkmcnt(4)
  v_mfma_f32_32x32x16_bf16 v[20:35], v[132:135], v[84:87], v[20:35]
  ds_read_b64_tr_b16 v[144:145], v237 offset:24576
  ds_read_b64_tr_b16 v[146:147], v237 offset:25088
  s_waitcnt lgkmcnt(4)
  v_mfma_f32_32x32x16_bf16 v[20:35], v[136:139], v[88:91], v[20:35]
  ds_read_b64_tr_b16 v[132:133], v238 offset:4096
  ds_read_b64_tr_b16 v[134:135], v238 offset:4608
  s_waitcnt lgkmcnt(4)
  v_mfma_f32_32x32x16_bf16 v[20:35], v[140:143], v[92:95], v[20:35]
  ds_read_b64_tr_b16 v[136:137], v238 offset:6144
  ds_read_b64_tr_b16 v[138:139], v238 offset:6656
  s_waitcnt lgkmcnt(4)
  v_mfma_f32_32x32x16_bf16 v[20:35], v[144:147], v[96:99], v[20:35]
  ds_write_b128 v243, v[12:15] offset:0
  ds_write_b128 v243, v[16:19] offset:1024
  ds_read_b64_tr_b16 v[140:141], v238 offset:22528
  ds_read_b64_tr_b16 v[142:143], v238 offset:23040
  s_waitcnt lgkmcnt(6)
  v_mfma_f32_32x32x16_bf16 v[20:35], v[132:135], v[100:103], v[20:35]
  ds_read_b64_tr_b16 v[144:145], v238 offset:24576
  ds_read_b64_tr_b16 v[146:147], v238 offset:25088
  s_waitcnt lgkmcnt(6)
  v_mfma_f32_32x32x16_bf16 v[20:35], v[136:139], v[104:107], v[20:35]
  s_waitcnt lgkmcnt(4)
  s_barrier
  ds_read_b64_tr_b16 v[132:133], v239 offset:4096
  ds_read_b64_tr_b16 v[134:135], v239 offset:4608
  s_waitcnt lgkmcnt(4)
  v_mfma_f32_32x32x16_bf16 v[20:35], v[140:143], v[108:111], v[20:35]
  ds_read_b128 v[248:251], v244 offset:0
  ds_read_b128 v[252:255], v244 offset:1024
  ds_read_b64_tr_b16 v[136:137], v239 offset:6144
  ds_read_b64_tr_b16 v[138:139], v239 offset:6656
  s_waitcnt lgkmcnt(6)
  v_mfma_f32_32x32x16_bf16 v[20:35], v[144:147], v[112:115], v[20:35]
  ds_read_b64_tr_b16 v[140:141], v239 offset:22528
  ds_read_b64_tr_b16 v[142:143], v239 offset:23040
  s_waitcnt lgkmcnt(6)
  v_mfma_f32_32x32x16_bf16 v[20:35], v[132:135], v[116:119], v[20:35]
  s_waitcnt lgkmcnt(4)
  v_add_f32 v200, v4, v248
  v_add_f32 v201, v5, v249
  v_add_f32 v202, v6, v250
  v_add_f32 v203, v7, v251
  v_add_f32 v204, v8, v252
  v_add_f32 v205, v9, v253
  v_add_f32 v206, v10, v254
  v_add_f32 v207, v11, v255
  ds_read_b64_tr_b16 v[144:145], v239 offset:24576
  ds_read_b64_tr_b16 v[146:147], v239 offset:25088
  s_waitcnt lgkmcnt(4)
  v_mfma_f32_32x32x16_bf16 v[20:35], v[136:139], v[120:123], v[20:35]
  v_cvt_pk_bf16_f32 v248, v200, v201
  v_cvt_pk_bf16_f32 v249, v202, v203
  v_cvt_pk_bf16_f32 v250, v204, v205
  v_cvt_pk_bf16_f32 v251, v206, v207
  s_add_u32 s40, s53, 0
  buffer_store_dwordx4 v[248:251], v175, s[48:51], s40 offen sc1
  ds_read_b64_tr_b16 v[132:133], v237 offset:8192
  ds_read_b64_tr_b16 v[134:135], v237 offset:8704
  s_waitcnt lgkmcnt(4)
  v_mfma_f32_32x32x16_bf16 v[20:35], v[140:143], v[124:127], v[20:35]
  ds_read_b64_tr_b16 v[136:137], v237 offset:10240
  ds_read_b64_tr_b16 v[138:139], v237 offset:10752
  s_waitcnt lgkmcnt(4)
  v_mfma_f32_32x32x16_bf16 v[20:35], v[144:147], v[128:131], v[20:35]
  ds_read_b64_tr_b16 v[140:141], v237 offset:26624
  ds_read_b64_tr_b16 v[142:143], v237 offset:27136
  s_waitcnt lgkmcnt(4)
  v_mfma_f32_32x32x16_bf16 v[36:51], v[132:135], v[84:87], v[36:51]
  ds_read_b64_tr_b16 v[144:145], v237 offset:28672
  ds_read_b64_tr_b16 v[146:147], v237 offset:29184
  s_waitcnt lgkmcnt(4)
  v_mfma_f32_32x32x16_bf16 v[36:51], v[136:139], v[88:91], v[36:51]
  ds_read_b64_tr_b16 v[132:133], v238 offset:8192
  ds_read_b64_tr_b16 v[134:135], v238 offset:8704
  s_waitcnt lgkmcnt(4)
  v_mfma_f32_32x32x16_bf16 v[36:51], v[140:143], v[92:95], v[36:51]
  ds_read_b64_tr_b16 v[136:137], v238 offset:10240
  ds_read_b64_tr_b16 v[138:139], v238 offset:10752
  s_waitcnt lgkmcnt(4)
  v_mfma_f32_32x32x16_bf16 v[36:51], v[144:147], v[96:99], v[36:51]
  ds_write_b128 v243, v[28:31] offset:16384
  ds_write_b128 v243, v[32:35] offset:17408
  ds_read_b64_tr_b16 v[140:141], v238 offset:26624
  ds_read_b64_tr_b16 v[142:143], v238 offset:27136
  s_waitcnt lgkmcnt(6)
  v_mfma_f32_32x32x16_bf16 v[36:51], v[132:135], v[100:103], v[36:51]
  ds_read_b64_tr_b16 v[144:145], v238 offset:28672
  ds_read_b64_tr_b16 v[146:147], v238 offset:29184
  s_waitcnt lgkmcnt(6)
  v_mfma_f32_32x32x16_bf16 v[36:51], v[136:139], v[104:107], v[36:51]
  s_waitcnt lgkmcnt(4)
  s_barrier
  ds_read_b64_tr_b16 v[132:133], v239 offset:8192
  ds_read_b64_tr_b16 v[134:135], v239 offset:8704
  s_waitcnt lgkmcnt(4)
  v_mfma_f32_32x32x16_bf16 v[36:51], v[140:143], v[108:111], v[36:51]
  ds_read_b128 v[248:251], v244 offset:16384
  ds_read_b128 v[252:255], v244 offset:17408
  ds_read_b64_tr_b16 v[136:137], v239 offset:10240
  ds_read_b64_tr_b16 v[138:139], v239 offset:10752
  s_waitcnt lgkmcnt(6)
  v_mfma_f32_32x32x16_bf16 v[36:51], v[144:147], v[112:115], v[36:51]
  ds_read_b64_tr_b16 v[140:141], v239 offset:26624
  ds_read_b64_tr_b16 v[142:143], v239 offset:27136
  s_waitcnt lgkmcnt(6)
  v_mfma_f32_32x32x16_bf16 v[36:51], v[132:135], v[116:119], v[36:51]
  s_waitcnt lgkmcnt(4)
  v_add_f32 v208, v20, v248
  v_add_f32 v209, v21, v249
  v_add_f32 v210, v22, v250
  v_add_f32 v211, v23, v251
  v_add_f32 v212, v24, v252
  v_add_f32 v213, v25, v253
  v_add_f32 v214, v26, v254
  v_add_f32 v215, v27, v255
  ds_read_b64_tr_b16 v[144:145], v239 offset:28672
  ds_read_b64_tr_b16 v[146:147], v239 offset:29184
  s_waitcnt lgkmcnt(4)
  v_mfma_f32_32x32x16_bf16 v[36:51], v[136:139], v[120:123], v[36:51]
  v_cvt_pk_bf16_f32 v248, v208, v209
  v_cvt_pk_bf16_f32 v249, v210, v211
  v_cvt_pk_bf16_f32 v250, v212, v213
  v_cvt_pk_bf16_f32 v251, v214, v215
  s_add_u32 s40, s53, 2048
  buffer_store_dwordx4 v[248:251], v175, s[48:51], s40 offen sc1
  ds_read_b64_tr_b16 v[132:133], v237 offset:12288
  ds_read_b64_tr_b16 v[134:135], v237 offset:12800
  s_waitcnt lgkmcnt(4)
  v_mfma_f32_32x32x16_bf16 v[36:51], v[140:143], v[124:127], v[36:51]
  ds_read_b64_tr_b16 v[136:137], v237 offset:14336
  ds_read_b64_tr_b16 v[138:139], v237 offset:14848
  s_waitcnt lgkmcnt(4)
  v_mfma_f32_32x32x16_bf16 v[36:51], v[144:147], v[128:131], v[36:51]
  ds_read_b64_tr_b16 v[140:141], v237 offset:30720
  ds_read_b64_tr_b16 v[142:143], v237 offset:31232
  s_waitcnt lgkmcnt(4)
  v_mfma_f32_32x32x16_bf16 v[52:67], v[132:135], v[84:87], v[52:67]
  ds_read_b64_tr_b16 v[144:145], v237 offset:32768
  ds_read_b64_tr_b16 v[146:147], v237 offset:33280
  s_waitcnt lgkmcnt(4)
  v_mfma_f32_32x32x16_bf16 v[52:67], v[136:139], v[88:91], v[52:67]
  ds_read_b64_tr_b16 v[132:133], v238 offset:12288
  ds_read_b64_tr_b16 v[134:135], v238 offset:12800
  s_waitcnt lgkmcnt(4)
  v_mfma_f32_32x32x16_bf16 v[52:67], v[140:143], v[92:95], v[52:67]
  ds_read_b64_tr_b16 v[136:137], v238 offset:14336
  ds_read_b64_tr_b16 v[138:139], v238 offset:14848
  s_waitcnt lgkmcnt(4)
  v_mfma_f32_32x32x16_bf16 v[52:67], v[144:147], v[96:99], v[52:67]
  ds_write_b128 v243, v[44:47] offset:0
  ds_write_b128 v243, v[48:51] offset:1024
  ds_read_b64_tr_b16 v[140:141], v238 offset:30720
  ds_read_b64_tr_b16 v[142:143], v238 offset:31232
  s_waitcnt lgkmcnt(6)
  v_mfma_f32_32x32x16_bf16 v[52:67], v[132:135], v[100:103], v[52:67]
  ds_read_b64_tr_b16 v[144:145], v238 offset:32768
  ds_read_b64_tr_b16 v[146:147], v238 offset:33280
  s_waitcnt lgkmcnt(6)
  v_mfma_f32_32x32x16_bf16 v[52:67], v[136:139], v[104:107], v[52:67]
  s_waitcnt lgkmcnt(4)
  s_barrier
  ds_read_b64_tr_b16 v[132:133], v239 offset:12288
  ds_read_b64_tr_b16 v[134:135], v239 offset:12800
  s_waitcnt lgkmcnt(4)
  v_mfma_f32_32x32x16_bf16 v[52:67], v[140:143], v[108:111], v[52:67]
  ds_read_b128 v[248:251], v244 offset:0
  ds_read_b128 v[252:255], v244 offset:1024
  ds_read_b64_tr_b16 v[136:137], v239 offset:14336
  ds_read_b64_tr_b16 v[138:139], v239 offset:14848
  s_waitcnt lgkmcnt(6)
  v_mfma_f32_32x32x16_bf16 v[52:67], v[144:147], v[112:115], v[52:67]
  ds_read_b64_tr_b16 v[140:141], v239 offset:30720
  ds_read_b64_tr_b16 v[142:143], v239 offset:31232
  s_waitcnt lgkmcnt(6)
  v_mfma_f32_32x32x16_bf16 v[52:67], v[132:135], v[116:119], v[52:67]
  s_waitcnt lgkmcnt(4)
  v_add_f32 v216, v36, v248
  v_add_f32 v217, v37, v249
  v_add_f32 v218, v38, v250
  v_add_f32 v219, v39, v251
  v_add_f32 v220, v40, v252
  v_add_f32 v221, v41, v253
  v_add_f32 v222, v42, v254
  v_add_f32 v223, v43, v255
  ds_read_b64_tr_b16 v[144:145], v239 offset:32768
  ds_read_b64_tr_b16 v[146:147], v239 offset:33280
  s_waitcnt lgkmcnt(4)
  v_mfma_f32_32x32x16_bf16 v[52:67], v[136:139], v[120:123], v[52:67]
  v_cvt_pk_bf16_f32 v248, v216, v217
  v_cvt_pk_bf16_f32 v249, v218, v219
  v_cvt_pk_bf16_f32 v250, v220, v221
  v_cvt_pk_bf16_f32 v251, v222, v223
  s_add_u32 s40, s53, 4096
  buffer_store_dwordx4 v[248:251], v175, s[48:51], s40 offen sc1
  ds_read_b64_tr_b16 v[132:133], v240 offset:0
  ds_read_b64_tr_b16 v[134:135], v240 offset:256
  s_waitcnt lgkmcnt(4)
  v_mfma_f32_32x32x16_bf16 v[52:67], v[140:143], v[124:127], v[52:67]
  ds_read_b64_tr_b16 v[136:137], v240 offset:1024
  ds_read_b64_tr_b16 v[138:139], v240 offset:1280
  s_waitcnt lgkmcnt(4)
  v_mfma_f32_32x32x16_bf16 v[52:67], v[144:147], v[128:131], v[52:67]
  ds_read_b64_tr_b16 v[140:141], v240 offset:18432
  ds_read_b64_tr_b16 v[142:143], v240 offset:18688
  s_waitcnt lgkmcnt(4)
  v_mfma_f32_32x32x16_bf16 v[68:83], v[132:135], v[84:87], v[68:83]
  ds_read_b64_tr_b16 v[144:145], v240 offset:19456
  ds_read_b64_tr_b16 v[146:147], v240 offset:19712
  s_waitcnt lgkmcnt(4)
  v_mfma_f32_32x32x16_bf16 v[68:83], v[136:139], v[88:91], v[68:83]
  ds_read_b64_tr_b16 v[132:133], v241 offset:0
  ds_read_b64_tr_b16 v[134:135], v241 offset:256
  s_waitcnt lgkmcnt(4)
  v_mfma_f32_32x32x16_bf16 v[68:83], v[140:143], v[92:95], v[68:83]
  ds_read_b64_tr_b16 v[136:137], v241 offset:1024
  ds_read_b64_tr_b16 v[138:139], v241 offset:1280
  s_waitcnt lgkmcnt(4)
  v_mfma_f32_32x32x16_bf16 v[68:83], v[144:147], v[96:99], v[68:83]
  ds_write_b128 v243, v[60:63] offset:16384
  ds_write_b128 v243, v[64:67] offset:17408
  ds_read_b64_tr_b16 v[140:141], v241 offset:18432
  ds_read_b64_tr_b16 v[142:143], v241 offset:18688
  s_waitcnt lgkmcnt(6)
  v_mfma_f32_32x32x16_bf16 v[68:83], v[132:135], v[100:103], v[68:83]
  ds_read_b64_tr_b16 v[144:145], v241 offset:19456
  ds_read_b64_tr_b16 v[146:147], v241 offset:19712
  s_waitcnt lgkmcnt(6)
  v_mfma_f32_32x32x16_bf16 v[68:83], v[136:139], v[104:107], v[68:83]
  s_waitcnt lgkmcnt(4)
  s_barrier
  ds_read_b64_tr_b16 v[132:133], v242 offset:0
  ds_read_b64_tr_b16 v[134:135], v242 offset:256
  s_waitcnt lgkmcnt(4)
  v_mfma_f32_32x32x16_bf16 v[68:83], v[140:143], v[108:111], v[68:83]
  ds_read_b128 v[248:251], v244 offset:16384
  ds_read_b128 v[252:255], v244 offset:17408
  ds_read_b64_tr_b16 v[136:137], v242 offset:1024
  ds_read_b64_tr_b16 v[138:139], v242 offset:1280
  s_waitcnt lgkmcnt(6)
  v_mfma_f32_32x32x16_bf16 v[68:83], v[144:147], v[112:115], v[68:83]
  ds_read_b64_tr_b16 v[140:141], v242 offset:18432
  ds_read_b64_tr_b16 v[142:143], v242 offset:18688
  s_waitcnt lgkmcnt(6)
  v_mfma_f32_32x32x16_bf16 v[68:83], v[132:135], v[116:119], v[68:83]
  s_waitcnt lgkmcnt(4)
  v_add_f32 v224, v52, v248
  v_add_f32 v225, v53, v249
  v_add_f32 v226, v54, v250
  v_add_f32 v227, v55, v251
  v_add_f32 v228, v56, v252
  v_add_f32 v229, v57, v253
  v_add_f32 v230, v58, v254
  v_add_f32 v231, v59, v255
  ds_read_b64_tr_b16 v[144:145], v242 offset:19456
  ds_read_b64_tr_b16 v[146:147], v242 offset:19712
  s_waitcnt lgkmcnt(4)
  v_mfma_f32_32x32x16_bf16 v[68:83], v[136:139], v[120:123], v[68:83]
  v_cvt_pk_bf16_f32 v248, v224, v225
  v_cvt_pk_bf16_f32 v249, v226, v227
  v_cvt_pk_bf16_f32 v250, v228, v229
  v_cvt_pk_bf16_f32 v251, v230, v231
  s_add_u32 s40, s53, 6144
  buffer_store_dwordx4 v[248:251], v175, s[48:51], s40 offen sc1
  s_waitcnt lgkmcnt(2)
  v_mfma_f32_32x32x16_bf16 v[68:83], v[140:143], v[124:127], v[68:83]
  s_waitcnt lgkmcnt(0)
  v_mfma_f32_32x32x16_bf16 v[68:83], v[144:147], v[128:131], v[68:83]
  s_nop 11
  ds_write_b128 v243, v[72:75] offset:0
  s_waitcnt lgkmcnt(0)
  s_barrier
  ds_read_b128 v[248:251], v244 offset:0
  s_waitcnt lgkmcnt(0)
  v_add_f32 v232, v68, v248
  v_add_f32 v233, v69, v249
  v_add_f32 v234, v70, v250
  v_add_f32 v235, v71, v251
  v_cvt_pk_bf16_f32 v248, v232, v233
  v_cvt_pk_bf16_f32 v249, v234, v235
  s_lshl_b32 s40, s30, 9
  s_sub_u32 s40, s53, s40
  s_add_u32 s40, s40, 8192
  v_lshrrev_b32 v180, 1, v175
  buffer_store_dwordx2 v[248:249], v180, s[48:51], s40 offen sc1
  s_barrier
  s_add_u32 s12, s8, 58720256
  s_addc_u32 s13, s9, 0
  s_mov_b32 s14, 9437184
  s_mov_b32 s15, 0x00020000
  s_add_u32 s16, s8, 13631488
  s_addc_u32 s17, s9, 0
  s_mov_b32 s18, 2359296
  s_mov_b32 s19, 0x00020000
  s_mov_b32 s20, s4
  s_mov_b32 s21, s5
  s_mov_b32 s22, 2359296
  s_mov_b32 s23, 0x00020000
  s_cmp_eq_u32 s29, s26
  s_cbranch_scc0 ffn2_kernel_pub
  s_lshl_b32 s39, s30, 11
  s_add_u32 s39, s39, 73728
  v_add_u32 v180, s39, v175
  ds_write_b128 v180, v[200:203] offset:0
  ds_write_b128 v180, v[204:207] offset:1024
  ds_write_b128 v180, v[208:211] offset:4096
  ds_write_b128 v180, v[212:215] offset:5120
  ds_write_b128 v180, v[216:219] offset:8192
  ds_write_b128 v180, v[220:223] offset:9216
  ds_write_b128 v180, v[224:227] offset:12288
  ds_write_b128 v180, v[228:231] offset:13312
  s_lshl_b32 s39, s30, 10
  s_add_u32 s39, s39, 90112
  v_add_u32 v180, s39, v175
  ds_write_b128 v180, v[232:235]
ffn2_kernel_pub:
  s_lshl_b32 s50, s25, 2
  s_add_u32 s50, s50, s26
  v_lshlrev_b32 v182, 8, v173
  v_lshl_add_u32 v182, v174, 3, v182
  s_add_u32 s60, s8, 8585216
  s_addc_u32 s61, s9, 0
  s_mov_b32 s62, 8192
  s_mov_b32 s63, 0x00020000
  s_lshl_b32 s42, s50, 7
  v_lshlrev_b32 v181, 2, v174
  buffer_load_dword v196, v181, s[60:63], s42 offen
  s_mov_b32 s52, s24
  s_lshr_b32 s54, s52, 1
  s_and_b32 s53, s52, 1
  s_lshl_b32 s55, s54, 2
  s_lshl_b32 s41, s53, 1
  s_cmp_eq_u32 s54, 4
  s_cselect_b32 s41, s53, s41
  s_add_u32 s55, s55, s41
  s_mul_i32 s42, s27, 18
  s_add_u32 s42, s42, s55
  s_lshr_b32 s43, s42, 1
  s_mul_i32 s41, s50, 36
  s_add_u32 s43, s43, s41
  s_lshl_b32 s43, s43, 10
  s_and_b32 s42, s42, 1
  s_lshl_b32 s42, s42, 3
  s_add_u32 s42, s42, s43
  buffer_load_dwordx4 v[188:191], v175, s[16:19], s42 offen
  s_cmp_lt_u32 s24, 2
  s_cbranch_scc0 ffn2_kernel_one
  s_add_u32 s56, s24, 8
  s_lshr_b32 s58, s56, 1
  s_and_b32 s57, s56, 1
  s_lshl_b32 s59, s58, 2
  s_lshl_b32 s41, s57, 1
  s_cmp_eq_u32 s58, 4
  s_cselect_b32 s41, s57, s41
  s_add_u32 s59, s59, s41
  s_mul_i32 s42, s27, 18
  s_add_u32 s42, s42, s59
  s_lshr_b32 s43, s42, 1
  s_mul_i32 s41, s50, 36
  s_add_u32 s43, s43, s41
  s_lshl_b32 s43, s43, 10
  s_and_b32 s42, s42, 1
  s_lshl_b32 s42, s42, 3
  s_add_u32 s42, s42, s43
  buffer_load_dwordx4 v[192:195], v175, s[16:19], s42 offen
ffn2_kernel_one:
  s_waitcnt vmcnt(0) lgkmcnt(0)
  s_barrier
  s_cmp_lg_u32 s24, 0
  s_cbranch_scc1 ffn2_kernel_wait
  s_add_u32 s44, s8, 20185088
  s_addc_u32 s45, s9, 0
  s_mov_b32 s46, 8192
  s_mov_b32 s47, 0x00020000
  s_lshl_b32 s41, s37, 7
  v_mov_b32 v180, 1
  v_mov_b32 v181, 0
  s_mov_b64 exec, 1
  buffer_atomic_add v180, v181, s[44:47], s41 offen sc1
  s_mov_b64 exec, -1
  s_mov_b32 s43, 0x200000
ffn2_kernel_spin:
  buffer_load_dword v180, v181, s[44:47], s41 offen sc1
  s_waitcnt vmcnt(0)
  v_readfirstlane_b32 s48, v180
  s_sub_u32 s43, s43, 1
  s_cmp_eq_u32 s43, 0
  s_cbranch_scc1 ffn2_kernel_wait
  s_cmp_ge_u32 s48, 4
  s_cbranch_scc1 ffn2_kernel_wait
  s_sleep 1
  s_branch ffn2_kernel_spin
ffn2_kernel_wait:
  s_barrier
  s_lshl_b32 s41, s54, 11
  s_lshl_b32 s42, s53, 10
  s_lshl_b32 s43, s53, 9
  s_cmp_eq_u32 s54, 4
  s_cselect_b32 s42, s43, s42
  s_add_u32 s41, s41, s42
  s_cmp_eq_u32 s54, 4
  s_cselect_b32 s42, 1, 0
  v_lshrrev_b32 v180, s42, v175
  s_add_u32 s40, s26, 1
  s_and_b32 s40, s40, 3
  s_add_u32 s43, s38, s26
  s_lshl_b32 s43, s43, 2
  s_add_u32 s40, s40, s43
  s_mul_i32 s40, s40, 9216
  s_add_u32 s40, s40, s41
  buffer_load_dwordx4 v[4:7], v180, s[12:15], s40 offen sc1
  s_add_u32 s40, s26, 2
  s_and_b32 s40, s40, 3
  s_add_u32 s43, s38, s26
  s_lshl_b32 s43, s43, 2
  s_add_u32 s40, s40, s43
  s_mul_i32 s40, s40, 9216
  s_add_u32 s40, s40, s41
  buffer_load_dwordx4 v[8:11], v180, s[12:15], s40 offen sc1
  s_add_u32 s40, s26, 3
  s_and_b32 s40, s40, 3
  s_add_u32 s43, s38, s26
  s_lshl_b32 s43, s43, 2
  s_add_u32 s40, s40, s43
  s_mul_i32 s40, s40, 9216
  s_add_u32 s40, s40, s41
  buffer_load_dwordx4 v[12:15], v180, s[12:15], s40 offen sc1
  s_lshl_b32 s42, s55, 10
  s_add_u32 s42, s42, 73728
  v_add_u32 v181, s42, v175
  ds_read_b128 v[16:19], v181
  ds_read_b128 v[20:23], v181 offset:1024
  s_cmp_lt_u32 s24, 2
  s_cbranch_scc0 ffn2_kernel_g1
  s_lshl_b32 s41, s58, 11
  s_lshl_b32 s42, s57, 10
  s_lshl_b32 s43, s57, 9
  s_cmp_eq_u32 s58, 4
  s_cselect_b32 s42, s43, s42
  s_add_u32 s41, s41, s42
  s_cmp_eq_u32 s58, 4
  s_cselect_b32 s42, 1, 0
  v_lshrrev_b32 v180, s42, v175
  s_add_u32 s40, s26, 1
  s_and_b32 s40, s40, 3
  s_add_u32 s43, s38, s26
  s_lshl_b32 s43, s43, 2
  s_add_u32 s40, s40, s43
  s_mul_i32 s40, s40, 9216
  s_add_u32 s40, s40, s41
  buffer_load_dwordx4 v[28:31], v180, s[12:15], s40 offen sc1
  s_add_u32 s40, s26, 2
  s_and_b32 s40, s40, 3
  s_add_u32 s43, s38, s26
  s_lshl_b32 s43, s43, 2
  s_add_u32 s40, s40, s43
  s_mul_i32 s40, s40, 9216
  s_add_u32 s40, s40, s41
  buffer_load_dwordx4 v[32:35], v180, s[12:15], s40 offen sc1
  s_add_u32 s40, s26, 3
  s_and_b32 s40, s40, 3
  s_add_u32 s43, s38, s26
  s_lshl_b32 s43, s43, 2
  s_add_u32 s40, s40, s43
  s_mul_i32 s40, s40, 9216
  s_add_u32 s40, s40, s41
  buffer_load_dwordx4 v[36:39], v180, s[12:15], s40 offen sc1
  s_lshl_b32 s42, s59, 10
  s_add_u32 s42, s42, 73728
  v_add_u32 v181, s42, v175
  ds_read_b128 v[40:43], v181
  ds_read_b128 v[44:47], v181 offset:1024
  s_waitcnt vmcnt(0) lgkmcnt(0)
  v_lshlrev_b32 v180, 16, v28
  v_and_b32 v181, 0xffff0000, v28
  v_add_f32 v40, v40, v180
  v_add_f32 v41, v41, v181
  v_lshlrev_b32 v180, 16, v29
  v_and_b32 v181, 0xffff0000, v29
  v_add_f32 v42, v42, v180
  v_add_f32 v43, v43, v181
  v_lshlrev_b32 v180, 16, v30
  v_and_b32 v181, 0xffff0000, v30
  v_add_f32 v44, v44, v180
  v_add_f32 v45, v45, v181
  v_lshlrev_b32 v180, 16, v31
  v_and_b32 v181, 0xffff0000, v31
  v_add_f32 v46, v46, v180
  v_add_f32 v47, v47, v181
  v_lshlrev_b32 v180, 16, v32
  v_and_b32 v181, 0xffff0000, v32
  v_add_f32 v40, v40, v180
  v_add_f32 v41, v41, v181
  v_lshlrev_b32 v180, 16, v33
  v_and_b32 v181, 0xffff0000, v33
  v_add_f32 v42, v42, v180
  v_add_f32 v43, v43, v181
  v_lshlrev_b32 v180, 16, v34
  v_and_b32 v181, 0xffff0000, v34
  v_add_f32 v44, v44, v180
  v_add_f32 v45, v45, v181
  v_lshlrev_b32 v180, 16, v35
  v_and_b32 v181, 0xffff0000, v35
  v_add_f32 v46, v46, v180
  v_add_f32 v47, v47, v181
  v_lshlrev_b32 v180, 16, v36
  v_and_b32 v181, 0xffff0000, v36
  v_add_f32 v40, v40, v180
  v_add_f32 v41, v41, v181
  v_lshlrev_b32 v180, 16, v37
  v_and_b32 v181, 0xffff0000, v37
  v_add_f32 v42, v42, v180
  v_add_f32 v43, v43, v181
  v_lshlrev_b32 v180, 16, v38
  v_and_b32 v181, 0xffff0000, v38
  v_add_f32 v44, v44, v180
  v_add_f32 v45, v45, v181
  v_lshlrev_b32 v180, 16, v39
  v_and_b32 v181, 0xffff0000, v39
  v_add_f32 v46, v46, v180
  v_add_f32 v47, v47, v181
  v_lshlrev_b32 v180, 16, v192
  v_and_b32 v181, 0xffff0000, v192
  v_add_f32 v40, v40, v180
  v_add_f32 v41, v41, v181
  v_lshlrev_b32 v180, 16, v193
  v_and_b32 v181, 0xffff0000, v193
  v_add_f32 v42, v42, v180
  v_add_f32 v43, v43, v181
  v_lshlrev_b32 v180, 16, v194
  v_and_b32 v181, 0xffff0000, v194
  v_add_f32 v44, v44, v180
  v_add_f32 v45, v45, v181
  v_lshlrev_b32 v180, 16, v195
  v_and_b32 v181, 0xffff0000, v195
  v_add_f32 v46, v46, v180
  v_add_f32 v47, v47, v181
  v_add_f32 v40, v40, v196
  v_add_f32 v41, v41, v196
  v_add_f32 v42, v42, v196
  v_add_f32 v43, v43, v196
  v_add_f32 v44, v44, v196
  v_add_f32 v45, v45, v196
  v_add_f32 v46, v46, v196
  v_add_f32 v47, v47, v196
  v_cvt_pk_bf16_f32 v40, v40, v41
  v_cvt_pk_bf16_f32 v41, v42, v43
  v_cvt_pk_bf16_f32 v42, v44, v45
  v_cvt_pk_bf16_f32 v43, v46, v47
  v_mul_u32_u24 v180, 304, v174
  v_lshl_add_u32 v180, v173, 3, v180
  s_lshl_b32 s42, s59, 4
  s_add_u32 s42, s42, 92160
  v_add_u32 v180, s42, v180
  ds_write_b64 v180, v[40:41]
  s_cmp_eq_u32 s58, 4
  s_cbranch_scc1 ffn2_kernel_half1
  ds_write_b64 v180, v[42:43] offset:16
ffn2_kernel_half1:
ffn2_kernel_g1:
  s_waitcnt vmcnt(0) lgkmcnt(0)
  v_lshlrev_b32 v180, 16, v4
  v_and_b32 v181, 0xffff0000, v4
  v_add_f32 v16, v16, v180
  v_add_f32 v17, v17, v181
  v_lshlrev_b32 v180, 16, v5
  v_and_b32 v181, 0xffff0000, v5
  v_add_f32 v18, v18, v180
  v_add_f32 v19, v19, v181
  v_lshlrev_b32 v180, 16, v6
  v_and_b32 v181, 0xffff0000, v6
  v_add_f32 v20, v20, v180
  v_add_f32 v21, v21, v181
  v_lshlrev_b32 v180, 16, v7
  v_and_b32 v181, 0xffff0000, v7
  v_add_f32 v22, v22, v180
  v_add_f32 v23, v23, v181
  v_lshlrev_b32 v180, 16, v8
  v_and_b32 v181, 0xffff0000, v8
  v_add_f32 v16, v16, v180
  v_add_f32 v17, v17, v181
  v_lshlrev_b32 v180, 16, v9
  v_and_b32 v181, 0xffff0000, v9
  v_add_f32 v18, v18, v180
  v_add_f32 v19, v19, v181
  v_lshlrev_b32 v180, 16, v10
  v_and_b32 v181, 0xffff0000, v10
  v_add_f32 v20, v20, v180
  v_add_f32 v21, v21, v181
  v_lshlrev_b32 v180, 16, v11
  v_and_b32 v181, 0xffff0000, v11
  v_add_f32 v22, v22, v180
  v_add_f32 v23, v23, v181
  v_lshlrev_b32 v180, 16, v12
  v_and_b32 v181, 0xffff0000, v12
  v_add_f32 v16, v16, v180
  v_add_f32 v17, v17, v181
  v_lshlrev_b32 v180, 16, v13
  v_and_b32 v181, 0xffff0000, v13
  v_add_f32 v18, v18, v180
  v_add_f32 v19, v19, v181
  v_lshlrev_b32 v180, 16, v14
  v_and_b32 v181, 0xffff0000, v14
  v_add_f32 v20, v20, v180
  v_add_f32 v21, v21, v181
  v_lshlrev_b32 v180, 16, v15
  v_and_b32 v181, 0xffff0000, v15
  v_add_f32 v22, v22, v180
  v_add_f32 v23, v23, v181
  v_lshlrev_b32 v180, 16, v188
  v_and_b32 v181, 0xffff0000, v188
  v_add_f32 v16, v16, v180
  v_add_f32 v17, v17, v181
  v_lshlrev_b32 v180, 16, v189
  v_and_b32 v181, 0xffff0000, v189
  v_add_f32 v18, v18, v180
  v_add_f32 v19, v19, v181
  v_lshlrev_b32 v180, 16, v190
  v_and_b32 v181, 0xffff0000, v190
  v_add_f32 v20, v20, v180
  v_add_f32 v21, v21, v181
  v_lshlrev_b32 v180, 16, v191
  v_and_b32 v181, 0xffff0000, v191
  v_add_f32 v22, v22, v180
  v_add_f32 v23, v23, v181
  v_add_f32 v16, v16, v196
  v_add_f32 v17, v17, v196
  v_add_f32 v18, v18, v196
  v_add_f32 v19, v19, v196
  v_add_f32 v20, v20, v196
  v_add_f32 v21, v21, v196
  v_add_f32 v22, v22, v196
  v_add_f32 v23, v23, v196
  v_cvt_pk_bf16_f32 v16, v16, v17
  v_cvt_pk_bf16_f32 v17, v18, v19
  v_cvt_pk_bf16_f32 v18, v20, v21
  v_cvt_pk_bf16_f32 v19, v22, v23
  v_mul_u32_u24 v180, 304, v174
  v_lshl_add_u32 v180, v173, 3, v180
  s_lshl_b32 s42, s55, 4
  s_add_u32 s42, s42, 92160
  v_add_u32 v180, s42, v180
  ds_write_b64 v180, v[16:17]
  s_cmp_eq_u32 s54, 4
  s_cbranch_scc1 ffn2_kernel_half0
  ds_write_b64 v180, v[18:19] offset:16
ffn2_kernel_half0:
  s_waitcnt lgkmcnt(0)
  s_barrier
  s_mov_b32 s44, 3641
  s_lshl_b32 s45, s50, 5
  s_mul_i32 s45, s45, 1152
  s_mul_i32 s46, s27, 288
  s_add_u32 s45, s45, s46
  v_add_u32 v180, 0, v0
  v_mul_lo_u32 v181, v180, s44
  v_lshrrev_b32 v181, 16, v181
  v_mul_u32_u24 v182, 18, v181
  v_sub_u32 v182, v180, v182
  v_mul_u32_u24 v183, 304, v181
  v_lshl_add_u32 v183, v182, 4, v183
  v_add_u32 v183, 92160, v183
  ds_read_b128 v[52:55], v183
  v_mul_u32_u24 v181, 1152, v181
  v_lshl_add_u32 v56, v182, 4, v181
  s_waitcnt lgkmcnt(0)
  buffer_store_dwordx4 v[52:55], v56, s[20:23], s45 offen
  s_cmp_lg_u32 s24, 0
  s_cbranch_scc1 ffn2_kernel_exit
  v_add_u32 v180, 512, v0
  v_mul_lo_u32 v181, v180, s44
  v_lshrrev_b32 v181, 16, v181
  v_mul_u32_u24 v182, 18, v181
  v_sub_u32 v182, v180, v182
  v_mul_u32_u24 v183, 304, v181
  v_lshl_add_u32 v183, v182, 4, v183
  v_add_u32 v183, 92160, v183
  ds_read_b128 v[60:63], v183
  v_mul_u32_u24 v181, 1152, v181
  v_lshl_add_u32 v64, v182, 4, v181
  s_waitcnt lgkmcnt(0)
  buffer_store_dwordx4 v[60:63], v64, s[20:23], s45 offen
ffn2_kernel_exit:
ffn2_kernel_end:
  s_endpgm
code_end:
.section .rodata,"a"
.p2align 6
.amdhsa_kernel ffn2_kernel
.amdhsa_next_free_vgpr 256
.amdhsa_next_free_sgpr 100
.amdhsa_accum_offset 256
.amdhsa_group_segment_fixed_size 0
.amdhsa_kernarg_size 80
.amdhsa_user_sgpr_count 2
.amdhsa_user_sgpr_kernarg_segment_ptr 1
.amdhsa_system_sgpr_workgroup_id_x 1
.amdhsa_float_denorm_mode_32 3
.amdhsa_ieee_mode 0
.end_amdhsa_kernel
```
